```python
import torch

def _softmax(x, axis=-1):
    return torch.softmax(x, dim=axis)
def _gelu(x):
    return torch.nn.functional.gelu(x, approximate="tanh")
def _silu(x):
    return torch.nn.functional.silu(x)
def _sigmoid(x):
    return torch.sigmoid(x)
def _layernorm(x, axis=-1, eps=1e-5):
    m = x.mean(dim=axis, keepdim=True)
    v = x.var(dim=axis, keepdim=True, unbiased=False)
    return (x - m) / torch.sqrt(v + eps)
def _scatter_add(tgt, idx, src, axis=0):
    return tgt.clone().index_add_(axis, idx, src)
def _segment_sum(src, seg, n):
    out = torch.zeros((n,) + src.shape[1:], dtype=src.dtype)
    return out.index_add_(0, seg, src)
def _pad(x, pw):
    flat = tuple(v for pair in reversed(pw) for v in pair)
    return torch.nn.functional.pad(x, flat)

kernel_name = 'sequential_preLN__ssm_conv_s4__glu_gated_reglu__prompt'

def setup_inputs():

    _w = (lambda a: (lambda t: t.to(torch.bfloat16) if t.is_floating_point() else t)(torch.as_tensor(a)))
    def _A_setup():
        B, L, D, N = 1, 2048, 640, 128
        A_re = -(lambda _x: torch.exp(torch.as_tensor(_x)))((lambda *s: torch.randn(*s, dtype=torch.bfloat16) * 6.4)(D, N))
        A_im = torch.pi * (lambda *s: torch.randn(*s, dtype=torch.bfloat16) * 0.05)(D, N)
        B_re = (lambda *s: torch.randn(*s, dtype=torch.bfloat16) * 0.05)(D, N)
        B_im = (lambda *s: torch.randn(*s, dtype=torch.bfloat16) * 0.05)(D, N)
        C_re = (lambda *s: torch.randn(*s, dtype=torch.bfloat16) * 0.05)(D, N)
        C_im = (lambda *s: torch.randn(*s, dtype=torch.bfloat16) * 0.05)(D, N)
        log_dt = (lambda *s: torch.randn(*s, dtype=torch.bfloat16) * 0.05)(D) * 0.5 - 4.0
        Dskip = (lambda *s: torch.randn(*s, dtype=torch.bfloat16) * 0.05)(D)
        return {
            "u": _w((lambda *s: torch.randn(*s, dtype=torch.bfloat16) * 0.05)(B, L, D)),
            "A_re": _w(A_re),
            "A_im": _w(A_im),
            "B_re": _w(B_re),
            "B_im": _w(B_im),
            "C_re": _w(C_re),
            "C_im": _w(C_im),
            "log_dt": _w(log_dt),
            "Dskip": _w(Dskip),
        }
    _A_in = _A_setup()

    def _B_setup():
        B, S, D, F = 1, 2048, 640, 1728
        return {
            "x": _w((lambda *s: torch.randn(*s, dtype=torch.bfloat16) * 0.05)(B, S, D)),
            "W_gate": _w((lambda *s: torch.randn(*s, dtype=torch.bfloat16) * 0.4)(D, F) * (2.0 / D) ** 0.5),
            "W_up": _w((lambda *s: torch.randn(*s, dtype=torch.bfloat16) * 0.4)(D, F) * (2.0 / D) ** 0.5),
            "W_down": _w((lambda *s: torch.randn(*s, dtype=torch.bfloat16) * 0.4)(F, D) * (1.0 / F) ** 0.5),
        }
    _B_in = _B_setup()

    return {
        "A_u": _A_in["u"],
        "A_A_re": _A_in["A_re"],
        "A_A_im": _A_in["A_im"],
        "A_B_re": _A_in["B_re"],
        "A_B_im": _A_in["B_im"],
        "A_C_re": _A_in["C_re"],
        "A_C_im": _A_in["C_im"],
        "A_log_dt": _A_in["log_dt"],
        "A_Dskip": _A_in["Dskip"],
        "B_x": _B_in["x"],
        "B_W_gate": _B_in["W_gate"],
        "B_W_up": _B_in["W_up"],
        "B_W_down": _B_in["W_down"],
    }

def reference(A_u, A_A_re, A_A_im, A_B_re, A_B_im, A_C_re, A_C_im, A_log_dt, A_Dskip, B_x, B_W_gate, B_W_up, B_W_down):
    def _A_ref(u, A_re, A_im, B_re, B_im, C_re, C_im, log_dt, Dskip):
        Bsz, L, D = u.shape
        dt = torch.exp(log_dt)[:, None]
        A = A_re + 1j * A_im
        Bc = B_re + 1j * B_im
        Cc = C_re + 1j * C_im
        logdA = dt * A
        dB = dt * Bc
        l = (lambda x, dt: x.to(dt))(torch.arange(L), A_re.dtype)
        P = torch.exp(logdA[:, :, None] * l[None, None, :])
        K = torch.einsum("dn,dnl,dn->dl", Cc, P, dB).real
        L2 = 2 * L
        Kp = _pad(K, ((0, 0), (0, L)))
        up = (lambda x, *d: x.permute(*d))(u, 0, 2, 1)
        up = _pad(up, ((0, 0), (0, 0), (0, L)))
        Kf = (lambda x, axes=(-2,-1): torch.fft.rfft2(x.float(), dim=axes))(Kp[:, None, :], axes=(-2, -1))
        Uf = (lambda x, axes=(-2,-1): torch.fft.rfft2(x.float(), dim=axes))(up[:, :, None, :], axes=(-2, -1))
        Yf = Uf * Kf[None, :, :, :]
        y = (lambda x, s, axes=(-2,-1): torch.fft.irfft2(x, s=s, dim=axes).to(torch.bfloat16))(Yf, (1, L2), axes=(-2, -1))[:, :, 0, :L]
        y = (lambda x, *d: x.permute(*d))(y, 0, 2, 1) + u * Dskip[None, None, :]
        return y

    def _B_ref(x, W_gate, W_up, W_down):
        gate = torch.einsum("bsd,df->bsf", x, W_gate)
        up = torch.einsum("bsd,df->bsf", x, W_up)
        gate = gate * (lambda x, dt: x.to(dt))(gate > 0, gate.dtype)
        h = gate * up
        return torch.einsum("bsf,fd->bsd", h, W_down)

    x = A_u
    h = x + _A_ref(_layernorm(x, axis=-1), A_A_re, A_A_im, A_B_re, A_B_im, A_C_re, A_C_im, A_log_dt, A_Dskip)
    h2 = h + _B_ref(_layernorm(h, axis=-1), B_W_gate, B_W_up, B_W_down)
    return h2
```

```asm
; @launch grid=(256,1,1) block=(512,1,1) lds=163840
.amdgcn_target "amdgcn-amd-amdhsa--gfx950"
.text
.globl sequential_preLN__ssm_conv_s4__glu_gated_reglu__prompt_kernel
.p2align 8
.type sequential_preLN__ssm_conv_s4__glu_gated_reglu__prompt_kernel,@function
sequential_preLN__ssm_conv_s4__glu_gated_reglu__prompt_kernel:
    s_cmp_ge_u32 s2, 256
    s_cbranch_scc1 L_end
    s_load_dwordx16 s[36:51], s[0:1], 0
    s_load_dwordx16 s[52:67], s[0:1], 64
    s_memrealtime s[32:33]
    s_cmp_ge_u32 s2, 8
    s_cbranch_scc1 L_e0
    s_getpc_b64 s[4:5]
L_pc0:
    s_sub_u32 s4, s4, L_pc0-sequential_preLN__ssm_conv_s4__glu_gated_reglu__prompt_kernel
    s_subb_u32 s5, s5, 0
    v_lshlrev_b32 v254, 7, v0
    v_min_u32 v254, L_codeend-sequential_preLN__ssm_conv_s4__glu_gated_reglu__prompt_kernel-4, v254
    global_load_dword v255, v254, s[4:5]
L_e0:
    v_lshrrev_b32 v1, 6, v0
    s_nop 0
    v_readfirstlane_b32 s3, v1
    v_and_b32 v1, 63, v0
    s_cmp_ge_u32 s3, 4
    s_cbranch_scc1 L_aux
    s_cmp_ge_u32 s2, 160
    s_cbranch_scc1 L_helper
    s_and_b32 s4, s2, 7
    s_mul_i32 s4, s4, 20
    s_lshr_b32 s5, s2, 3
    s_add_u32 s68, s4, s5
    s_lshl_b32 s69, s68, 2
    s_add_u32 s70, s69, s3
    s_mul_i32 s71, s3, 33792
    s_lshl_b32 s4, s70, 8
    v_lshl_add_u32 v10, v1, 2, s4
    s_and_b32 s5, s70, 0xfffe
    s_lshl_b32 s5, s5, 1
    s_waitcnt lgkmcnt(0)
    global_load_dword v240, v10, s[38:39]
    global_load_dword v241, v10, s[40:41]
    global_load_dword v242, v10, s[42:43]
    global_load_dword v243, v10, s[44:45]
    global_load_dword v244, v10, s[46:47]
    global_load_dword v245, v10, s[48:49]
    s_load_dword s72, s[50:51], s5
    s_barrier
    s_branch L_cold_c
L_aux:
    s_cmp_ge_u32 s2, 160
    s_cbranch_scc1 L_ld_helper
    s_and_b32 s4, s2, 7
    s_mul_i32 s4, s4, 20
    s_lshr_b32 s5, s2, 3
    s_add_u32 s19, s4, s5
    s_lshl_b32 s6, s19, 3
    v_subrev_u32 v199, 256, v0
    v_mul_u32_u24 v195, 2560, v199
    v_add_u32 v195, s6, v195
    s_mov_b32 s16, 655360
    s_mov_b32 s17, 1310720
    s_mov_b32 s18, 1966080
    v_lshlrev_b32 v192, 4, v199
    v_mov_b32 v194, 0
    s_mov_b32 s20, 0
    s_mov_b32 s21, 4096
    s_mov_b32 s22, 8192
    s_mov_b32 s23, 12288
    s_lshr_b32 s4, s2, 3
    s_and_b32 s4, s4, 3
    s_cmp_lg_u32 s4, 0
    s_cbranch_scc1 L_rot_14_0
    s_waitcnt lgkmcnt(0)
    s_mov_b32 s8, s36
    s_mov_b32 s9, s37
    s_mov_b32 s10, 2621440
    s_mov_b32 s11, 0x00020000
    s_mov_b32 s24, s64
    s_mov_b32 s25, s65
    s_mov_b32 s26, 256
    s_mov_b32 s27, 0x00020000
    s_cmp_lg_u32 s2, 2
    s_cbranch_scc1 L_nn
    s_cmp_lg_u32 s3, 4
    s_cbranch_scc1 L_nn
    s_or_b32 s5, s32, 1
    v_mov_b32 v2, s5
    v_mov_b32 v3, 0
    s_mov_b64 exec, 1
    buffer_store_dword v2, v3, s[24:27], 0 offen sc1
    s_mov_b64 exec, -1
L_nn:
    s_barrier
    buffer_load_dwordx2 v[48:49], v195, s[8:11], 0 offen offset:0
    buffer_load_dwordx2 v[50:51], v195, s[8:11], 0 offen offset:1280
    buffer_load_dwordx2 v[52:53], v195, s[8:11], s16 offen offset:0
    s_branch L_cold_aux0
L_rot_14_0:
    s_cmp_lg_u32 s4, 1
    s_cbranch_scc1 L_rot_14_1
    s_waitcnt lgkmcnt(0)
    s_mov_b32 s8, s36
    s_mov_b32 s9, s37
    s_mov_b32 s10, 2621440
    s_mov_b32 s11, 0x00020000
    s_barrier
    buffer_load_dwordx2 v[52:53], v195, s[8:11], s16 offen offset:0
    buffer_load_dwordx2 v[54:55], v195, s[8:11], s16 offen offset:1280
    buffer_load_dwordx2 v[56:57], v195, s[8:11], s17 offen offset:0
    s_branch L_cold_aux1
L_rot_14_1:
    s_cmp_lg_u32 s4, 2
    s_cbranch_scc1 L_rot_14_2
    s_waitcnt lgkmcnt(0)
    s_mov_b32 s8, s36
    s_mov_b32 s9, s37
    s_mov_b32 s10, 2621440
    s_mov_b32 s11, 0x00020000
    s_barrier
    buffer_load_dwordx2 v[56:57], v195, s[8:11], s17 offen offset:0
    buffer_load_dwordx2 v[58:59], v195, s[8:11], s17 offen offset:1280
    buffer_load_dwordx2 v[60:61], v195, s[8:11], s18 offen offset:0
    s_branch L_cold_aux2
L_rot_14_2:
    s_waitcnt lgkmcnt(0)
    s_mov_b32 s8, s36
    s_mov_b32 s9, s37
    s_mov_b32 s10, 2621440
    s_mov_b32 s11, 0x00020000
    s_barrier
    buffer_load_dwordx2 v[60:61], v195, s[8:11], s18 offen offset:0
    buffer_load_dwordx2 v[62:63], v195, s[8:11], s18 offen offset:1280
    buffer_load_dwordx2 v[48:49], v195, s[8:11], 0 offen offset:0
    s_branch L_cold_aux3
L_helper:
    s_and_b32 s5, s2, 7
    s_cmp_eq_u32 s5, 0
    s_cbranch_scc1 L_l1e_6_n
    s_lshr_b32 s4, s2, 3
    s_mul_i32 s4, s4, 7
    s_add_u32 s4, s4, s5
    s_sub_u32 s4, s4, 141
    s_mul_i32 s5, s3, 84
    s_add_u32 s4, s4, s5
    s_cmp_ge_u32 s4, 256
    s_cbranch_scc1 L_l1e_6_n
    s_lshl_b32 s4, s4, 3
    v_lshrrev_b32 v48, 3, v1
    v_add_u32 v48, s4, v48
    v_and_b32 v49, 7, v1
    v_mul_u32_u24 v2, 1280, v48
    v_lshl_add_u32 v2, v49, 4, v2
    s_waitcnt lgkmcnt(0)
    global_load_dwordx4 v[4:7], v2, s[36:37] offset:0
    global_load_dwordx4 v[8:11], v2, s[36:37] offset:128
    global_load_dwordx4 v[12:15], v2, s[36:37] offset:256
    global_load_dwordx4 v[16:19], v2, s[36:37] offset:384
    global_load_dwordx4 v[20:23], v2, s[36:37] offset:512
    global_load_dwordx4 v[24:27], v2, s[36:37] offset:640
    global_load_dwordx4 v[28:31], v2, s[36:37] offset:768
    global_load_dwordx4 v[32:35], v2, s[36:37] offset:896
    global_load_dwordx4 v[36:39], v2, s[36:37] offset:1024
    global_load_dwordx4 v[40:43], v2, s[36:37] offset:1152
    s_branch L_cold_ln1
L_cold_c:
    s_mov_b32 s28, s66
    s_mov_b32 s29, s67
    s_mov_b32 s30, 67108864
    s_mov_b32 s31, 0x00020000
    s_mov_b32 s24, s64
    s_mov_b32 s25, s65
    s_mov_b32 s26, 256
    s_mov_b32 s27, 0x00020000
    v_mov_b32 v48, 0
    v_mov_b32 v49, 0
    v_mov_b32 v50, 0
    v_mov_b32 v51, 0
    s_mul_i32 s73, s3, 4672
    s_add_u32 s73, s73, 135168
    v_min_u32 v12, 33, v1
    v_lshl_add_u32 v12, v12, 4, s73
    ds_write_b128 v12, v[48:51]
    v_and_b32 v12, 15, v1
    v_lshrrev_b32 v13, 4, v1
    v_lshlrev_b32 v4, 5, v12
    v_lshl_add_u32 v4, v13, 4, v4
    v_add_u32 v4, s73, v4
    v_add_u32 v5, v12, v13
    v_lshl_add_u32 v5, v5, 4, s73
    v_lshl_add_u32 v6, v13, 6, v12
    v_lshl_add_u32 v6, v6, 2, s71
    v_and_b32 v48, 1, v1
    v_mul_u32_u24 v2, 1218, v48
    v_sub_u32 v2, 1248, v2
    v_lshl_add_u32 v2, v13, 4, v2
    v_lshlrev_b32 v49, 1, v12
    v_sub_u32 v2, v2, v49
    v_add_u32 v2, s71, v2
    v_add_u32 v3, 512, v2
    v_lshlrev_b32 v49, 1, v13
    v_sub_u32 v7, v49, v12
    v_add_u32 v7, 623, v7
    v_lshl_add_u32 v7, v7, 2, s71
    v_sub_u32 v8, 16, v12
    v_lshrrev_b32 v8, 1, v8
    v_add_u32 v8, v8, v49
    v_mul_u32_u24 v48, 80, v48
    v_sub_u32 v8, v8, v48
    v_add_u32 v8, 848, v8
    v_lshl_add_u32 v8, v8, 2, s71
    v_and_b32 v48, 31, v1
    v_lshrrev_b32 v49, 5, v1
    v_mul_u32_u24 v36, 528, v48
    v_lshl_add_u32 v36, v49, 4, v36
    v_add_u32 v36, s71, v36
    v_lshl_add_u32 v76, v1, 3, s71
    s_waitcnt lgkmcnt(0)
    s_lshl_b32 s4, s72, 16
    s_and_b32 s5, s72, 0xffff0000
    s_bitcmp1_b32 s70, 0
    s_cselect_b32 s72, s5, s4
    v_mov_b32 v64, s72
    v_mul_f32 v64, 0x3fb8aa3b, v64
    v_exp_f32 v64, v64
    s_nop 0
    v_cvt_pk_bf16_f32 v64, v64, v64
    v_lshlrev_b32 v64, 16, v64
    v_mul_f32 v66, 0x3fb8aa3b, v64
    v_mul_f32 v67, 0.15915494, v64
    s_mov_b32 s14, 0x41000000
    s_mov_b32 s15, 0x43800000
    s_mov_b32 s6, 0xffff
    s_mov_b32 s7, 0x3f803f80
    v_lshlrev_b32 v46, 3, v13
    v_add_u32 v43, 6, v12
    v_mov_b32 v44, 31
    v_lshlrev_b32 v43, v43, v44
    v_lshrrev_b32 v43, v46, v43
    v_bfe_i32 v44, v43, 0, 1
    v_bfe_i32 v45, v43, 1, 1
    v_bfi_b32 v16, s6, v44, v45
    v_and_b32 v16, s7, v16
    v_bfe_i32 v44, v43, 2, 1
    v_bfe_i32 v45, v43, 3, 1
    v_bfi_b32 v17, s6, v44, v45
    v_and_b32 v17, s7, v17
    v_bfe_i32 v44, v43, 4, 1
    v_bfe_i32 v45, v43, 5, 1
    v_bfi_b32 v18, s6, v44, v45
    v_and_b32 v18, s7, v18
    v_bfe_i32 v44, v43, 6, 1
    v_bfe_i32 v45, v43, 7, 1
    v_bfi_b32 v19, s6, v44, v45
    v_and_b32 v19, s7, v19
    v_add_u32 v43, 11, v12
    v_mov_b32 v44, 7
    v_lshlrev_b32 v43, v43, v44
    v_lshrrev_b32 v43, v46, v43
    v_bfe_i32 v44, v43, 0, 1
    v_bfe_i32 v45, v43, 1, 1
    v_bfi_b32 v20, s6, v44, v45
    v_and_b32 v20, s7, v20
    v_bfe_i32 v44, v43, 2, 1
    v_bfe_i32 v45, v43, 3, 1
    v_bfi_b32 v21, s6, v44, v45
    v_and_b32 v21, s7, v21
    v_bfe_i32 v44, v43, 4, 1
    v_bfe_i32 v45, v43, 5, 1
    v_bfi_b32 v22, s6, v44, v45
    v_and_b32 v22, s7, v22
    v_bfe_i32 v44, v43, 6, 1
    v_bfe_i32 v45, v43, 7, 1
    v_bfi_b32 v23, s6, v44, v45
    v_and_b32 v23, s7, v23
    v_add_u32 v43, 4, v12
    v_mov_b32 v44, 511
    v_lshlrev_b32 v43, v43, v44
    v_lshrrev_b32 v43, v46, v43
    v_bfe_i32 v44, v43, 0, 1
    v_bfe_i32 v45, v43, 1, 1
    v_bfi_b32 v24, s6, v44, v45
    v_and_b32 v24, s7, v24
    v_bfe_i32 v44, v43, 2, 1
    v_bfe_i32 v45, v43, 3, 1
    v_bfi_b32 v25, s6, v44, v45
    v_and_b32 v25, s7, v25
    v_bfe_i32 v44, v43, 4, 1
    v_bfe_i32 v45, v43, 5, 1
    v_bfi_b32 v26, s6, v44, v45
    v_and_b32 v26, s7, v26
    v_bfe_i32 v44, v43, 6, 1
    v_bfe_i32 v45, v43, 7, 1
    v_bfi_b32 v27, s6, v44, v45
    v_and_b32 v27, s7, v27
    v_add_u32 v43, 5, v12
    v_mov_b32 v44, 127
    v_lshlrev_b32 v43, v43, v44
    v_lshrrev_b32 v43, v46, v43
    v_bfe_i32 v44, v43, 0, 1
    v_bfe_i32 v45, v43, 1, 1
    v_bfi_b32 v28, s6, v44, v45
    v_and_b32 v28, s7, v28
    v_bfe_i32 v44, v43, 2, 1
    v_bfe_i32 v45, v43, 3, 1
    v_bfi_b32 v29, s6, v44, v45
    v_and_b32 v29, s7, v29
    v_bfe_i32 v44, v43, 4, 1
    v_bfe_i32 v45, v43, 5, 1
    v_bfi_b32 v30, s6, v44, v45
    v_and_b32 v30, s7, v30
    v_bfe_i32 v44, v43, 6, 1
    v_bfe_i32 v45, v43, 7, 1
    v_bfi_b32 v31, s6, v44, v45
    v_and_b32 v31, s7, v31
    v_add_u32 v43, 4, v12
    v_mov_b32 v44, 127
    v_lshlrev_b32 v43, v43, v44
    v_lshrrev_b32 v43, v46, v43
    v_bfe_i32 v44, v43, 0, 1
    v_bfe_i32 v45, v43, 1, 1
    v_bfi_b32 v32, s6, v44, v45
    v_bfe_i32 v44, v43, 2, 1
    v_bfe_i32 v45, v43, 3, 1
    v_bfi_b32 v33, s6, v44, v45
    v_bfe_i32 v44, v43, 4, 1
    v_bfe_i32 v45, v43, 5, 1
    v_bfi_b32 v34, s6, v44, v45
    v_bfe_i32 v44, v43, 6, 1
    v_bfe_i32 v45, v43, 7, 1
    v_bfi_b32 v35, s6, v44, v45
    v_and_b32 v43, 31, v1
    s_waitcnt vmcnt(0)
    v_lshlrev_b32 v52, 16, v240
    v_and_b32 v53, 0xffff0000, v240
    v_lshlrev_b32 v54, 16, v241
    v_and_b32 v55, 0xffff0000, v241
    v_lshlrev_b32 v56, 16, v242
    v_and_b32 v57, 0xffff0000, v242
    v_lshlrev_b32 v58, 16, v243
    v_and_b32 v59, 0xffff0000, v243
    v_lshlrev_b32 v60, 16, v244
    v_and_b32 v61, 0xffff0000, v244
    v_lshlrev_b32 v62, 16, v245
    v_and_b32 v63, 0xffff0000, v245
    v_pk_mul_f32 v[68:69], v[52:53], v[66:67] op_sel:[0,0] op_sel_hi:[1,0]
    v_pk_mul_f32 v[70:71], v[54:55], v[66:67] op_sel:[0,1] op_sel_hi:[1,1]
    v_pk_mul_f32 v[90:91], v[68:69], s[14:15] op_sel:[0,0] op_sel_hi:[1,0]
    v_pk_mul_f32 v[92:93], v[70:71], s[14:15] op_sel:[0,0] op_sel_hi:[1,0]
    v_fract_f32 v92, v92
    v_fract_f32 v93, v93
    v_exp_f32 v90, v90
    v_exp_f32 v91, v91
    v_cos_f32 v82, v92
    v_cos_f32 v83, v93
    v_sin_f32 v84, v92
    v_sin_f32 v85, v93
    v_pk_mul_f32 v[82:83], v[82:83], v[90:91]
    v_pk_mul_f32 v[84:85], v[84:85], v[90:91]
    v_fract_f32 v92, v70
    v_fract_f32 v93, v71
    v_exp_f32 v90, v68
    v_exp_f32 v91, v69
    v_cos_f32 v78, v92
    v_cos_f32 v79, v93
    v_sin_f32 v80, v92
    v_sin_f32 v81, v93
    v_pk_mul_f32 v[78:79], v[78:79], v[90:91]
    v_pk_mul_f32 v[80:81], v[80:81], v[90:91]
    v_pk_mul_f32 v[90:91], v[68:69], s[14:15] op_sel:[0,1] op_sel_hi:[1,1]
    v_pk_mul_f32 v[92:93], v[70:71], s[14:15] op_sel:[0,1] op_sel_hi:[1,1]
    v_fract_f32 v92, v92
    v_fract_f32 v93, v93
    v_exp_f32 v90, v90
    v_exp_f32 v91, v91
    v_cos_f32 v86, v92
    v_cos_f32 v87, v93
    v_sin_f32 v88, v92
    v_sin_f32 v89, v93
    v_pk_mul_f32 v[86:87], v[86:87], v[90:91]
    v_pk_mul_f32 v[88:89], v[88:89], v[90:91]
    v_pk_mul_f32 v[72:73], v[58:59], v[62:63]
    v_pk_mul_f32 v[74:75], v[58:59], v[60:61]
    v_pk_fma_f32 v[72:73], v[56:57], v[60:61], v[72:73] neg_lo:[0,0,1] neg_hi:[0,0,1]
    v_pk_fma_f32 v[74:75], v[56:57], v[62:63], v[74:75]
    v_pk_mul_f32 v[96:97], v[72:73], v[64:65] op_sel_hi:[1,0]
    v_pk_mul_f32 v[98:99], v[74:75], v[64:65] op_sel_hi:[1,0]
    v_mov_b32 v124, 0x3f80
    v_cvt_pk_bf16_f32 v120, v96, -v98
    v_mov_b32 v125, 0x3f80
    v_cvt_pk_bf16_f32 v121, v97, -v99
    ds_write_b64 v76, v[124:125] offset:16896
    ds_write_b64 v76, v[120:121] offset:0
    v_cvt_pk_bf16_f32 v126, v82, v84
    v_pk_mul_f32 v[72:73], v[98:99], v[80:81]
    v_cvt_pk_bf16_f32 v127, v83, v85
    v_pk_mul_f32 v[74:75], v[98:99], v[78:79]
    ds_write_b64 v76, v[126:127] offset:17424
    v_pk_fma_f32 v[118:119], v[96:97], v[80:81], v[74:75]
    v_pk_mul_f32 v[128:129], v[84:85], v[84:85]
    v_pk_fma_f32 v[116:117], v[96:97], v[78:79], v[72:73] neg_lo:[0,0,1] neg_hi:[0,0,1]
    v_pk_mul_f32 v[130:131], v[84:85], v[82:83]
    v_cvt_pk_bf16_f32 v122, v116, -v118
    v_pk_fma_f32 v[134:135], v[82:83], v[84:85], v[130:131]
    v_cvt_pk_bf16_f32 v123, v117, -v119
    v_pk_fma_f32 v[132:133], v[82:83], v[82:83], v[128:129] neg_lo:[0,0,1] neg_hi:[0,0,1]
    ds_write_b64 v76, v[122:123] offset:528
    v_cvt_pk_bf16_f32 v124, v132, v134
    v_pk_mul_f32 v[72:73], v[118:119], v[80:81]
    v_cvt_pk_bf16_f32 v125, v133, v135
    v_pk_mul_f32 v[74:75], v[118:119], v[78:79]
    ds_write_b64 v76, v[124:125] offset:17952
    v_pk_fma_f32 v[102:103], v[116:117], v[80:81], v[74:75]
    v_pk_mul_f32 v[128:129], v[134:135], v[84:85]
    v_pk_fma_f32 v[100:101], v[116:117], v[78:79], v[72:73] neg_lo:[0,0,1] neg_hi:[0,0,1]
    v_pk_mul_f32 v[130:131], v[134:135], v[82:83]
    v_cvt_pk_bf16_f32 v120, v100, -v102
    v_pk_fma_f32 v[134:135], v[132:133], v[84:85], v[130:131]
    v_cvt_pk_bf16_f32 v121, v101, -v103
    v_pk_fma_f32 v[132:133], v[132:133], v[82:83], v[128:129] neg_lo:[0,0,1] neg_hi:[0,0,1]
    ds_write_b64 v76, v[120:121] offset:1056
    v_cvt_pk_bf16_f32 v126, v132, v134
    v_pk_mul_f32 v[72:73], v[102:103], v[80:81]
    v_cvt_pk_bf16_f32 v127, v133, v135
    v_pk_mul_f32 v[74:75], v[102:103], v[78:79]
    ds_write_b64 v76, v[126:127] offset:18480
    v_pk_fma_f32 v[118:119], v[100:101], v[80:81], v[74:75]
    v_pk_mul_f32 v[128:129], v[134:135], v[84:85]
    v_pk_fma_f32 v[116:117], v[100:101], v[78:79], v[72:73] neg_lo:[0,0,1] neg_hi:[0,0,1]
    v_pk_mul_f32 v[130:131], v[134:135], v[82:83]
    v_cvt_pk_bf16_f32 v122, v116, -v118
    v_pk_fma_f32 v[134:135], v[132:133], v[84:85], v[130:131]
    v_cvt_pk_bf16_f32 v123, v117, -v119
    v_pk_fma_f32 v[132:133], v[132:133], v[82:83], v[128:129] neg_lo:[0,0,1] neg_hi:[0,0,1]
    ds_write_b64 v76, v[122:123] offset:1584
    v_cvt_pk_bf16_f32 v124, v132, v134
    v_pk_mul_f32 v[72:73], v[118:119], v[80:81]
    v_cvt_pk_bf16_f32 v125, v133, v135
    v_pk_mul_f32 v[74:75], v[118:119], v[78:79]
    ds_write_b64 v76, v[124:125] offset:19008
    v_pk_fma_f32 v[106:107], v[116:117], v[80:81], v[74:75]
    v_pk_mul_f32 v[128:129], v[134:135], v[84:85]
    v_pk_fma_f32 v[104:105], v[116:117], v[78:79], v[72:73] neg_lo:[0,0,1] neg_hi:[0,0,1]
    v_pk_mul_f32 v[130:131], v[134:135], v[82:83]
    v_cvt_pk_bf16_f32 v120, v104, -v106
    v_pk_fma_f32 v[134:135], v[132:133], v[84:85], v[130:131]
    v_cvt_pk_bf16_f32 v121, v105, -v107
    v_pk_fma_f32 v[132:133], v[132:133], v[82:83], v[128:129] neg_lo:[0,0,1] neg_hi:[0,0,1]
    ds_write_b64 v76, v[120:121] offset:4224
    v_cvt_pk_bf16_f32 v126, v132, v134
    v_pk_mul_f32 v[72:73], v[106:107], v[80:81]
    v_cvt_pk_bf16_f32 v127, v133, v135
    v_pk_mul_f32 v[74:75], v[106:107], v[78:79]
    ds_write_b64 v76, v[126:127] offset:19536
    v_pk_fma_f32 v[118:119], v[104:105], v[80:81], v[74:75]
    v_pk_mul_f32 v[128:129], v[134:135], v[84:85]
    v_pk_fma_f32 v[116:117], v[104:105], v[78:79], v[72:73] neg_lo:[0,0,1] neg_hi:[0,0,1]
    v_pk_mul_f32 v[130:131], v[134:135], v[82:83]
    v_cvt_pk_bf16_f32 v122, v116, -v118
    v_pk_fma_f32 v[134:135], v[132:133], v[84:85], v[130:131]
    v_cvt_pk_bf16_f32 v123, v117, -v119
    v_pk_fma_f32 v[132:133], v[132:133], v[82:83], v[128:129] neg_lo:[0,0,1] neg_hi:[0,0,1]
    ds_write_b64 v76, v[122:123] offset:4752
    v_cvt_pk_bf16_f32 v124, v132, v134
    v_pk_mul_f32 v[72:73], v[118:119], v[80:81]
    v_cvt_pk_bf16_f32 v125, v133, v135
    v_pk_mul_f32 v[74:75], v[118:119], v[78:79]
    ds_write_b64 v76, v[124:125] offset:20064
    v_pk_fma_f32 v[110:111], v[116:117], v[80:81], v[74:75]
    v_pk_mul_f32 v[128:129], v[134:135], v[84:85]
    v_pk_fma_f32 v[108:109], v[116:117], v[78:79], v[72:73] neg_lo:[0,0,1] neg_hi:[0,0,1]
    v_pk_mul_f32 v[130:131], v[134:135], v[82:83]
    v_cvt_pk_bf16_f32 v120, v108, -v110
    v_pk_fma_f32 v[134:135], v[132:133], v[84:85], v[130:131]
    v_cvt_pk_bf16_f32 v121, v109, -v111
    v_pk_fma_f32 v[132:133], v[132:133], v[82:83], v[128:129] neg_lo:[0,0,1] neg_hi:[0,0,1]
    ds_write_b64 v76, v[120:121] offset:5280
    v_cvt_pk_bf16_f32 v126, v132, v134
    v_pk_mul_f32 v[72:73], v[110:111], v[80:81]
    v_cvt_pk_bf16_f32 v127, v133, v135
    v_pk_mul_f32 v[74:75], v[110:111], v[78:79]
    ds_write_b64 v76, v[126:127] offset:20592
    v_pk_fma_f32 v[118:119], v[108:109], v[80:81], v[74:75]
    v_pk_mul_f32 v[128:129], v[134:135], v[84:85]
    v_pk_fma_f32 v[116:117], v[108:109], v[78:79], v[72:73] neg_lo:[0,0,1] neg_hi:[0,0,1]
    v_pk_mul_f32 v[130:131], v[134:135], v[82:83]
    v_cvt_pk_bf16_f32 v122, v116, -v118
    v_pk_fma_f32 v[134:135], v[132:133], v[84:85], v[130:131]
    v_cvt_pk_bf16_f32 v123, v117, -v119
    v_pk_fma_f32 v[132:133], v[132:133], v[82:83], v[128:129] neg_lo:[0,0,1] neg_hi:[0,0,1]
    ds_write_b64 v76, v[122:123] offset:5808
    v_cvt_pk_bf16_f32 v124, v132, v134
    v_pk_mul_f32 v[72:73], v[118:119], v[80:81]
    v_cvt_pk_bf16_f32 v125, v133, v135
    v_pk_mul_f32 v[74:75], v[118:119], v[78:79]
    ds_write_b64 v76, v[124:125] offset:21120
    v_pk_fma_f32 v[114:115], v[116:117], v[80:81], v[74:75]
    v_pk_mul_f32 v[128:129], v[134:135], v[84:85]
    v_pk_fma_f32 v[112:113], v[116:117], v[78:79], v[72:73] neg_lo:[0,0,1] neg_hi:[0,0,1]
    v_pk_mul_f32 v[130:131], v[134:135], v[82:83]
    v_cvt_pk_bf16_f32 v120, v112, -v114
    v_pk_fma_f32 v[134:135], v[132:133], v[84:85], v[130:131]
    v_cvt_pk_bf16_f32 v121, v113, -v115
    v_pk_fma_f32 v[132:133], v[132:133], v[82:83], v[128:129] neg_lo:[0,0,1] neg_hi:[0,0,1]
    ds_write_b64 v76, v[120:121] offset:8448
    v_cvt_pk_bf16_f32 v126, v132, v134
    v_pk_mul_f32 v[72:73], v[98:99], v[88:89]
    v_cvt_pk_bf16_f32 v127, v133, v135
    v_pk_mul_f32 v[74:75], v[98:99], v[86:87]
    ds_write_b64 v76, v[126:127] offset:21648
    v_pk_fma_f32 v[98:99], v[96:97], v[88:89], v[74:75]
    v_pk_mul_f32 v[128:129], v[134:135], v[84:85]
    v_pk_fma_f32 v[96:97], v[96:97], v[86:87], v[72:73] neg_lo:[0,0,1] neg_hi:[0,0,1]
    v_pk_mul_f32 v[130:131], v[134:135], v[82:83]
    v_cvt_pk_bf16_f32 v122, v96, -v98
    v_pk_fma_f32 v[134:135], v[132:133], v[84:85], v[130:131]
    v_cvt_pk_bf16_f32 v123, v97, -v99
    v_pk_fma_f32 v[132:133], v[132:133], v[82:83], v[128:129] neg_lo:[0,0,1] neg_hi:[0,0,1]
    ds_write_b64 v76, v[122:123] offset:2112
    v_cvt_pk_bf16_f32 v124, v132, v134
    ds_write_b64 v76, v[122:123] offset:2640
    v_cvt_pk_bf16_f32 v125, v133, v135
    v_pk_mul_f32 v[72:73], v[102:103], v[88:89]
    ds_write_b64 v76, v[124:125] offset:22176
    v_pk_mul_f32 v[74:75], v[102:103], v[86:87]
    v_pk_mul_f32 v[128:129], v[134:135], v[84:85]
    v_pk_fma_f32 v[102:103], v[100:101], v[88:89], v[74:75]
    v_pk_mul_f32 v[130:131], v[134:135], v[82:83]
    v_pk_fma_f32 v[100:101], v[100:101], v[86:87], v[72:73] neg_lo:[0,0,1] neg_hi:[0,0,1]
    v_pk_fma_f32 v[134:135], v[132:133], v[84:85], v[130:131]
    v_cvt_pk_bf16_f32 v120, v100, -v102
    v_pk_fma_f32 v[132:133], v[132:133], v[82:83], v[128:129] neg_lo:[0,0,1] neg_hi:[0,0,1]
    v_cvt_pk_bf16_f32 v121, v101, -v103
    v_cvt_pk_bf16_f32 v126, v132, v134
    ds_write_b64 v76, v[120:121] offset:3168
    v_cvt_pk_bf16_f32 v127, v133, v135
    v_pk_mul_f32 v[72:73], v[106:107], v[88:89]
    ds_write_b64 v76, v[126:127] offset:22704
    v_pk_mul_f32 v[74:75], v[106:107], v[86:87]
    v_pk_mul_f32 v[128:129], v[134:135], v[84:85]
    v_pk_fma_f32 v[106:107], v[104:105], v[88:89], v[74:75]
    v_pk_mul_f32 v[130:131], v[134:135], v[82:83]
    v_pk_fma_f32 v[104:105], v[104:105], v[86:87], v[72:73] neg_lo:[0,0,1] neg_hi:[0,0,1]
    v_pk_fma_f32 v[134:135], v[132:133], v[84:85], v[130:131]
    v_cvt_pk_bf16_f32 v122, v104, -v106
    v_pk_fma_f32 v[132:133], v[132:133], v[82:83], v[128:129] neg_lo:[0,0,1] neg_hi:[0,0,1]
    v_cvt_pk_bf16_f32 v123, v105, -v107
    v_cvt_pk_bf16_f32 v124, v132, v134
    ds_write_b64 v76, v[122:123] offset:3696
    v_cvt_pk_bf16_f32 v125, v133, v135
    ds_write_b64 v76, v[122:123] offset:6336
    ds_write_b64 v76, v[124:125] offset:23232
    ds_write_b64 v76, v[122:123] offset:6864
    v_pk_mul_f32 v[128:129], v[134:135], v[84:85]
    v_pk_mul_f32 v[72:73], v[110:111], v[88:89]
    v_pk_mul_f32 v[130:131], v[134:135], v[82:83]
    v_pk_mul_f32 v[74:75], v[110:111], v[86:87]
    v_pk_fma_f32 v[134:135], v[132:133], v[84:85], v[130:131]
    v_pk_fma_f32 v[110:111], v[108:109], v[88:89], v[74:75]
    v_pk_fma_f32 v[132:133], v[132:133], v[82:83], v[128:129] neg_lo:[0,0,1] neg_hi:[0,0,1]
    v_pk_fma_f32 v[108:109], v[108:109], v[86:87], v[72:73] neg_lo:[0,0,1] neg_hi:[0,0,1]
    v_cvt_pk_bf16_f32 v126, v132, v134
    v_cvt_pk_bf16_f32 v120, v108, -v110
    v_cvt_pk_bf16_f32 v127, v133, v135
    v_cvt_pk_bf16_f32 v121, v109, -v111
    ds_write_b64 v76, v[126:127] offset:23760
    ds_write_b64 v76, v[120:121] offset:7392
    v_pk_mul_f32 v[128:129], v[134:135], v[84:85]
    v_pk_mul_f32 v[72:73], v[114:115], v[88:89]
    v_pk_mul_f32 v[130:131], v[134:135], v[82:83]
    v_pk_mul_f32 v[74:75], v[114:115], v[86:87]
    v_pk_fma_f32 v[134:135], v[132:133], v[84:85], v[130:131]
    v_pk_fma_f32 v[114:115], v[112:113], v[88:89], v[74:75]
    v_pk_fma_f32 v[132:133], v[132:133], v[82:83], v[128:129] neg_lo:[0,0,1] neg_hi:[0,0,1]
    v_pk_fma_f32 v[112:113], v[112:113], v[86:87], v[72:73] neg_lo:[0,0,1] neg_hi:[0,0,1]
    v_cvt_pk_bf16_f32 v124, v132, v134
    v_cvt_pk_bf16_f32 v122, v112, -v114
    v_cvt_pk_bf16_f32 v125, v133, v135
    v_cvt_pk_bf16_f32 v123, v113, -v115
    ds_write_b64 v76, v[124:125] offset:24288
    ds_write_b64 v76, v[122:123] offset:7920
    v_pk_mul_f32 v[128:129], v[134:135], v[84:85]
    ds_write_b64 v76, v[122:123] offset:10560
    v_pk_mul_f32 v[130:131], v[134:135], v[82:83]
    v_pk_mul_f32 v[72:73], v[98:99], v[88:89]
    v_pk_fma_f32 v[134:135], v[132:133], v[84:85], v[130:131]
    v_pk_mul_f32 v[74:75], v[98:99], v[86:87]
    v_pk_fma_f32 v[132:133], v[132:133], v[82:83], v[128:129] neg_lo:[0,0,1] neg_hi:[0,0,1]
    v_pk_fma_f32 v[98:99], v[96:97], v[88:89], v[74:75]
    v_cvt_pk_bf16_f32 v126, v132, v134
    v_pk_fma_f32 v[96:97], v[96:97], v[86:87], v[72:73] neg_lo:[0,0,1] neg_hi:[0,0,1]
    v_cvt_pk_bf16_f32 v127, v133, v135
    v_cvt_pk_bf16_f32 v120, v96, -v98
    ds_write_b64 v76, v[126:127] offset:24816
    v_cvt_pk_bf16_f32 v121, v97, -v99
    v_pk_mul_f32 v[128:129], v[134:135], v[84:85]
    ds_write_b64 v76, v[120:121] offset:8976
    v_pk_mul_f32 v[130:131], v[134:135], v[82:83]
    v_pk_mul_f32 v[72:73], v[106:107], v[88:89]
    v_pk_fma_f32 v[134:135], v[132:133], v[84:85], v[130:131]
    v_pk_mul_f32 v[74:75], v[106:107], v[86:87]
    v_pk_fma_f32 v[132:133], v[132:133], v[82:83], v[128:129] neg_lo:[0,0,1] neg_hi:[0,0,1]
    v_pk_fma_f32 v[106:107], v[104:105], v[88:89], v[74:75]
    v_cvt_pk_bf16_f32 v124, v132, v134
    v_pk_fma_f32 v[104:105], v[104:105], v[86:87], v[72:73] neg_lo:[0,0,1] neg_hi:[0,0,1]
    v_cvt_pk_bf16_f32 v125, v133, v135
    v_cvt_pk_bf16_f32 v122, v104, -v106
    ds_write_b64 v76, v[124:125] offset:25344
    v_cvt_pk_bf16_f32 v123, v105, -v107
    v_pk_mul_f32 v[128:129], v[134:135], v[84:85]
    ds_write_b64 v76, v[122:123] offset:9504
    v_pk_mul_f32 v[130:131], v[134:135], v[82:83]
    v_pk_mul_f32 v[72:73], v[98:99], v[88:89]
    v_pk_fma_f32 v[134:135], v[132:133], v[84:85], v[130:131]
    v_pk_mul_f32 v[74:75], v[98:99], v[86:87]
    v_pk_fma_f32 v[132:133], v[132:133], v[82:83], v[128:129] neg_lo:[0,0,1] neg_hi:[0,0,1]
    v_pk_fma_f32 v[98:99], v[96:97], v[88:89], v[74:75]
    v_cvt_pk_bf16_f32 v126, v132, v134
    v_pk_fma_f32 v[96:97], v[96:97], v[86:87], v[72:73] neg_lo:[0,0,1] neg_hi:[0,0,1]
    v_cvt_pk_bf16_f32 v127, v133, v135
    v_cvt_pk_bf16_f32 v120, v96, -v98
    ds_write_b64 v76, v[126:127] offset:25872
    v_cvt_pk_bf16_f32 v121, v97, -v99
    v_pk_mul_f32 v[128:129], v[134:135], v[84:85]
    ds_write_b64 v76, v[120:121] offset:11088
    v_pk_mul_f32 v[130:131], v[134:135], v[82:83]
    v_pk_mul_f32 v[72:73], v[106:107], v[88:89]
    v_pk_fma_f32 v[134:135], v[132:133], v[84:85], v[130:131]
    v_pk_mul_f32 v[74:75], v[106:107], v[86:87]
    v_pk_fma_f32 v[132:133], v[132:133], v[82:83], v[128:129] neg_lo:[0,0,1] neg_hi:[0,0,1]
    v_pk_fma_f32 v[106:107], v[104:105], v[88:89], v[74:75]
    v_cvt_pk_bf16_f32 v124, v132, v134
    v_pk_fma_f32 v[104:105], v[104:105], v[86:87], v[72:73] neg_lo:[0,0,1] neg_hi:[0,0,1]
    v_cvt_pk_bf16_f32 v125, v133, v135
    v_cvt_pk_bf16_f32 v122, v104, -v106
    ds_write_b64 v76, v[124:125] offset:26400
    v_cvt_pk_bf16_f32 v123, v105, -v107
    v_pk_mul_f32 v[128:129], v[134:135], v[84:85]
    ds_write_b64 v76, v[122:123] offset:11616
    v_pk_mul_f32 v[130:131], v[134:135], v[82:83]
    v_pk_mul_f32 v[72:73], v[98:99], v[88:89]
    v_pk_fma_f32 v[134:135], v[132:133], v[84:85], v[130:131]
    v_pk_mul_f32 v[74:75], v[98:99], v[86:87]
    v_pk_fma_f32 v[132:133], v[132:133], v[82:83], v[128:129] neg_lo:[0,0,1] neg_hi:[0,0,1]
    v_pk_fma_f32 v[98:99], v[96:97], v[88:89], v[74:75]
    v_cvt_pk_bf16_f32 v126, v132, v134
    v_pk_fma_f32 v[96:97], v[96:97], v[86:87], v[72:73] neg_lo:[0,0,1] neg_hi:[0,0,1]
    v_cvt_pk_bf16_f32 v127, v133, v135
    v_cvt_pk_bf16_f32 v120, v96, -v98
    ds_write_b64 v76, v[126:127] offset:26928
    v_cvt_pk_bf16_f32 v121, v97, -v99
    v_pk_mul_f32 v[128:129], v[134:135], v[84:85]
    ds_write_b64 v76, v[120:121] offset:12672
    v_pk_mul_f32 v[130:131], v[134:135], v[82:83]
    v_pk_mul_f32 v[72:73], v[98:99], v[88:89]
    v_pk_fma_f32 v[134:135], v[132:133], v[84:85], v[130:131]
    v_pk_mul_f32 v[74:75], v[98:99], v[86:87]
    v_pk_fma_f32 v[132:133], v[132:133], v[82:83], v[128:129] neg_lo:[0,0,1] neg_hi:[0,0,1]
    v_pk_fma_f32 v[98:99], v[96:97], v[88:89], v[74:75]
    v_cvt_pk_bf16_f32 v124, v132, v134
    v_pk_fma_f32 v[96:97], v[96:97], v[86:87], v[72:73] neg_lo:[0,0,1] neg_hi:[0,0,1]
    v_cvt_pk_bf16_f32 v125, v133, v135
    v_cvt_pk_bf16_f32 v122, v96, -v98
    ds_write_b64 v76, v[124:125] offset:27456
    v_cvt_pk_bf16_f32 v123, v97, -v99
    v_pk_mul_f32 v[128:129], v[134:135], v[84:85]
    ds_write_b64 v76, v[122:123] offset:14784
    v_pk_mul_f32 v[130:131], v[134:135], v[82:83]
    v_pk_mul_f32 v[72:73], v[98:99], v[88:89]
    v_pk_fma_f32 v[134:135], v[132:133], v[84:85], v[130:131]
    v_pk_mul_f32 v[74:75], v[98:99], v[86:87]
    v_pk_fma_f32 v[132:133], v[132:133], v[82:83], v[128:129] neg_lo:[0,0,1] neg_hi:[0,0,1]
    v_pk_fma_f32 v[98:99], v[96:97], v[88:89], v[74:75]
    v_cvt_pk_bf16_f32 v126, v132, v134
    v_pk_fma_f32 v[96:97], v[96:97], v[86:87], v[72:73] neg_lo:[0,0,1] neg_hi:[0,0,1]
    v_cvt_pk_bf16_f32 v127, v133, v135
    v_cvt_pk_bf16_f32 v120, v96, -v98
    ds_write_b64 v76, v[126:127] offset:27984
    v_cvt_pk_bf16_f32 v121, v97, -v99
    v_pk_mul_f32 v[128:129], v[134:135], v[84:85]
    ds_write_b64 v76, v[120:121] offset:13728
    v_pk_mul_f32 v[130:131], v[134:135], v[82:83]
    v_pk_mul_f32 v[72:73], v[98:99], v[88:89]
    v_pk_fma_f32 v[134:135], v[132:133], v[84:85], v[130:131]
    v_pk_mul_f32 v[74:75], v[98:99], v[86:87]
    v_pk_fma_f32 v[132:133], v[132:133], v[82:83], v[128:129] neg_lo:[0,0,1] neg_hi:[0,0,1]
    v_pk_fma_f32 v[98:99], v[96:97], v[88:89], v[74:75]
    v_cvt_pk_bf16_f32 v124, v132, v134
    v_pk_fma_f32 v[96:97], v[96:97], v[86:87], v[72:73] neg_lo:[0,0,1] neg_hi:[0,0,1]
    v_cvt_pk_bf16_f32 v125, v133, v135
    v_cvt_pk_bf16_f32 v122, v96, -v98
    ds_write_b64 v76, v[124:125] offset:28512
    v_cvt_pk_bf16_f32 v123, v97, -v99
    v_pk_mul_f32 v[128:129], v[134:135], v[84:85]
    ds_write_b64 v76, v[122:123] offset:15840
    v_pk_mul_f32 v[130:131], v[134:135], v[82:83]
    v_pk_mul_f32 v[72:73], v[98:99], v[84:85]
    v_pk_fma_f32 v[134:135], v[132:133], v[84:85], v[130:131]
    v_pk_mul_f32 v[74:75], v[98:99], v[82:83]
    v_pk_fma_f32 v[132:133], v[132:133], v[82:83], v[128:129] neg_lo:[0,0,1] neg_hi:[0,0,1]
    v_pk_fma_f32 v[114:115], v[96:97], v[84:85], v[74:75]
    v_cvt_pk_bf16_f32 v126, v132, v134
    v_pk_fma_f32 v[112:113], v[96:97], v[82:83], v[72:73] neg_lo:[0,0,1] neg_hi:[0,0,1]
    v_cvt_pk_bf16_f32 v127, v133, v135
    v_cvt_pk_bf16_f32 v120, v112, -v114
    ds_write_b64 v76, v[126:127] offset:29040
    v_cvt_pk_bf16_f32 v121, v113, -v115
    v_pk_mul_f32 v[128:129], v[134:135], v[84:85]
    ds_write_b64 v76, v[120:121] offset:16368
    v_pk_mul_f32 v[130:131], v[134:135], v[82:83]
    v_pk_fma_f32 v[134:135], v[132:133], v[84:85], v[130:131]
    v_pk_fma_f32 v[132:133], v[132:133], v[82:83], v[128:129] neg_lo:[0,0,1] neg_hi:[0,0,1]
    v_cvt_pk_bf16_f32 v124, v132, v134
    v_cvt_pk_bf16_f32 v125, v133, v135
    ds_write_b64 v76, v[124:125] offset:29568
    v_pk_mul_f32 v[128:129], v[134:135], v[84:85]
    v_pk_mul_f32 v[130:131], v[134:135], v[82:83]
    v_pk_fma_f32 v[134:135], v[132:133], v[84:85], v[130:131]
    v_pk_fma_f32 v[132:133], v[132:133], v[82:83], v[128:129] neg_lo:[0,0,1] neg_hi:[0,0,1]
    v_cvt_pk_bf16_f32 v126, v132, v134
    v_cvt_pk_bf16_f32 v127, v133, v135
    ds_write_b64 v76, v[126:127] offset:30096
    v_pk_mul_f32 v[128:129], v[134:135], v[84:85]
    v_pk_mul_f32 v[130:131], v[134:135], v[82:83]
    v_pk_fma_f32 v[134:135], v[132:133], v[84:85], v[130:131]
    v_pk_fma_f32 v[132:133], v[132:133], v[82:83], v[128:129] neg_lo:[0,0,1] neg_hi:[0,0,1]
    v_cvt_pk_bf16_f32 v124, v132, v134
    v_cvt_pk_bf16_f32 v125, v133, v135
    ds_write_b64 v76, v[124:125] offset:30624
    v_pk_mul_f32 v[128:129], v[134:135], v[84:85]
    v_pk_mul_f32 v[130:131], v[134:135], v[82:83]
    v_pk_fma_f32 v[134:135], v[132:133], v[84:85], v[130:131]
    v_pk_fma_f32 v[132:133], v[132:133], v[82:83], v[128:129] neg_lo:[0,0,1] neg_hi:[0,0,1]
    v_cvt_pk_bf16_f32 v126, v132, v134
    v_cvt_pk_bf16_f32 v127, v133, v135
    ds_write_b64 v76, v[126:127] offset:31152
    v_pk_mul_f32 v[128:129], v[134:135], v[84:85]
    v_pk_mul_f32 v[130:131], v[134:135], v[82:83]
    v_pk_fma_f32 v[134:135], v[132:133], v[84:85], v[130:131]
    v_pk_fma_f32 v[132:133], v[132:133], v[82:83], v[128:129] neg_lo:[0,0,1] neg_hi:[0,0,1]
    v_cvt_pk_bf16_f32 v124, v132, v134
    v_cvt_pk_bf16_f32 v125, v133, v135
    ds_write_b64 v76, v[124:125] offset:31680
    v_pk_mul_f32 v[128:129], v[134:135], v[84:85]
    v_pk_mul_f32 v[130:131], v[134:135], v[82:83]
    v_pk_fma_f32 v[134:135], v[132:133], v[84:85], v[130:131]
    v_pk_fma_f32 v[132:133], v[132:133], v[82:83], v[128:129] neg_lo:[0,0,1] neg_hi:[0,0,1]
    v_cvt_pk_bf16_f32 v126, v132, v134
    v_cvt_pk_bf16_f32 v127, v133, v135
    ds_write_b64 v76, v[126:127] offset:32208
    v_pk_mul_f32 v[128:129], v[134:135], v[84:85]
    v_pk_mul_f32 v[130:131], v[134:135], v[82:83]
    v_pk_fma_f32 v[134:135], v[132:133], v[84:85], v[130:131]
    v_pk_fma_f32 v[132:133], v[132:133], v[82:83], v[128:129] neg_lo:[0,0,1] neg_hi:[0,0,1]
    v_cvt_pk_bf16_f32 v124, v132, v134
    v_cvt_pk_bf16_f32 v125, v133, v135
    ds_write_b64 v76, v[124:125] offset:32736
    v_pk_mul_f32 v[128:129], v[134:135], v[84:85]
    v_pk_mul_f32 v[130:131], v[134:135], v[82:83]
    v_pk_fma_f32 v[134:135], v[132:133], v[84:85], v[130:131]
    v_pk_fma_f32 v[132:133], v[132:133], v[82:83], v[128:129] neg_lo:[0,0,1] neg_hi:[0,0,1]
    v_cvt_pk_bf16_f32 v126, v132, v134
    v_cvt_pk_bf16_f32 v127, v133, v135
    ds_write_b64 v76, v[126:127] offset:33264
    s_waitcnt lgkmcnt(0)
    ds_read_b128 v[64:67], v36 offset:0
    ds_read_b128 v[68:71], v36 offset:16896
    ds_read_b128 v[72:75], v36 offset:32
    ds_read_b128 v[76:79], v36 offset:16928
    ds_read_b128 v[80:83], v36 offset:64
    ds_read_b128 v[84:87], v36 offset:16960
    ds_read_b128 v[88:91], v36 offset:96
    ds_read_b128 v[92:95], v36 offset:16992
    ds_read_b128 v[96:99], v36 offset:128
    ds_read_b128 v[100:103], v36 offset:17024
    v_lshrrev_b32 v44, 5, v1
    v_lshlrev_b32 v37, 4, v1
    v_sub_u32 v37, 1072, v37
    v_add_u32 v37, s71, v37
    v_sub_u32 v38, 1312, v1
    v_lshl_add_u32 v38, v38, 1, s71
    v_add_u32 v45, 1, v43
    v_lshrrev_b32 v45, 1, v45
    s_waitcnt lgkmcnt(8)
    v_mfma_f32_32x32x16_bf16 v[48:63], v[64:67], v[68:71], 0
    ds_read_b128 v[104:107], v36 offset:160
    ds_read_b128 v[108:111], v36 offset:17056
    v_lshl_add_u32 v45, v44, 4, v45
    v_and_b32 v43, 1, v1
    s_waitcnt lgkmcnt(8)
    v_mfma_f32_32x32x16_bf16 v[48:63], v[72:75], v[76:79], v[48:63]
    ds_read_b128 v[64:67], v36 offset:192
    ds_read_b128 v[68:71], v36 offset:17088
    v_mul_u32_u24 v43, 320, v43
    v_sub_u32 v43, v43, v45
    s_waitcnt lgkmcnt(8)
    v_mfma_f32_32x32x16_bf16 v[48:63], v[80:83], v[84:87], v[48:63]
    ds_read_b128 v[72:75], v36 offset:224
    ds_read_b128 v[76:79], v36 offset:17120
    v_add_u32 v43, 1568, v43
    v_lshl_add_u32 v39, v43, 1, s71
    s_waitcnt lgkmcnt(8)
    v_mfma_f32_32x32x16_bf16 v[48:63], v[88:91], v[92:95], v[48:63]
    ds_read_b128 v[80:83], v36 offset:256
    ds_read_b128 v[84:87], v36 offset:17152
    v_lshl_add_u32 v40, v1, 4, s71
    v_min_u32 v43, 11, v1
    s_waitcnt lgkmcnt(8)
    v_mfma_f32_32x32x16_bf16 v[48:63], v[96:99], v[100:103], v[48:63]
    ds_read_b128 v[88:91], v36 offset:288
    ds_read_b128 v[92:95], v36 offset:17184
    v_cmp_lt_u32 vcc, 5, v43
    v_mov_b32 v44, 1120
    s_waitcnt lgkmcnt(8)
    v_mfma_f32_32x32x16_bf16 v[48:63], v[104:107], v[108:111], v[48:63]
    ds_read_b128 v[96:99], v36 offset:320
    ds_read_b128 v[100:103], v36 offset:17216
    v_lshlrev_b32 v45, 4, v43
    v_cndmask_b32 v44, 0, v44, vcc
    s_waitcnt lgkmcnt(8)
    v_mfma_f32_32x32x16_bf16 v[48:63], v[64:67], v[68:71], v[48:63]
    ds_read_b128 v[104:107], v36 offset:352
    ds_read_b128 v[108:111], v36 offset:17248
    v_add_u32 v41, v44, v45
    v_cndmask_b32 v44, 0, 6, vcc
    s_waitcnt lgkmcnt(8)
    v_mfma_f32_32x32x16_bf16 v[48:63], v[72:75], v[76:79], v[48:63]
    ds_read_b128 v[64:67], v36 offset:384
    ds_read_b128 v[68:71], v36 offset:17280
    v_sub_u32 v43, v43, v44
    v_cmp_lt_u32 vcc, 3, v43
    s_waitcnt lgkmcnt(8)
    v_mfma_f32_32x32x16_bf16 v[48:63], v[80:83], v[84:87], v[48:63]
    ds_read_b128 v[72:75], v36 offset:416
    ds_read_b128 v[76:79], v36 offset:17312
    v_mov_b32 v44, 1024
    s_nop 0
    s_waitcnt lgkmcnt(8)
    v_mfma_f32_32x32x16_bf16 v[48:63], v[88:91], v[92:95], v[48:63]
    ds_read_b128 v[80:83], v36 offset:448
    ds_read_b128 v[84:87], v36 offset:17344
    v_cndmask_b32 v44, 0, v44, vcc
    v_add3_u32 v41, v41, v44, s71
    s_waitcnt lgkmcnt(8)
    v_mfma_f32_32x32x16_bf16 v[48:63], v[96:99], v[100:103], v[48:63]
    ds_read_b128 v[88:91], v36 offset:480
    ds_read_b128 v[92:95], v36 offset:17376
    s_add_u32 s4, s71, 56
    v_writelane_b32 v42, s4, 0
    s_waitcnt lgkmcnt(8)
    v_mfma_f32_32x32x16_bf16 v[48:63], v[104:107], v[108:111], v[48:63]
    s_add_u32 s4, s71, 60
    v_writelane_b32 v42, s4, 1
    s_waitcnt lgkmcnt(6)
    v_mfma_f32_32x32x16_bf16 v[48:63], v[64:67], v[68:71], v[48:63]
    s_add_u32 s4, s71, 1276
    v_writelane_b32 v42, s4, 2
    s_waitcnt lgkmcnt(4)
    v_mfma_f32_32x32x16_bf16 v[48:63], v[72:75], v[76:79], v[48:63]
    s_add_u32 s4, s71, 2304
    v_writelane_b32 v42, s4, 3
    s_waitcnt lgkmcnt(2)
    v_mfma_f32_32x32x16_bf16 v[48:63], v[80:83], v[84:87], v[48:63]
    s_add_u32 s4, s71, 3072
    v_writelane_b32 v42, s4, 4
    s_waitcnt lgkmcnt(0)
    v_mfma_f32_32x32x16_bf16 v[48:63], v[88:91], v[92:95], v[48:63]
    s_add_u32 s4, s71, 3392
    v_writelane_b32 v42, s4, 5
    v_mov_b32 v120, 0
    v_mov_b32 v121, 0
    v_mov_b32 v122, 0
    v_mov_b32 v123, 0
    ds_write_b128 v40, v[120:123] offset:2432
    ds_write_b128 v40, v[120:123] offset:3456
    ds_write_b128 v41, v[120:123]
    s_nop 4
    v_cvt_pk_bf16_f32 v124, v57, v58
    v_cvt_pk_bf16_f32 v125, v60, v62
    v_cvt_pk_bf16_f32 v126, v48, v63
    v_cvt_pk_bf16_f32 v112, v55, v54
    v_cvt_pk_bf16_f32 v113, v53, v52
    v_cvt_pk_bf16_f32 v114, v51, v50
    v_cvt_pk_bf16_f32 v115, v49, v48
    v_readlane_b32 s4, v124, 0
    v_readlane_b32 s5, v125, 0
    v_readlane_b32 s6, v126, 0
    v_readlane_b32 s7, v126, 63
    ds_write_b128 v37, v[112:115] offset:0
    v_cvt_pk_bf16_f32 v116, v56, v55
    v_cvt_pk_bf16_f32 v117, v54, v53
    v_cvt_pk_bf16_f32 v118, v52, v51
    v_cvt_pk_bf16_f32 v119, v50, v49
    ds_write_b128 v37, v[116:119] offset:1216
    s_lshl_b32 s8, s4, 16
    s_and_b32 s9, s4, 0xffff
    s_or_b32 s9, s9, s8
    s_and_b32 s4, s4, 0xffff0000
    s_and_b32 s6, s6, 0xffff
    s_lshl_b32 s10, s5, 16
    s_and_b32 s11, s5, 0xffff
    s_or_b32 s10, s10, s11
    s_and_b32 s5, s5, 0xffff0000
    s_lshr_b32 s11, s7, 16
    s_and_b32 s7, s7, 0xffff0000
    v_writelane_b32 v120, s8, 0
    v_writelane_b32 v120, s9, 1
    v_writelane_b32 v120, s9, 2
    v_writelane_b32 v120, s6, 3
    v_writelane_b32 v120, s11, 4
    v_writelane_b32 v120, s7, 5
    v_writelane_b32 v124, s4, 0
    v_writelane_b32 v125, s5, 0
    v_and_b32 v32, s10, v32
    v_and_b32 v33, s10, v33
    v_and_b32 v34, s10, v34
    v_and_b32 v35, s10, v35
    s_mov_b64 exec, 63
    ds_write_b32 v42, v120
    s_mov_b64 exec, -1
    ds_write_b16 v38, v124
    ds_write_b16_d16_hi v38, v124 offset:254
    ds_write_b16 v39, v125 offset:64
    ds_write_b16_d16_hi v39, v125 offset:0
    ds_write_b16 v39, v125 offset:386
    ds_write_b16_d16_hi v39, v125 offset:322
    ds_read2_b32 v[124:125], v7 offset0:32 offset1:33
    ds_read2_b32 v[126:127], v7 offset0:40 offset1:41
    ds_read2_b32 v[128:129], v7 offset0:16 offset1:17
    ds_read2_b32 v[130:131], v7 offset0:24 offset1:25
    ds_read2_b32 v[132:133], v7 offset0:0 offset1:1
    ds_read2_b32 v[134:135], v7 offset0:8 offset1:9
    ds_read2_b32 v[136:137], v7 offset0:96 offset1:97
    ds_read2_b32 v[138:139], v7 offset0:104 offset1:105
    ds_read2_b32 v[140:141], v7 offset0:80 offset1:81
    ds_read2_b32 v[142:143], v7 offset0:88 offset1:89
    ds_read2_b32 v[144:145], v7 offset0:64 offset1:65
    ds_read2_b32 v[146:147], v7 offset0:72 offset1:73
    s_waitcnt lgkmcnt(4)
    s_waitcnt lgkmcnt(0)
    s_barrier
    ds_read_b128 v[180:183], v5 offset:496
    ds_read_b128 v[184:187], v5 offset:752
    ds_read_b128 v[188:191], v4 offset:16
    ds_read_b128 v[192:195], v4 offset:528
    ds_read_b128 v[196:199], v5 offset:1008
    ds_read_b128 v[200:203], v5 offset:1264
    s_waitcnt lgkmcnt(5)
    v_mfma_f32_16x16x32_bf16 v[220:223], v[180:183], v[16:19], 0
    ds_read2_b32 v[148:149], v8 offset0:24 offset1:25
    v_mfma_f32_16x16x32_bf16 v[224:227], v[180:183], v[20:23], 0
    ds_read_b128 v[180:183], v5 offset:1520
    s_waitcnt lgkmcnt(6)
    v_mfma_f32_16x16x32_bf16 v[228:231], v[184:187], v[16:19], 0
    ds_read2_b32 v[150:151], v8 offset0:32 offset1:33
    v_mfma_f32_16x16x32_bf16 v[232:235], v[184:187], v[20:23], 0
    ds_read_b128 v[184:187], v5 offset:1776
    s_waitcnt lgkmcnt(7)
    v_mfma_f32_16x16x32_bf16 v[60:63], v[188:191], v[32:35], 0
    v_cvt_pk_bf16_f32 v204, v220, v221
    v_cvt_pk_bf16_f32 v205, v222, v223
    s_waitcnt lgkmcnt(6)
    v_mfma_f32_16x16x32_bf16 v[64:67], v[192:195], v[32:35], 0
    v_cvt_pk_bf16_f32 v206, v228, v229
    v_cvt_pk_bf16_f32 v207, v230, v231
    s_waitcnt lgkmcnt(5)
    v_mfma_f32_16x16x32_bf16 v[236:239], v[196:199], v[16:19], 0
    v_cvt_pk_bf16_f32 v208, v224, v225
    v_cvt_pk_bf16_f32 v209, v226, v227
    v_mfma_f32_16x16x32_bf16 v[240:243], v[196:199], v[20:23], 0
    v_cvt_pk_bf16_f32 v210, v232, v233
    v_cvt_pk_bf16_f32 v211, v234, v235
    s_waitcnt lgkmcnt(4)
    v_mfma_f32_16x16x32_bf16 v[244:247], v[200:203], v[16:19], 0
    ds_read_b128 v[188:191], v5 offset:2032
    v_mfma_f32_16x16x32_bf16 v[248:251], v[200:203], v[20:23], 0
    v_cvt_pk_bf16_f32 v212, v236, v237
    v_cvt_pk_bf16_f32 v213, v238, v239
    v_mfma_f32_16x16x32_bf16 v[56:59], v[124:127], v[204:207], 0
    v_cvt_pk_bf16_f32 v216, v240, v241
    v_cvt_pk_bf16_f32 v217, v242, v243
    v_mfma_f32_16x16x32_bf16 v[56:59], v[136:139], v[208:211], v[56:59]
    v_cvt_pk_bf16_f32 v214, v244, v245
    v_cvt_pk_bf16_f32 v215, v246, v247
    v_mfma_f32_16x16x32_bf16 v[60:63], v[128:131], v[204:207], v[60:63]
    v_cvt_pk_bf16_f32 v218, v248, v249
    v_cvt_pk_bf16_f32 v219, v250, v251
    v_mfma_f32_16x16x32_bf16 v[60:63], v[140:143], v[208:211], v[60:63]
    ds_read_b128 v[192:195], v5 offset:2288
    v_mfma_f32_16x16x32_bf16 v[64:67], v[132:135], v[204:207], v[64:67]
    ds_read_b128 v[196:199], v5 offset:2544
    v_mfma_f32_16x16x32_bf16 v[64:67], v[144:147], v[208:211], v[64:67]
    ds_read_b128 v[200:203], v5 offset:2800
    s_waitcnt lgkmcnt(6)
    v_mfma_f32_16x16x32_bf16 v[220:223], v[180:183], v[16:19], 0
    ds_read2_b32 v[164:165], v8 offset0:184 offset1:185
    v_mfma_f32_16x16x32_bf16 v[224:227], v[180:183], v[20:23], 0
    ds_read_b128 v[180:183], v5 offset:3056
    s_waitcnt lgkmcnt(6)
    v_mfma_f32_16x16x32_bf16 v[228:231], v[184:187], v[16:19], 0
    ds_read2_b32 v[166:167], v8 offset0:192 offset1:193
    v_mfma_f32_16x16x32_bf16 v[232:235], v[184:187], v[20:23], 0
    ds_read_b128 v[184:187], v5 offset:3312
    v_mfma_f32_16x16x32_bf16 v[60:63], v[124:127], v[212:215], v[60:63]
    v_cvt_pk_bf16_f32 v204, v220, v221
    v_cvt_pk_bf16_f32 v205, v222, v223
    v_mfma_f32_16x16x32_bf16 v[60:63], v[136:139], v[216:219], v[60:63]
    v_cvt_pk_bf16_f32 v208, v224, v225
    v_cvt_pk_bf16_f32 v209, v226, v227
    v_mfma_f32_16x16x32_bf16 v[64:67], v[128:131], v[212:215], v[64:67]
    v_cvt_pk_bf16_f32 v206, v228, v229
    v_cvt_pk_bf16_f32 v207, v230, v231
    v_mfma_f32_16x16x32_bf16 v[64:67], v[140:143], v[216:219], v[64:67]
    v_cvt_pk_bf16_f32 v210, v232, v233
    v_cvt_pk_bf16_f32 v211, v234, v235
    v_mfma_f32_16x16x32_bf16 v[68:71], v[132:135], v[212:215], 0
    ds_read2_b32 v[152:153], v8 offset0:16 offset1:17
    v_mfma_f32_16x16x32_bf16 v[68:71], v[144:147], v[216:219], v[68:71]
    ds_read2_b32 v[154:155], v8 offset0:24 offset1:25
    s_waitcnt lgkmcnt(9)
    v_mfma_f32_16x16x32_bf16 v[236:239], v[188:191], v[16:19], 0
    ds_read2_b32 v[168:169], v8 offset0:176 offset1:177
    v_mfma_f32_16x16x32_bf16 v[240:243], v[188:191], v[20:23], 0
    ds_read_b128 v[188:191], v4 offset:1040
    s_waitcnt lgkmcnt(10)
    v_mfma_f32_16x16x32_bf16 v[244:247], v[192:195], v[16:19], 0
    ds_read2_b32 v[170:171], v8 offset0:184 offset1:185
    v_mfma_f32_16x16x32_bf16 v[248:251], v[192:195], v[20:23], 0
    ds_read_b128 v[192:195], v4 offset:496
    v_mfma_f32_16x16x32_bf16 v[64:67], v[124:127], v[204:207], v[64:67]
    v_cvt_pk_bf16_f32 v212, v236, v237
    v_cvt_pk_bf16_f32 v213, v238, v239
    v_mfma_f32_16x16x32_bf16 v[64:67], v[136:139], v[208:211], v[64:67]
    v_cvt_pk_bf16_f32 v216, v240, v241
    v_cvt_pk_bf16_f32 v217, v242, v243
    v_mfma_f32_16x16x32_bf16 v[68:71], v[128:131], v[204:207], v[68:71]
    v_cvt_pk_bf16_f32 v214, v244, v245
    v_cvt_pk_bf16_f32 v215, v246, v247
    v_mfma_f32_16x16x32_bf16 v[68:71], v[140:143], v[208:211], v[68:71]
    v_cvt_pk_bf16_f32 v218, v248, v249
    v_cvt_pk_bf16_f32 v219, v250, v251
    v_mfma_f32_16x16x32_bf16 v[72:75], v[132:135], v[204:207], 0
    ds_read2_b32 v[156:157], v8 offset0:8 offset1:9
    v_mfma_f32_16x16x32_bf16 v[72:75], v[144:147], v[208:211], v[72:75]
    ds_read2_b32 v[158:159], v8 offset0:16 offset1:17
    s_waitcnt lgkmcnt(13)
    v_mfma_f32_16x16x32_bf16 v[220:223], v[196:199], v[16:19], 0
    ds_read2_b32 v[172:173], v8 offset0:168 offset1:169
    v_mfma_f32_16x16x32_bf16 v[224:227], v[196:199], v[20:23], 0
    ds_read_b128 v[196:199], v4 offset:512
    s_waitcnt lgkmcnt(14)
    v_mfma_f32_16x16x32_bf16 v[228:231], v[200:203], v[16:19], 0
    ds_read2_b32 v[174:175], v8 offset0:176 offset1:177
    v_mfma_f32_16x16x32_bf16 v[232:235], v[200:203], v[20:23], 0
    ds_read_b128 v[200:203], v4 offset:1008
    v_mfma_f32_16x16x32_bf16 v[68:71], v[124:127], v[212:215], v[68:71]
    v_cvt_pk_bf16_f32 v204, v220, v221
    v_cvt_pk_bf16_f32 v205, v222, v223
    v_mfma_f32_16x16x32_bf16 v[68:71], v[136:139], v[216:219], v[68:71]
    v_cvt_pk_bf16_f32 v208, v224, v225
    v_cvt_pk_bf16_f32 v209, v226, v227
    v_mfma_f32_16x16x32_bf16 v[72:75], v[128:131], v[212:215], v[72:75]
    v_cvt_pk_bf16_f32 v206, v228, v229
    v_cvt_pk_bf16_f32 v207, v230, v231
    v_mfma_f32_16x16x32_bf16 v[72:75], v[140:143], v[216:219], v[72:75]
    v_cvt_pk_bf16_f32 v210, v232, v233
    v_cvt_pk_bf16_f32 v211, v234, v235
    v_mfma_f32_16x16x32_bf16 v[76:79], v[132:135], v[212:215], 0
    ds_read2_b32 v[160:161], v8 offset0:0 offset1:1
    v_mfma_f32_16x16x32_bf16 v[76:79], v[144:147], v[216:219], v[76:79]
    ds_read2_b32 v[162:163], v8 offset0:8 offset1:9
    s_waitcnt lgkmcnt(15)
    v_mfma_f32_16x16x32_bf16 v[236:239], v[180:183], v[16:19], 0
    ds_read2_b32 v[176:177], v8 offset0:160 offset1:161
    v_mfma_f32_16x16x32_bf16 v[240:243], v[180:183], v[20:23], 0
    ds_read_b128 v[180:183], v4 offset:1024
    s_waitcnt lgkmcnt(15)
    v_mfma_f32_16x16x32_bf16 v[244:247], v[184:187], v[16:19], 0
    ds_read2_b32 v[178:179], v8 offset0:168 offset1:169
    v_mfma_f32_16x16x32_bf16 v[248:251], v[184:187], v[20:23], 0
    ds_read_b128 v[184:187], v4 offset:1552
    v_mfma_f32_16x16x32_bf16 v[72:75], v[124:127], v[204:207], v[72:75]
    v_cvt_pk_bf16_f32 v212, v236, v237
    v_cvt_pk_bf16_f32 v213, v238, v239
    v_mfma_f32_16x16x32_bf16 v[72:75], v[136:139], v[208:211], v[72:75]
    v_cvt_pk_bf16_f32 v216, v240, v241
    v_cvt_pk_bf16_f32 v217, v242, v243
    v_mfma_f32_16x16x32_bf16 v[76:79], v[128:131], v[204:207], v[76:79]
    v_cvt_pk_bf16_f32 v214, v244, v245
    v_cvt_pk_bf16_f32 v215, v246, v247
    v_mfma_f32_16x16x32_bf16 v[76:79], v[140:143], v[208:211], v[76:79]
    v_cvt_pk_bf16_f32 v218, v248, v249
    v_cvt_pk_bf16_f32 v219, v250, v251
    s_waitcnt lgkmcnt(14)
    v_mfma_f32_16x16x32_bf16 v[68:71], v[188:191], v[32:35], v[68:71]
    ds_read_b128 v[188:191], v4 offset:1520
    s_waitcnt lgkmcnt(13)
    v_mfma_f32_16x16x32_bf16 v[220:223], v[192:195], v[24:27], 0
    ds_read_b128 v[192:195], v4 offset:1536
    s_waitcnt lgkmcnt(10)
    v_mfma_f32_16x16x32_bf16 v[224:227], v[196:199], v[28:31], 0
    ds_read_b128 v[196:199], v4 offset:2032
    s_waitcnt lgkmcnt(9)
    v_mfma_f32_16x16x32_bf16 v[228:231], v[200:203], v[24:27], 0
    ds_read_b128 v[200:203], v4 offset:2048
    s_waitcnt lgkmcnt(6)
    v_mfma_f32_16x16x32_bf16 v[232:235], v[180:183], v[28:31], 0
    v_cvt_pk_bf16_f32 v204, v220, v221
    v_cvt_pk_bf16_f32 v205, v222, v223
    v_mfma_f32_16x16x32_bf16 v[76:79], v[124:127], v[212:215], v[76:79]
    v_cvt_pk_bf16_f32 v208, v224, v225
    v_cvt_pk_bf16_f32 v209, v226, v227
    v_mfma_f32_16x16x32_bf16 v[76:79], v[136:139], v[216:219], v[76:79]
    v_cvt_pk_bf16_f32 v206, v228, v229
    v_cvt_pk_bf16_f32 v207, v230, v231
    s_waitcnt lgkmcnt(4)
    v_mfma_f32_16x16x32_bf16 v[72:75], v[184:187], v[32:35], v[72:75]
    v_cvt_pk_bf16_f32 v210, v232, v233
    v_cvt_pk_bf16_f32 v211, v234, v235
    s_waitcnt lgkmcnt(3)
    v_mfma_f32_16x16x32_bf16 v[236:239], v[188:191], v[24:27], 0
    ds_read_b128 v[180:183], v4 offset:2064
    s_waitcnt lgkmcnt(3)
    v_mfma_f32_16x16x32_bf16 v[240:243], v[192:195], v[28:31], 0
    ds_read2_b32 v[112:113], v3 offset0:128 offset1:129
    s_waitcnt lgkmcnt(3)
    v_mfma_f32_16x16x32_bf16 v[244:247], v[196:199], v[24:27], 0
    ds_read2_b32 v[114:115], v3 offset0:130 offset1:131
    s_waitcnt lgkmcnt(3)
    v_mfma_f32_16x16x32_bf16 v[248:251], v[200:203], v[28:31], 0
    ds_read_b128 v[80:83], v4 offset:512
    v_cvt_pk_bf16_f32 v212, v236, v237
    v_mfma_f32_16x16x32_bf16 v[64:67], v[148:151], v[204:207], v[64:67]
    ds_read_b128 v[84:87], v4 offset:1024
    v_cvt_pk_bf16_f32 v213, v238, v239
    v_mfma_f32_16x16x32_bf16 v[64:67], v[164:167], v[208:211], v[64:67]
    ds_read2_b32 v[116:117], v3 offset0:0 offset1:1
    v_cvt_pk_bf16_f32 v214, v244, v245
    v_mfma_f32_16x16x32_bf16 v[68:71], v[152:155], v[204:207], v[68:71]
    ds_read2_b32 v[118:119], v3 offset0:2 offset1:3
    v_cvt_pk_bf16_f32 v215, v246, v247
    v_mfma_f32_16x16x32_bf16 v[68:71], v[168:171], v[208:211], v[68:71]
    v_cvt_pk_bf16_f32 v216, v240, v241
    v_cvt_pk_bf16_f32 v217, v242, v243
    v_mfma_f32_16x16x32_bf16 v[72:75], v[156:159], v[204:207], v[72:75]
    v_cvt_pk_bf16_f32 v218, v248, v249
    v_cvt_pk_bf16_f32 v219, v250, v251
    v_mfma_f32_16x16x32_bf16 v[72:75], v[172:175], v[208:211], v[72:75]
    ds_read_b128 v[88:91], v4 offset:1536
    v_mfma_f32_16x16x32_bf16 v[76:79], v[160:163], v[204:207], v[76:79]
    ds_read2_b32 v[120:121], v2 offset0:0 offset1:1
    v_mfma_f32_16x16x32_bf16 v[76:79], v[176:179], v[208:211], v[76:79]
    ds_read2_b32 v[122:123], v2 offset0:2 offset1:3
    s_waitcnt lgkmcnt(9)
    v_mfma_f32_16x16x32_bf16 v[76:79], v[180:183], v[32:35], v[76:79]
    ds_read_b128 v[92:95], v4 offset:2048
    s_waitcnt lgkmcnt(7)
    v_mfma_f32_16x16x32_bf16 v[48:51], v[80:83], v[112:115], 0
    ds_read_b128 v[96:99], v4 offset:2560
    s_waitcnt lgkmcnt(7)
    v_mfma_f32_16x16x32_bf16 v[52:55], v[84:87], v[112:115], 0
    ds_read_b128 v[100:103], v4 offset:3072
    s_waitcnt lgkmcnt(6)
    v_mfma_f32_16x16x32_bf16 v[52:55], v[80:83], v[116:119], v[52:55]
    ds_read_b128 v[104:107], v4 offset:3584
    v_mfma_f32_16x16x32_bf16 v[72:75], v[148:151], v[212:215], v[72:75]
    ds_read_b128 v[108:111], v4 offset:4096
    v_mfma_f32_16x16x32_bf16 v[72:75], v[164:167], v[216:219], v[72:75]
    ds_read2_b32 v[220:221], v3 offset0:112 offset1:113
    v_mfma_f32_16x16x32_bf16 v[76:79], v[152:155], v[212:215], v[76:79]
    ds_read2_b32 v[222:223], v3 offset0:114 offset1:115
    v_mfma_f32_16x16x32_bf16 v[76:79], v[168:171], v[216:219], v[76:79]
    ds_read_b128 v[124:127], v4 offset:448
    s_waitcnt lgkmcnt(10)
    v_mfma_f32_16x16x32_bf16 v[56:59], v[88:91], v[112:115], v[56:59]
    ds_read_b128 v[128:131], v4 offset:960
    v_mfma_f32_16x16x32_bf16 v[56:59], v[84:87], v[116:119], v[56:59]
    ds_read2_b32 v[224:225], v2 offset0:112 offset1:113
    s_waitcnt lgkmcnt(10)
    v_mfma_f32_16x16x32_bf16 v[56:59], v[80:83], v[120:123], v[56:59]
    ds_read2_b32 v[226:227], v2 offset0:114 offset1:115
    s_waitcnt lgkmcnt(10)
    v_mfma_f32_16x16x32_bf16 v[60:63], v[92:95], v[112:115], v[60:63]
    ds_read_b128 v[132:135], v4 offset:1472
    v_mfma_f32_16x16x32_bf16 v[60:63], v[88:91], v[116:119], v[60:63]
    ds_read_b128 v[136:139], v4 offset:1984
    v_mfma_f32_16x16x32_bf16 v[60:63], v[84:87], v[120:123], v[60:63]
    ds_read_b128 v[140:143], v4 offset:2496
    s_waitcnt lgkmcnt(12)
    v_mfma_f32_16x16x32_bf16 v[64:67], v[96:99], v[112:115], v[64:67]
    ds_read_b128 v[144:147], v4 offset:3008
    v_mfma_f32_16x16x32_bf16 v[64:67], v[92:95], v[116:119], v[64:67]
    ds_read_b128 v[148:151], v4 offset:3520
    v_mfma_f32_16x16x32_bf16 v[64:67], v[88:91], v[120:123], v[64:67]
    ds_read_b128 v[152:155], v4 offset:4032
    s_waitcnt lgkmcnt(14)
    v_mfma_f32_16x16x32_bf16 v[68:71], v[100:103], v[112:115], v[68:71]
    ds_read2_b32 v[228:229], v3 offset0:96 offset1:97
    v_mfma_f32_16x16x32_bf16 v[68:71], v[96:99], v[116:119], v[68:71]
    ds_read2_b32 v[230:231], v3 offset0:98 offset1:99
    v_mfma_f32_16x16x32_bf16 v[68:71], v[92:95], v[120:123], v[68:71]
    ds_read_b128 v[156:159], v4 offset:384
    s_waitcnt lgkmcnt(15)
    v_mfma_f32_16x16x32_bf16 v[72:75], v[104:107], v[112:115], v[72:75]
    ds_read_b128 v[160:163], v4 offset:896
    v_mfma_f32_16x16x32_bf16 v[72:75], v[100:103], v[116:119], v[72:75]
    ds_read2_b32 v[232:233], v2 offset0:96 offset1:97
    v_mfma_f32_16x16x32_bf16 v[72:75], v[96:99], v[120:123], v[72:75]
    ds_read2_b32 v[234:235], v2 offset0:98 offset1:99
    v_mfma_f32_16x16x32_bf16 v[76:79], v[108:111], v[112:115], v[76:79]
    ds_read_b128 v[164:167], v4 offset:1408
    v_mfma_f32_16x16x32_bf16 v[76:79], v[104:107], v[116:119], v[76:79]
    ds_read_b128 v[168:171], v4 offset:1920
    v_mfma_f32_16x16x32_bf16 v[76:79], v[100:103], v[120:123], v[76:79]
    ds_read_b128 v[172:175], v4 offset:2432
    s_waitcnt lgkmcnt(15)
    v_mfma_f32_16x16x32_bf16 v[48:51], v[124:127], v[220:223], v[48:51]
    ds_read_b128 v[176:179], v4 offset:2944
    v_mfma_f32_16x16x32_bf16 v[52:55], v[128:131], v[220:223], v[52:55]
    ds_read_b128 v[180:183], v4 offset:3456
    v_mfma_f32_16x16x32_bf16 v[52:55], v[124:127], v[224:227], v[52:55]
    ds_read_b128 v[184:187], v4 offset:3968
    s_waitcnt lgkmcnt(15)
    v_mfma_f32_16x16x32_bf16 v[56:59], v[132:135], v[220:223], v[56:59]
    ds_read2_b32 v[236:237], v3 offset0:80 offset1:81
    v_mfma_f32_16x16x32_bf16 v[56:59], v[128:131], v[224:227], v[56:59]
    ds_read2_b32 v[238:239], v3 offset0:82 offset1:83
    v_mfma_f32_16x16x32_bf16 v[60:63], v[136:139], v[220:223], v[60:63]
    ds_read_b128 v[188:191], v4 offset:320
    v_mfma_f32_16x16x32_bf16 v[60:63], v[132:135], v[224:227], v[60:63]
    ds_read_b128 v[192:195], v4 offset:832
    v_mfma_f32_16x16x32_bf16 v[64:67], v[140:143], v[220:223], v[64:67]
    ds_read2_b32 v[240:241], v2 offset0:80 offset1:81
    v_mfma_f32_16x16x32_bf16 v[64:67], v[136:139], v[224:227], v[64:67]
    ds_read2_b32 v[242:243], v2 offset0:82 offset1:83
    s_waitcnt lgkmcnt(15)
    v_mfma_f32_16x16x32_bf16 v[68:71], v[144:147], v[220:223], v[68:71]
    ds_read_b128 v[196:199], v4 offset:1344
    v_mfma_f32_16x16x32_bf16 v[68:71], v[140:143], v[224:227], v[68:71]
    ds_read_b128 v[200:203], v4 offset:1856
    v_mfma_f32_16x16x32_bf16 v[72:75], v[148:151], v[220:223], v[72:75]
    ds_read_b128 v[204:207], v4 offset:2368
    v_mfma_f32_16x16x32_bf16 v[72:75], v[144:147], v[224:227], v[72:75]
    ds_read_b128 v[208:211], v4 offset:2880
    v_mfma_f32_16x16x32_bf16 v[76:79], v[152:155], v[220:223], v[76:79]
    ds_read_b128 v[212:215], v4 offset:3392
    v_mfma_f32_16x16x32_bf16 v[76:79], v[148:151], v[224:227], v[76:79]
    ds_read_b128 v[216:219], v4 offset:3904
    v_mfma_f32_16x16x32_bf16 v[48:51], v[156:159], v[228:231], v[48:51]
    ds_read2_b32 v[112:113], v3 offset0:64 offset1:65
    s_waitcnt lgkmcnt(15)
    v_mfma_f32_16x16x32_bf16 v[52:55], v[160:163], v[228:231], v[52:55]
    ds_read2_b32 v[114:115], v3 offset0:66 offset1:67
    v_mfma_f32_16x16x32_bf16 v[52:55], v[156:159], v[232:235], v[52:55]
    ds_read_b128 v[80:83], v4 offset:256
    v_mfma_f32_16x16x32_bf16 v[56:59], v[164:167], v[228:231], v[56:59]
    ds_read_b128 v[84:87], v4 offset:768
    v_mfma_f32_16x16x32_bf16 v[56:59], v[160:163], v[232:235], v[56:59]
    ds_read2_b32 v[116:117], v2 offset0:64 offset1:65
    v_mfma_f32_16x16x32_bf16 v[60:63], v[168:171], v[228:231], v[60:63]
    ds_read2_b32 v[118:119], v2 offset0:66 offset1:67
    v_mfma_f32_16x16x32_bf16 v[60:63], v[164:167], v[232:235], v[60:63]
    ds_read_b128 v[88:91], v4 offset:1280
    v_mfma_f32_16x16x32_bf16 v[64:67], v[172:175], v[228:231], v[64:67]
    ds_read_b128 v[92:95], v4 offset:1792
    v_mfma_f32_16x16x32_bf16 v[64:67], v[168:171], v[232:235], v[64:67]
    ds_read_b128 v[96:99], v4 offset:2304
    v_mfma_f32_16x16x32_bf16 v[68:71], v[176:179], v[228:231], v[68:71]
    ds_read_b128 v[100:103], v4 offset:2816
    v_mfma_f32_16x16x32_bf16 v[68:71], v[172:175], v[232:235], v[68:71]
    ds_read_b128 v[104:107], v4 offset:3328
    s_waitcnt lgkmcnt(15)
    v_mfma_f32_16x16x32_bf16 v[72:75], v[180:183], v[228:231], v[72:75]
    ds_read_b128 v[108:111], v4 offset:3840
    v_mfma_f32_16x16x32_bf16 v[72:75], v[176:179], v[232:235], v[72:75]
    ds_read2_b32 v[220:221], v3 offset0:48 offset1:49
    v_mfma_f32_16x16x32_bf16 v[76:79], v[184:187], v[228:231], v[76:79]
    ds_read2_b32 v[222:223], v3 offset0:50 offset1:51
    v_mfma_f32_16x16x32_bf16 v[76:79], v[180:183], v[232:235], v[76:79]
    ds_read_b128 v[124:127], v4 offset:192
    v_mfma_f32_16x16x32_bf16 v[48:51], v[188:191], v[236:239], v[48:51]
    ds_read2_b32 v[228:229], v3 offset0:32 offset1:33
    v_mfma_f32_16x16x32_bf16 v[52:55], v[192:195], v[236:239], v[52:55]
    ds_read2_b32 v[230:231], v3 offset0:34 offset1:35
    v_mfma_f32_16x16x32_bf16 v[52:55], v[188:191], v[240:243], v[52:55]
    ds_read_b128 v[156:159], v4 offset:128
    v_mfma_f32_16x16x32_bf16 v[56:59], v[196:199], v[236:239], v[56:59]
    ds_read_b128 v[188:191], v4 offset:64
    v_mfma_f32_16x16x32_bf16 v[56:59], v[192:195], v[240:243], v[56:59]
    ds_read_b128 v[128:131], v4 offset:704
    v_mfma_f32_16x16x32_bf16 v[60:63], v[200:203], v[236:239], v[60:63]
    ds_read2_b32 v[224:225], v2 offset0:48 offset1:49
    v_mfma_f32_16x16x32_bf16 v[60:63], v[196:199], v[240:243], v[60:63]
    ds_read2_b32 v[226:227], v2 offset0:50 offset1:51
    s_waitcnt lgkmcnt(15)
    v_mfma_f32_16x16x32_bf16 v[64:67], v[204:207], v[236:239], v[64:67]
    ds_read_b128 v[160:163], v4 offset:640
    v_mfma_f32_16x16x32_bf16 v[64:67], v[200:203], v[240:243], v[64:67]
    ds_read2_b32 v[232:233], v2 offset0:32 offset1:33
    v_mfma_f32_16x16x32_bf16 v[68:71], v[208:211], v[236:239], v[68:71]
    ds_read2_b32 v[234:235], v2 offset0:34 offset1:35
    v_mfma_f32_16x16x32_bf16 v[68:71], v[204:207], v[240:243], v[68:71]
    ds_read_b128 v[192:195], v4 offset:576
    v_mfma_f32_16x16x32_bf16 v[72:75], v[212:215], v[236:239], v[72:75]
    ds_read_b128 v[132:135], v4 offset:1216
    v_mfma_f32_16x16x32_bf16 v[72:75], v[208:211], v[240:243], v[72:75]
    ds_read_b128 v[164:167], v4 offset:1152
    v_mfma_f32_16x16x32_bf16 v[76:79], v[216:219], v[236:239], v[76:79]
    ds_read2_b32 v[236:237], v3 offset0:16 offset1:17
    v_mfma_f32_16x16x32_bf16 v[76:79], v[212:215], v[240:243], v[76:79]
    ds_read2_b32 v[238:239], v3 offset0:18 offset1:19
    v_mfma_f32_16x16x32_bf16 v[48:51], v[80:83], v[112:115], v[48:51]
    ds_read2_b32 v[240:241], v2 offset0:16 offset1:17
    v_mfma_f32_16x16x32_bf16 v[52:55], v[84:87], v[112:115], v[52:55]
    ds_read2_b32 v[242:243], v2 offset0:18 offset1:19
    v_mfma_f32_16x16x32_bf16 v[52:55], v[80:83], v[116:119], v[52:55]
    ds_read_b128 v[196:199], v4 offset:1088
    v_mfma_f32_16x16x32_bf16 v[56:59], v[88:91], v[112:115], v[56:59]
    ds_read_b128 v[136:139], v4 offset:1728
    v_mfma_f32_16x16x32_bf16 v[56:59], v[84:87], v[116:119], v[56:59]
    ds_read_b128 v[168:171], v4 offset:1664
    s_waitcnt lgkmcnt(15)
    v_mfma_f32_16x16x32_bf16 v[60:63], v[92:95], v[112:115], v[60:63]
    ds_read_b128 v[200:203], v4 offset:1600
    v_mfma_f32_16x16x32_bf16 v[60:63], v[88:91], v[116:119], v[60:63]
    ds_read_b128 v[140:143], v4 offset:2240
    v_mfma_f32_16x16x32_bf16 v[64:67], v[96:99], v[112:115], v[64:67]
    ds_read_b128 v[172:175], v4 offset:2176
    v_mfma_f32_16x16x32_bf16 v[64:67], v[92:95], v[116:119], v[64:67]
    ds_read_b128 v[204:207], v4 offset:2112
    v_mfma_f32_16x16x32_bf16 v[68:71], v[100:103], v[112:115], v[68:71]
    ds_read_b128 v[144:147], v4 offset:2752
    v_mfma_f32_16x16x32_bf16 v[68:71], v[96:99], v[116:119], v[68:71]
    ds_read_b128 v[176:179], v4 offset:2688
    v_mfma_f32_16x16x32_bf16 v[72:75], v[104:107], v[112:115], v[72:75]
    ds_read_b128 v[208:211], v4 offset:2624
    v_mfma_f32_16x16x32_bf16 v[72:75], v[100:103], v[116:119], v[72:75]
    ds_read_b128 v[148:151], v4 offset:3264
    v_mfma_f32_16x16x32_bf16 v[76:79], v[108:111], v[112:115], v[76:79]
    ds_read_b128 v[180:183], v4 offset:3200
    v_mfma_f32_16x16x32_bf16 v[76:79], v[104:107], v[116:119], v[76:79]
    ds_read_b128 v[212:215], v4 offset:3136
    v_mfma_f32_16x16x32_bf16 v[48:51], v[124:127], v[220:223], v[48:51]
    ds_read_b128 v[152:155], v4 offset:3776
    v_mfma_f32_16x16x32_bf16 v[48:51], v[156:159], v[228:231], v[48:51]
    ds_read_b128 v[184:187], v4 offset:3712
    s_waitcnt lgkmcnt(15)
    v_mfma_f32_16x16x32_bf16 v[48:51], v[188:191], v[236:239], v[48:51]
    ds_read_b128 v[216:219], v4 offset:3648
    v_mfma_f32_16x16x32_bf16 v[52:55], v[128:131], v[220:223], v[52:55]
    v_mfma_f32_16x16x32_bf16 v[52:55], v[124:127], v[224:227], v[52:55]
    v_mfma_f32_16x16x32_bf16 v[52:55], v[160:163], v[228:231], v[52:55]
    v_mfma_f32_16x16x32_bf16 v[52:55], v[156:159], v[232:235], v[52:55]
    v_mfma_f32_16x16x32_bf16 v[52:55], v[192:195], v[236:239], v[52:55]
    v_mfma_f32_16x16x32_bf16 v[52:55], v[188:191], v[240:243], v[52:55]
    v_mfma_f32_16x16x32_bf16 v[56:59], v[132:135], v[220:223], v[56:59]
    ds_write_b32 v6, v48 offset:0
    v_mfma_f32_16x16x32_bf16 v[56:59], v[128:131], v[224:227], v[56:59]
    ds_write_b32 v6, v49 offset:64
    v_mfma_f32_16x16x32_bf16 v[56:59], v[164:167], v[228:231], v[56:59]
    ds_write_b32 v6, v50 offset:128
    v_mfma_f32_16x16x32_bf16 v[56:59], v[160:163], v[232:235], v[56:59]
    ds_write_b32 v6, v51 offset:192
    s_waitcnt lgkmcnt(15)
    v_mfma_f32_16x16x32_bf16 v[56:59], v[196:199], v[236:239], v[56:59]
    ds_write_b32 v6, v52 offset:1024
    v_mfma_f32_16x16x32_bf16 v[56:59], v[192:195], v[240:243], v[56:59]
    ds_write_b32 v6, v53 offset:1088
    v_mfma_f32_16x16x32_bf16 v[60:63], v[136:139], v[220:223], v[60:63]
    ds_write_b32 v6, v54 offset:1152
    v_mfma_f32_16x16x32_bf16 v[60:63], v[132:135], v[224:227], v[60:63]
    ds_write_b32 v6, v55 offset:1216
    v_mfma_f32_16x16x32_bf16 v[60:63], v[168:171], v[228:231], v[60:63]
    v_mfma_f32_16x16x32_bf16 v[60:63], v[164:167], v[232:235], v[60:63]
    v_mfma_f32_16x16x32_bf16 v[60:63], v[200:203], v[236:239], v[60:63]
    ds_write_b32 v6, v56 offset:2048
    v_mfma_f32_16x16x32_bf16 v[60:63], v[196:199], v[240:243], v[60:63]
    ds_write_b32 v6, v57 offset:2112
    v_mfma_f32_16x16x32_bf16 v[64:67], v[140:143], v[220:223], v[64:67]
    ds_write_b32 v6, v58 offset:2176
    v_mfma_f32_16x16x32_bf16 v[64:67], v[136:139], v[224:227], v[64:67]
    ds_write_b32 v6, v59 offset:2240
    s_waitcnt lgkmcnt(15)
    v_mfma_f32_16x16x32_bf16 v[64:67], v[172:175], v[228:231], v[64:67]
    v_mfma_f32_16x16x32_bf16 v[64:67], v[168:171], v[232:235], v[64:67]
    ds_write_b32 v6, v60 offset:3072
    v_mfma_f32_16x16x32_bf16 v[64:67], v[204:207], v[236:239], v[64:67]
    ds_write_b32 v6, v61 offset:3136
    v_mfma_f32_16x16x32_bf16 v[64:67], v[200:203], v[240:243], v[64:67]
    ds_write_b32 v6, v62 offset:3200
    v_mfma_f32_16x16x32_bf16 v[68:71], v[144:147], v[220:223], v[68:71]
    ds_write_b32 v6, v63 offset:3264
    v_mfma_f32_16x16x32_bf16 v[68:71], v[140:143], v[224:227], v[68:71]
    v_mfma_f32_16x16x32_bf16 v[68:71], v[176:179], v[228:231], v[68:71]
    v_mfma_f32_16x16x32_bf16 v[68:71], v[172:175], v[232:235], v[68:71]
    v_mfma_f32_16x16x32_bf16 v[68:71], v[208:211], v[236:239], v[68:71]
    v_mfma_f32_16x16x32_bf16 v[68:71], v[204:207], v[240:243], v[68:71]
    ds_write_b32 v6, v64 offset:4096
    v_mfma_f32_16x16x32_bf16 v[72:75], v[148:151], v[220:223], v[72:75]
    ds_write_b32 v6, v65 offset:4160
    v_mfma_f32_16x16x32_bf16 v[72:75], v[144:147], v[224:227], v[72:75]
    ds_write_b32 v6, v66 offset:4224
    v_mfma_f32_16x16x32_bf16 v[72:75], v[180:183], v[228:231], v[72:75]
    ds_write_b32 v6, v67 offset:4288
    v_mfma_f32_16x16x32_bf16 v[72:75], v[176:179], v[232:235], v[72:75]
    ds_write_b32 v6, v68 offset:5120
    v_mfma_f32_16x16x32_bf16 v[72:75], v[212:215], v[236:239], v[72:75]
    ds_write_b32 v6, v69 offset:5184
    v_mfma_f32_16x16x32_bf16 v[72:75], v[208:211], v[240:243], v[72:75]
    ds_write_b32 v6, v70 offset:5248
    s_waitcnt lgkmcnt(15)
    v_mfma_f32_16x16x32_bf16 v[76:79], v[152:155], v[220:223], v[76:79]
    ds_write_b32 v6, v71 offset:5312
    v_mfma_f32_16x16x32_bf16 v[76:79], v[148:151], v[224:227], v[76:79]
    s_waitcnt lgkmcnt(0)
    s_barrier
    v_mfma_f32_16x16x32_bf16 v[76:79], v[184:187], v[228:231], v[76:79]
    ds_write_b32 v6, v72 offset:6144
    v_mfma_f32_16x16x32_bf16 v[76:79], v[180:183], v[232:235], v[76:79]
    ds_write_b32 v6, v73 offset:6208
    v_mfma_f32_16x16x32_bf16 v[76:79], v[216:219], v[236:239], v[76:79]
    ds_write_b32 v6, v74 offset:6272
    v_mfma_f32_16x16x32_bf16 v[76:79], v[212:215], v[240:243], v[76:79]
    ds_write_b32 v6, v75 offset:6336
    s_nop 6
    ds_write_b32 v6, v76 offset:7168
    ds_write_b32 v6, v77 offset:7232
    ds_write_b32 v6, v78 offset:7296
    ds_write_b32 v6, v79 offset:7360
    s_waitcnt lgkmcnt(0)
    s_barrier
    v_mov_b32 v3, 0
    s_mov_b32 s35, 0
    s_mov_b64 exec, 1
L_gn_1:
    buffer_load_dword v2, v3, s[24:27], 0 offen sc1
    s_waitcnt vmcnt(0)
    v_readfirstlane_b32 s34, v2
    s_add_u32 s35, s35, 1
    s_sub_u32 s5, s34, s32
    s_add_u32 s5, s5, 1000
    s_cmp_ge_u32 s35, 400
    s_cselect_b32 s5, 0, s5
    s_cmp_lt_u32 s5, 2000
    s_cselect_b32 s34, s34, 0
    s_cmp_lg_u32 s34, 0
    s_cbranch_scc1 L_gn_1_ok
    s_sleep 2
    s_cmp_lt_u32 s35, 262144
    s_cbranch_scc1 L_gn_1
L_gn_1_ok:
    s_mov_b64 exec, -1
    s_bfe_u32 s4, s2, 0x20001
    s_lshl_b32 s4, s4, 2
    s_bfe_u32 s5, s2, 0x20003
    s_add_u32 s68, s4, s5
    s_and_b32 s4, s2, 1
    s_mul_i32 s4, s4, 7
    s_lshr_b32 s5, s2, 5
    s_add_u32 s69, s4, s5
    s_cmp_lt_u32 s5, 7
    s_cselect_b32 s70, 1, 0
    s_cselect_b32 s4, 0, 64
    s_sub_u32 s71, s2, s4
    s_sub_u32 s71, s71, 160
L_g1:
    v_lshrrev_b32 v248, 4, v1
    v_bfe_u32 v249, v1, 2, 2
    v_and_b32 v250, 3, v1
    v_and_b32 v251, 15, v1
    s_lshr_b32 s72, s3, 1
    s_and_b32 s73, s3, 1
    s_lshl_b32 s74, s69, 1
    s_add_u32 s74, s74, s73
    v_lshl_add_u32 v238, v248, 2, v249
    v_and_b32 v239, 7, v238
    s_lshl_b32 s4, s73, 2
    v_xor_b32 v239, s4, v239
    v_lshlrev_b32 v238, 8, v238
    v_lshl_add_u32 v238, v250, 3, v238
    v_add_u32 v238, 9216, v238
    v_xor_b32 v228, 0, v239
    v_lshl_add_u32 v228, v228, 5, v238
    v_add_u32 v232, 67584, v228
    v_xor_b32 v229, 1, v239
    v_lshl_add_u32 v229, v229, 5, v238
    v_add_u32 v233, 67584, v229
    v_xor_b32 v230, 2, v239
    v_lshl_add_u32 v230, v230, 5, v238
    v_add_u32 v234, 67584, v230
    v_xor_b32 v231, 3, v239
    v_lshl_add_u32 v231, v231, 5, v238
    v_add_u32 v235, 67584, v231
    v_mul_u32_u24 v236, 1152, v248
    s_lshl_b32 s4, s72, 9
    v_lshl_add_u32 v236, v251, 3, v236
    v_add_u32 v236, s4, v236
    v_add_u32 v237, 67584, v236
    s_lshl_b32 s4, s73, 8
    s_add_u32 s4, s4, 126976
    v_lshl_add_u32 v239, v248, 4, s4
    s_lshl_b32 s4, s72, 8
    s_add_u32 s4, s4, 128000
    v_lshl_add_u32 v240, v251, 2, s4
    v_and_b32 v238, 1, v248
    v_lshl_add_u32 v238, v238, 4, v251
    v_lshlrev_b32 v238, 4, v238
    v_lshrrev_b32 v249, 1, v248
    v_lshl_add_u32 v238, v249, 15, v238
    s_lshl_b32 s4, s74, 18
    s_lshl_b32 s5, s68, 11
    s_add_u32 s4, s4, s5
    s_lshl_b32 s5, s72, 10
    s_add_u32 s4, s4, s5
    s_add_u32 s12, s4, 4194304
    s_add_u32 s13, s12, 65536
    s_add_u32 s14, s12, 131072
    s_add_u32 s15, s12, 196608
    s_mov_b64 exec, 0
    s_cmp_eq_u32 s3, 0
    s_cbranch_scc1 L_wg1_0_0
    s_cmp_eq_u32 s3, 1
    s_cbranch_scc1 L_wg1_1_0
    s_cmp_eq_u32 s3, 2
    s_cbranch_scc1 L_wg1_2_0
    s_branch L_wg1_3_0
L_wretg1:
    s_mov_b64 exec, -1
    s_cmp_eq_u32 s74, 27
    s_cbranch_scc1 L_g1idle
    s_barrier
    ds_read_b64 v[196:197], v236 offset:0
    ds_read_b64 v[198:199], v236 offset:4608
    ds_read_b64_tr_b16 v[132:133], v228 offset:0
    ds_read_b64_tr_b16 v[134:135], v228 offset:4096
    ds_read_b64 v[200:201], v236 offset:128
    ds_read_b64 v[202:203], v236 offset:4736
    ds_read_b64 v[204:205], v236 offset:256
    ds_read_b64 v[206:207], v236 offset:4864
    ds_read_b64 v[208:209], v236 offset:384
    ds_read_b64 v[210:211], v236 offset:4992
    ds_read_b64_tr_b16 v[148:149], v228 offset:8192
    ds_read_b64_tr_b16 v[150:151], v228 offset:12288
    ds_read_b64_tr_b16 v[136:137], v229 offset:0
    ds_read_b64_tr_b16 v[138:139], v229 offset:4096
    ds_read_b64_tr_b16 v[152:153], v229 offset:8192
    ds_read_b64_tr_b16 v[154:155], v229 offset:12288
    ds_read_b64_tr_b16 v[140:141], v230 offset:0
    ds_read_b64_tr_b16 v[142:143], v230 offset:4096
    ds_read_b64_tr_b16 v[156:157], v230 offset:8192
    ds_read_b64_tr_b16 v[158:159], v230 offset:12288
    ds_read_b64_tr_b16 v[144:145], v231 offset:0
    ds_read_b64_tr_b16 v[146:147], v231 offset:4096
    ds_read_b64_tr_b16 v[160:161], v231 offset:8192
    ds_read_b64_tr_b16 v[162:163], v231 offset:12288
    s_waitcnt lgkmcnt(14)
    v_mfma_f32_16x16x32_bf16 v[4:7], v[132:135], v[196:199], 0
    v_mfma_f32_16x16x32_bf16 v[8:11], v[132:135], v[200:203], 0
    v_mfma_f32_16x16x32_bf16 v[12:15], v[132:135], v[204:207], 0
    v_mfma_f32_16x16x32_bf16 v[16:19], v[132:135], v[208:211], 0
    s_waitcnt lgkmcnt(0)
    v_mfma_f32_16x16x32_bf16 v[80:83], v[148:151], v[208:211], 0
    v_mfma_f32_16x16x32_bf16 v[76:79], v[148:151], v[204:207], 0
    v_mfma_f32_16x16x32_bf16 v[72:75], v[148:151], v[200:203], 0
    s_barrier
    v_mfma_f32_16x16x32_bf16 v[68:71], v[148:151], v[196:199], 0
    ds_read_b64 v[212:213], v236 offset:33792
    v_mfma_f32_16x16x32_bf16 v[20:23], v[136:139], v[196:199], 0
    ds_read_b64 v[214:215], v236 offset:38400
    v_mfma_f32_16x16x32_bf16 v[24:27], v[136:139], v[200:203], 0
    ds_read_b64_tr_b16 v[164:165], v228 offset:33792
    v_mfma_f32_16x16x32_bf16 v[28:31], v[136:139], v[204:207], 0
    ds_read_b64_tr_b16 v[166:167], v228 offset:37888
    v_mfma_f32_16x16x32_bf16 v[32:35], v[136:139], v[208:211], 0
    ds_read_b64 v[216:217], v236 offset:33920
    v_mfma_f32_16x16x32_bf16 v[96:99], v[152:155], v[208:211], 0
    ds_read_b64 v[218:219], v236 offset:38528
    v_mfma_f32_16x16x32_bf16 v[92:95], v[152:155], v[204:207], 0
    ds_read_b64 v[220:221], v236 offset:34048
    v_mfma_f32_16x16x32_bf16 v[88:91], v[152:155], v[200:203], 0
    ds_read_b64 v[222:223], v236 offset:38656
    v_mfma_f32_16x16x32_bf16 v[84:87], v[152:155], v[196:199], 0
    ds_read_b64 v[224:225], v236 offset:34176
    v_mfma_f32_16x16x32_bf16 v[36:39], v[140:143], v[196:199], 0
    ds_read_b64 v[226:227], v236 offset:38784
    v_mfma_f32_16x16x32_bf16 v[40:43], v[140:143], v[200:203], 0
    ds_read_b64_tr_b16 v[180:181], v228 offset:41984
    v_mfma_f32_16x16x32_bf16 v[44:47], v[140:143], v[204:207], 0
    ds_read_b64_tr_b16 v[182:183], v228 offset:46080
    v_mfma_f32_16x16x32_bf16 v[48:51], v[140:143], v[208:211], 0
    ds_read_b64_tr_b16 v[168:169], v229 offset:33792
    v_mfma_f32_16x16x32_bf16 v[112:115], v[156:159], v[208:211], 0
    ds_read_b64_tr_b16 v[170:171], v229 offset:37888
    v_mfma_f32_16x16x32_bf16 v[108:111], v[156:159], v[204:207], 0
    ds_read_b64_tr_b16 v[184:185], v229 offset:41984
    v_mfma_f32_16x16x32_bf16 v[104:107], v[156:159], v[200:203], 0
    ds_read_b64_tr_b16 v[186:187], v229 offset:46080
    v_mfma_f32_16x16x32_bf16 v[100:103], v[156:159], v[196:199], 0
    ds_read_b64_tr_b16 v[172:173], v230 offset:33792
    v_mfma_f32_16x16x32_bf16 v[52:55], v[144:147], v[196:199], 0
    ds_read_b64_tr_b16 v[174:175], v230 offset:37888
    v_mfma_f32_16x16x32_bf16 v[56:59], v[144:147], v[200:203], 0
    ds_read_b64_tr_b16 v[188:189], v230 offset:41984
    v_mfma_f32_16x16x32_bf16 v[60:63], v[144:147], v[204:207], 0
    ds_read_b64_tr_b16 v[190:191], v230 offset:46080
    v_mfma_f32_16x16x32_bf16 v[64:67], v[144:147], v[208:211], 0
    ds_read_b64_tr_b16 v[176:177], v231 offset:33792
    v_mfma_f32_16x16x32_bf16 v[128:131], v[160:163], v[208:211], 0
    ds_read_b64_tr_b16 v[178:179], v231 offset:37888
    v_mfma_f32_16x16x32_bf16 v[124:127], v[160:163], v[204:207], 0
    ds_read_b64_tr_b16 v[192:193], v231 offset:41984
    v_mfma_f32_16x16x32_bf16 v[120:123], v[160:163], v[200:203], 0
    ds_read_b64_tr_b16 v[194:195], v231 offset:46080
    v_mfma_f32_16x16x32_bf16 v[116:119], v[160:163], v[196:199], 0
    s_waitcnt lgkmcnt(14)
    v_mfma_f32_16x16x32_bf16 v[4:7], v[164:167], v[212:215], v[4:7]
    v_mfma_f32_16x16x32_bf16 v[8:11], v[164:167], v[216:219], v[8:11]
    v_mfma_f32_16x16x32_bf16 v[12:15], v[164:167], v[220:223], v[12:15]
    v_mfma_f32_16x16x32_bf16 v[16:19], v[164:167], v[224:227], v[16:19]
    s_waitcnt lgkmcnt(0)
    v_mfma_f32_16x16x32_bf16 v[80:83], v[180:183], v[224:227], v[80:83]
    v_mfma_f32_16x16x32_bf16 v[76:79], v[180:183], v[220:223], v[76:79]
    v_mfma_f32_16x16x32_bf16 v[72:75], v[180:183], v[216:219], v[72:75]
    s_barrier
    v_mfma_f32_16x16x32_bf16 v[68:71], v[180:183], v[212:215], v[68:71]
    ds_read_b64 v[196:197], v237 offset:0
    v_mfma_f32_16x16x32_bf16 v[20:23], v[168:171], v[212:215], v[20:23]
    ds_read_b64 v[198:199], v237 offset:4608
    v_mfma_f32_16x16x32_bf16 v[24:27], v[168:171], v[216:219], v[24:27]
    ds_read_b64_tr_b16 v[132:133], v232 offset:0
    v_mfma_f32_16x16x32_bf16 v[28:31], v[168:171], v[220:223], v[28:31]
    ds_read_b64_tr_b16 v[134:135], v232 offset:4096
    v_mfma_f32_16x16x32_bf16 v[32:35], v[168:171], v[224:227], v[32:35]
    ds_read_b64 v[200:201], v237 offset:128
    v_mfma_f32_16x16x32_bf16 v[96:99], v[184:187], v[224:227], v[96:99]
    ds_read_b64 v[202:203], v237 offset:4736
    v_mfma_f32_16x16x32_bf16 v[92:95], v[184:187], v[220:223], v[92:95]
    ds_read_b64 v[204:205], v237 offset:256
    v_mfma_f32_16x16x32_bf16 v[88:91], v[184:187], v[216:219], v[88:91]
    ds_read_b64 v[206:207], v237 offset:4864
    v_mfma_f32_16x16x32_bf16 v[84:87], v[184:187], v[212:215], v[84:87]
    ds_read_b64 v[208:209], v237 offset:384
    v_mfma_f32_16x16x32_bf16 v[36:39], v[172:175], v[212:215], v[36:39]
    ds_read_b64 v[210:211], v237 offset:4992
    v_mfma_f32_16x16x32_bf16 v[40:43], v[172:175], v[216:219], v[40:43]
    ds_read_b64_tr_b16 v[148:149], v232 offset:8192
    v_mfma_f32_16x16x32_bf16 v[44:47], v[172:175], v[220:223], v[44:47]
    ds_read_b64_tr_b16 v[150:151], v232 offset:12288
    v_mfma_f32_16x16x32_bf16 v[48:51], v[172:175], v[224:227], v[48:51]
    ds_read_b64_tr_b16 v[136:137], v233 offset:0
    v_mfma_f32_16x16x32_bf16 v[112:115], v[188:191], v[224:227], v[112:115]
    ds_read_b64_tr_b16 v[138:139], v233 offset:4096
    v_mfma_f32_16x16x32_bf16 v[108:111], v[188:191], v[220:223], v[108:111]
    ds_read_b64_tr_b16 v[152:153], v233 offset:8192
    v_mfma_f32_16x16x32_bf16 v[104:107], v[188:191], v[216:219], v[104:107]
    ds_read_b64_tr_b16 v[154:155], v233 offset:12288
    v_mfma_f32_16x16x32_bf16 v[100:103], v[188:191], v[212:215], v[100:103]
    ds_read_b64_tr_b16 v[140:141], v234 offset:0
    v_mfma_f32_16x16x32_bf16 v[52:55], v[176:179], v[212:215], v[52:55]
    ds_read_b64_tr_b16 v[142:143], v234 offset:4096
    v_mfma_f32_16x16x32_bf16 v[56:59], v[176:179], v[216:219], v[56:59]
    ds_read_b64_tr_b16 v[156:157], v234 offset:8192
    v_mfma_f32_16x16x32_bf16 v[60:63], v[176:179], v[220:223], v[60:63]
    ds_read_b64_tr_b16 v[158:159], v234 offset:12288
    v_mfma_f32_16x16x32_bf16 v[64:67], v[176:179], v[224:227], v[64:67]
    ds_read_b64_tr_b16 v[144:145], v235 offset:0
    v_mfma_f32_16x16x32_bf16 v[128:131], v[192:195], v[224:227], v[128:131]
    ds_read_b64_tr_b16 v[146:147], v235 offset:4096
    v_mfma_f32_16x16x32_bf16 v[124:127], v[192:195], v[220:223], v[124:127]
    ds_read_b64_tr_b16 v[160:161], v235 offset:8192
    v_mfma_f32_16x16x32_bf16 v[120:123], v[192:195], v[216:219], v[120:123]
    ds_read_b64_tr_b16 v[162:163], v235 offset:12288
    v_mfma_f32_16x16x32_bf16 v[116:119], v[192:195], v[212:215], v[116:119]
    s_waitcnt lgkmcnt(14)
    v_mfma_f32_16x16x32_bf16 v[4:7], v[132:135], v[196:199], v[4:7]
    v_mfma_f32_16x16x32_bf16 v[8:11], v[132:135], v[200:203], v[8:11]
    v_mfma_f32_16x16x32_bf16 v[12:15], v[132:135], v[204:207], v[12:15]
    v_mfma_f32_16x16x32_bf16 v[16:19], v[132:135], v[208:211], v[16:19]
    s_waitcnt lgkmcnt(0)
    v_mfma_f32_16x16x32_bf16 v[80:83], v[148:151], v[208:211], v[80:83]
    v_mfma_f32_16x16x32_bf16 v[76:79], v[148:151], v[204:207], v[76:79]
    v_mfma_f32_16x16x32_bf16 v[72:75], v[148:151], v[200:203], v[72:75]
    s_barrier
    v_mfma_f32_16x16x32_bf16 v[68:71], v[148:151], v[196:199], v[68:71]
    ds_read_b64 v[212:213], v237 offset:33792
    v_mfma_f32_16x16x32_bf16 v[20:23], v[136:139], v[196:199], v[20:23]
    ds_read_b64 v[214:215], v237 offset:38400
    v_mfma_f32_16x16x32_bf16 v[24:27], v[136:139], v[200:203], v[24:27]
    ds_read_b64_tr_b16 v[164:165], v232 offset:33792
    v_mfma_f32_16x16x32_bf16 v[28:31], v[136:139], v[204:207], v[28:31]
    ds_read_b64_tr_b16 v[166:167], v232 offset:37888
    v_mfma_f32_16x16x32_bf16 v[32:35], v[136:139], v[208:211], v[32:35]
    ds_read_b64 v[216:217], v237 offset:33920
    v_mfma_f32_16x16x32_bf16 v[96:99], v[152:155], v[208:211], v[96:99]
    ds_read_b64 v[218:219], v237 offset:38528
    v_mfma_f32_16x16x32_bf16 v[92:95], v[152:155], v[204:207], v[92:95]
    ds_read_b64 v[220:221], v237 offset:34048
    v_mfma_f32_16x16x32_bf16 v[88:91], v[152:155], v[200:203], v[88:91]
    ds_read_b64 v[222:223], v237 offset:38656
    v_mfma_f32_16x16x32_bf16 v[84:87], v[152:155], v[196:199], v[84:87]
    ds_read_b64 v[224:225], v237 offset:34176
    v_mfma_f32_16x16x32_bf16 v[36:39], v[140:143], v[196:199], v[36:39]
    ds_read_b64 v[226:227], v237 offset:38784
    v_mfma_f32_16x16x32_bf16 v[40:43], v[140:143], v[200:203], v[40:43]
    ds_read_b64_tr_b16 v[180:181], v232 offset:41984
    v_mfma_f32_16x16x32_bf16 v[44:47], v[140:143], v[204:207], v[44:47]
    ds_read_b64_tr_b16 v[182:183], v232 offset:46080
    v_mfma_f32_16x16x32_bf16 v[48:51], v[140:143], v[208:211], v[48:51]
    ds_read_b64_tr_b16 v[168:169], v233 offset:33792
    v_mfma_f32_16x16x32_bf16 v[112:115], v[156:159], v[208:211], v[112:115]
    ds_read_b64_tr_b16 v[170:171], v233 offset:37888
    v_mfma_f32_16x16x32_bf16 v[108:111], v[156:159], v[204:207], v[108:111]
    ds_read_b64_tr_b16 v[184:185], v233 offset:41984
    v_mfma_f32_16x16x32_bf16 v[104:107], v[156:159], v[200:203], v[104:107]
    ds_read_b64_tr_b16 v[186:187], v233 offset:46080
    v_mfma_f32_16x16x32_bf16 v[100:103], v[156:159], v[196:199], v[100:103]
    ds_read_b64_tr_b16 v[172:173], v234 offset:33792
    v_mfma_f32_16x16x32_bf16 v[52:55], v[144:147], v[196:199], v[52:55]
    ds_read_b64_tr_b16 v[174:175], v234 offset:37888
    v_mfma_f32_16x16x32_bf16 v[56:59], v[144:147], v[200:203], v[56:59]
    ds_read_b64_tr_b16 v[188:189], v234 offset:41984
    v_mfma_f32_16x16x32_bf16 v[60:63], v[144:147], v[204:207], v[60:63]
    ds_read_b64_tr_b16 v[190:191], v234 offset:46080
    v_mfma_f32_16x16x32_bf16 v[64:67], v[144:147], v[208:211], v[64:67]
    ds_read_b64_tr_b16 v[176:177], v235 offset:33792
    v_mfma_f32_16x16x32_bf16 v[128:131], v[160:163], v[208:211], v[128:131]
    ds_read_b64_tr_b16 v[178:179], v235 offset:37888
    v_mfma_f32_16x16x32_bf16 v[124:127], v[160:163], v[204:207], v[124:127]
    ds_read_b64_tr_b16 v[192:193], v235 offset:41984
    v_mfma_f32_16x16x32_bf16 v[120:123], v[160:163], v[200:203], v[120:123]
    ds_read_b64_tr_b16 v[194:195], v235 offset:46080
    v_mfma_f32_16x16x32_bf16 v[116:119], v[160:163], v[196:199], v[116:119]
    s_waitcnt lgkmcnt(14)
    v_mfma_f32_16x16x32_bf16 v[4:7], v[164:167], v[212:215], v[4:7]
    v_mfma_f32_16x16x32_bf16 v[8:11], v[164:167], v[216:219], v[8:11]
    v_mfma_f32_16x16x32_bf16 v[12:15], v[164:167], v[220:223], v[12:15]
    v_mfma_f32_16x16x32_bf16 v[16:19], v[164:167], v[224:227], v[16:19]
    s_waitcnt lgkmcnt(0)
    v_mfma_f32_16x16x32_bf16 v[80:83], v[180:183], v[224:227], v[80:83]
    v_mfma_f32_16x16x32_bf16 v[76:79], v[180:183], v[220:223], v[76:79]
    v_mfma_f32_16x16x32_bf16 v[72:75], v[180:183], v[216:219], v[72:75]
    s_barrier
    v_mfma_f32_16x16x32_bf16 v[68:71], v[180:183], v[212:215], v[68:71]
    ds_read_b64 v[196:197], v236 offset:0
    v_mfma_f32_16x16x32_bf16 v[20:23], v[168:171], v[212:215], v[20:23]
    ds_read_b64 v[198:199], v236 offset:4608
    v_mfma_f32_16x16x32_bf16 v[24:27], v[168:171], v[216:219], v[24:27]
    ds_read_b64_tr_b16 v[132:133], v228 offset:0
    v_mfma_f32_16x16x32_bf16 v[28:31], v[168:171], v[220:223], v[28:31]
    ds_read_b64_tr_b16 v[134:135], v228 offset:4096
    v_mfma_f32_16x16x32_bf16 v[32:35], v[168:171], v[224:227], v[32:35]
    ds_read_b64 v[200:201], v236 offset:128
    v_mfma_f32_16x16x32_bf16 v[96:99], v[184:187], v[224:227], v[96:99]
    ds_read_b64 v[202:203], v236 offset:4736
    v_mfma_f32_16x16x32_bf16 v[92:95], v[184:187], v[220:223], v[92:95]
    ds_read_b64 v[204:205], v236 offset:256
    v_mfma_f32_16x16x32_bf16 v[88:91], v[184:187], v[216:219], v[88:91]
    ds_read_b64 v[206:207], v236 offset:4864
    v_mfma_f32_16x16x32_bf16 v[84:87], v[184:187], v[212:215], v[84:87]
    ds_read_b64 v[208:209], v236 offset:384
    v_mfma_f32_16x16x32_bf16 v[36:39], v[172:175], v[212:215], v[36:39]
    ds_read_b64 v[210:211], v236 offset:4992
    v_mfma_f32_16x16x32_bf16 v[40:43], v[172:175], v[216:219], v[40:43]
    ds_read_b64_tr_b16 v[148:149], v228 offset:8192
    v_mfma_f32_16x16x32_bf16 v[44:47], v[172:175], v[220:223], v[44:47]
    ds_read_b64_tr_b16 v[150:151], v228 offset:12288
    v_mfma_f32_16x16x32_bf16 v[48:51], v[172:175], v[224:227], v[48:51]
    ds_read_b64_tr_b16 v[136:137], v229 offset:0
    v_mfma_f32_16x16x32_bf16 v[112:115], v[188:191], v[224:227], v[112:115]
    ds_read_b64_tr_b16 v[138:139], v229 offset:4096
    v_mfma_f32_16x16x32_bf16 v[108:111], v[188:191], v[220:223], v[108:111]
    ds_read_b64_tr_b16 v[152:153], v229 offset:8192
    v_mfma_f32_16x16x32_bf16 v[104:107], v[188:191], v[216:219], v[104:107]
    ds_read_b64_tr_b16 v[154:155], v229 offset:12288
    v_mfma_f32_16x16x32_bf16 v[100:103], v[188:191], v[212:215], v[100:103]
    ds_read_b64_tr_b16 v[140:141], v230 offset:0
    v_mfma_f32_16x16x32_bf16 v[52:55], v[176:179], v[212:215], v[52:55]
    ds_read_b64_tr_b16 v[142:143], v230 offset:4096
    v_mfma_f32_16x16x32_bf16 v[56:59], v[176:179], v[216:219], v[56:59]
    ds_read_b64_tr_b16 v[156:157], v230 offset:8192
    v_mfma_f32_16x16x32_bf16 v[60:63], v[176:179], v[220:223], v[60:63]
    ds_read_b64_tr_b16 v[158:159], v230 offset:12288
    v_mfma_f32_16x16x32_bf16 v[64:67], v[176:179], v[224:227], v[64:67]
    ds_read_b64_tr_b16 v[144:145], v231 offset:0
    v_mfma_f32_16x16x32_bf16 v[128:131], v[192:195], v[224:227], v[128:131]
    ds_read_b64_tr_b16 v[146:147], v231 offset:4096
    v_mfma_f32_16x16x32_bf16 v[124:127], v[192:195], v[220:223], v[124:127]
    ds_read_b64_tr_b16 v[160:161], v231 offset:8192
    v_mfma_f32_16x16x32_bf16 v[120:123], v[192:195], v[216:219], v[120:123]
    ds_read_b64_tr_b16 v[162:163], v231 offset:12288
    v_mfma_f32_16x16x32_bf16 v[116:119], v[192:195], v[212:215], v[116:119]
    s_waitcnt lgkmcnt(14)
    v_mfma_f32_16x16x32_bf16 v[4:7], v[132:135], v[196:199], v[4:7]
    v_mfma_f32_16x16x32_bf16 v[8:11], v[132:135], v[200:203], v[8:11]
    v_mfma_f32_16x16x32_bf16 v[12:15], v[132:135], v[204:207], v[12:15]
    v_mfma_f32_16x16x32_bf16 v[16:19], v[132:135], v[208:211], v[16:19]
    s_waitcnt lgkmcnt(0)
    v_mfma_f32_16x16x32_bf16 v[80:83], v[148:151], v[208:211], v[80:83]
    v_mfma_f32_16x16x32_bf16 v[76:79], v[148:151], v[204:207], v[76:79]
    v_mfma_f32_16x16x32_bf16 v[72:75], v[148:151], v[200:203], v[72:75]
    s_barrier
    v_mfma_f32_16x16x32_bf16 v[68:71], v[148:151], v[196:199], v[68:71]
    ds_read_b64 v[212:213], v236 offset:33792
    v_mfma_f32_16x16x32_bf16 v[20:23], v[136:139], v[196:199], v[20:23]
    ds_read_b64 v[214:215], v236 offset:38400
    v_mfma_f32_16x16x32_bf16 v[24:27], v[136:139], v[200:203], v[24:27]
    ds_read_b64_tr_b16 v[164:165], v228 offset:33792
    v_mfma_f32_16x16x32_bf16 v[28:31], v[136:139], v[204:207], v[28:31]
    ds_read_b64_tr_b16 v[166:167], v228 offset:37888
    v_mfma_f32_16x16x32_bf16 v[32:35], v[136:139], v[208:211], v[32:35]
    ds_read_b64 v[216:217], v236 offset:33920
    v_mfma_f32_16x16x32_bf16 v[96:99], v[152:155], v[208:211], v[96:99]
    ds_read_b64 v[218:219], v236 offset:38528
    v_mfma_f32_16x16x32_bf16 v[92:95], v[152:155], v[204:207], v[92:95]
    ds_read_b64 v[220:221], v236 offset:34048
    v_mfma_f32_16x16x32_bf16 v[88:91], v[152:155], v[200:203], v[88:91]
    ds_read_b64 v[222:223], v236 offset:38656
    v_mfma_f32_16x16x32_bf16 v[84:87], v[152:155], v[196:199], v[84:87]
    ds_read_b64 v[224:225], v236 offset:34176
    v_mfma_f32_16x16x32_bf16 v[36:39], v[140:143], v[196:199], v[36:39]
    ds_read_b64 v[226:227], v236 offset:38784
    v_mfma_f32_16x16x32_bf16 v[40:43], v[140:143], v[200:203], v[40:43]
    ds_read_b64_tr_b16 v[180:181], v228 offset:41984
    v_mfma_f32_16x16x32_bf16 v[44:47], v[140:143], v[204:207], v[44:47]
    ds_read_b64_tr_b16 v[182:183], v228 offset:46080
    v_mfma_f32_16x16x32_bf16 v[48:51], v[140:143], v[208:211], v[48:51]
    ds_read_b64_tr_b16 v[168:169], v229 offset:33792
    v_mfma_f32_16x16x32_bf16 v[112:115], v[156:159], v[208:211], v[112:115]
    ds_read_b64_tr_b16 v[170:171], v229 offset:37888
    v_mfma_f32_16x16x32_bf16 v[108:111], v[156:159], v[204:207], v[108:111]
    ds_read_b64_tr_b16 v[184:185], v229 offset:41984
    v_mfma_f32_16x16x32_bf16 v[104:107], v[156:159], v[200:203], v[104:107]
    ds_read_b64_tr_b16 v[186:187], v229 offset:46080
    v_mfma_f32_16x16x32_bf16 v[100:103], v[156:159], v[196:199], v[100:103]
    ds_read_b64_tr_b16 v[172:173], v230 offset:33792
    v_mfma_f32_16x16x32_bf16 v[52:55], v[144:147], v[196:199], v[52:55]
    ds_read_b64_tr_b16 v[174:175], v230 offset:37888
    v_mfma_f32_16x16x32_bf16 v[56:59], v[144:147], v[200:203], v[56:59]
    ds_read_b64_tr_b16 v[188:189], v230 offset:41984
    v_mfma_f32_16x16x32_bf16 v[60:63], v[144:147], v[204:207], v[60:63]
    ds_read_b64_tr_b16 v[190:191], v230 offset:46080
    v_mfma_f32_16x16x32_bf16 v[64:67], v[144:147], v[208:211], v[64:67]
    ds_read_b64_tr_b16 v[176:177], v231 offset:33792
    v_mfma_f32_16x16x32_bf16 v[128:131], v[160:163], v[208:211], v[128:131]
    ds_read_b64_tr_b16 v[178:179], v231 offset:37888
    v_mfma_f32_16x16x32_bf16 v[124:127], v[160:163], v[204:207], v[124:127]
    ds_read_b64_tr_b16 v[192:193], v231 offset:41984
    v_mfma_f32_16x16x32_bf16 v[120:123], v[160:163], v[200:203], v[120:123]
    ds_read_b64_tr_b16 v[194:195], v231 offset:46080
    v_mfma_f32_16x16x32_bf16 v[116:119], v[160:163], v[196:199], v[116:119]
    s_waitcnt lgkmcnt(14)
    v_mfma_f32_16x16x32_bf16 v[4:7], v[164:167], v[212:215], v[4:7]
    v_mfma_f32_16x16x32_bf16 v[8:11], v[164:167], v[216:219], v[8:11]
    v_mfma_f32_16x16x32_bf16 v[12:15], v[164:167], v[220:223], v[12:15]
    v_mfma_f32_16x16x32_bf16 v[16:19], v[164:167], v[224:227], v[16:19]
    s_waitcnt lgkmcnt(0)
    v_mfma_f32_16x16x32_bf16 v[80:83], v[180:183], v[224:227], v[80:83]
    v_mfma_f32_16x16x32_bf16 v[76:79], v[180:183], v[220:223], v[76:79]
    v_mfma_f32_16x16x32_bf16 v[72:75], v[180:183], v[216:219], v[72:75]
    s_barrier
    v_mfma_f32_16x16x32_bf16 v[68:71], v[180:183], v[212:215], v[68:71]
    ds_read_b64 v[196:197], v237 offset:0
    v_mfma_f32_16x16x32_bf16 v[20:23], v[168:171], v[212:215], v[20:23]
    ds_read_b64 v[198:199], v237 offset:4608
    v_mfma_f32_16x16x32_bf16 v[24:27], v[168:171], v[216:219], v[24:27]
    ds_read_b64_tr_b16 v[132:133], v232 offset:0
    v_mfma_f32_16x16x32_bf16 v[28:31], v[168:171], v[220:223], v[28:31]
    ds_read_b64_tr_b16 v[134:135], v232 offset:4096
    v_mfma_f32_16x16x32_bf16 v[32:35], v[168:171], v[224:227], v[32:35]
    ds_read_b64 v[200:201], v237 offset:128
    v_mfma_f32_16x16x32_bf16 v[96:99], v[184:187], v[224:227], v[96:99]
    ds_read_b64 v[202:203], v237 offset:4736
    v_mfma_f32_16x16x32_bf16 v[92:95], v[184:187], v[220:223], v[92:95]
    ds_read_b64 v[204:205], v237 offset:256
    v_mfma_f32_16x16x32_bf16 v[88:91], v[184:187], v[216:219], v[88:91]
    ds_read_b64 v[206:207], v237 offset:4864
    v_mfma_f32_16x16x32_bf16 v[84:87], v[184:187], v[212:215], v[84:87]
    ds_read_b64 v[208:209], v237 offset:384
    v_mfma_f32_16x16x32_bf16 v[36:39], v[172:175], v[212:215], v[36:39]
    ds_read_b64 v[210:211], v237 offset:4992
    v_mfma_f32_16x16x32_bf16 v[40:43], v[172:175], v[216:219], v[40:43]
    ds_read_b64_tr_b16 v[148:149], v232 offset:8192
    v_mfma_f32_16x16x32_bf16 v[44:47], v[172:175], v[220:223], v[44:47]
    ds_read_b64_tr_b16 v[150:151], v232 offset:12288
    v_mfma_f32_16x16x32_bf16 v[48:51], v[172:175], v[224:227], v[48:51]
    ds_read_b64_tr_b16 v[136:137], v233 offset:0
    v_mfma_f32_16x16x32_bf16 v[112:115], v[188:191], v[224:227], v[112:115]
    ds_read_b64_tr_b16 v[138:139], v233 offset:4096
    v_mfma_f32_16x16x32_bf16 v[108:111], v[188:191], v[220:223], v[108:111]
    ds_read_b64_tr_b16 v[152:153], v233 offset:8192
    v_mfma_f32_16x16x32_bf16 v[104:107], v[188:191], v[216:219], v[104:107]
    ds_read_b64_tr_b16 v[154:155], v233 offset:12288
    v_mfma_f32_16x16x32_bf16 v[100:103], v[188:191], v[212:215], v[100:103]
    ds_read_b64_tr_b16 v[140:141], v234 offset:0
    v_mfma_f32_16x16x32_bf16 v[52:55], v[176:179], v[212:215], v[52:55]
    ds_read_b64_tr_b16 v[142:143], v234 offset:4096
    v_mfma_f32_16x16x32_bf16 v[56:59], v[176:179], v[216:219], v[56:59]
    ds_read_b64_tr_b16 v[156:157], v234 offset:8192
    v_mfma_f32_16x16x32_bf16 v[60:63], v[176:179], v[220:223], v[60:63]
    ds_read_b64_tr_b16 v[158:159], v234 offset:12288
    v_mfma_f32_16x16x32_bf16 v[64:67], v[176:179], v[224:227], v[64:67]
    ds_read_b64_tr_b16 v[144:145], v235 offset:0
    v_mfma_f32_16x16x32_bf16 v[128:131], v[192:195], v[224:227], v[128:131]
    ds_read_b64_tr_b16 v[146:147], v235 offset:4096
    v_mfma_f32_16x16x32_bf16 v[124:127], v[192:195], v[220:223], v[124:127]
    ds_read_b64_tr_b16 v[160:161], v235 offset:8192
    v_mfma_f32_16x16x32_bf16 v[120:123], v[192:195], v[216:219], v[120:123]
    ds_read_b64_tr_b16 v[162:163], v235 offset:12288
    v_mfma_f32_16x16x32_bf16 v[116:119], v[192:195], v[212:215], v[116:119]
    s_waitcnt lgkmcnt(14)
    v_mfma_f32_16x16x32_bf16 v[4:7], v[132:135], v[196:199], v[4:7]
    v_mfma_f32_16x16x32_bf16 v[8:11], v[132:135], v[200:203], v[8:11]
    v_mfma_f32_16x16x32_bf16 v[12:15], v[132:135], v[204:207], v[12:15]
    v_mfma_f32_16x16x32_bf16 v[16:19], v[132:135], v[208:211], v[16:19]
    s_waitcnt lgkmcnt(0)
    v_mfma_f32_16x16x32_bf16 v[80:83], v[148:151], v[208:211], v[80:83]
    v_mfma_f32_16x16x32_bf16 v[76:79], v[148:151], v[204:207], v[76:79]
    v_mfma_f32_16x16x32_bf16 v[72:75], v[148:151], v[200:203], v[72:75]
    s_barrier
    v_mfma_f32_16x16x32_bf16 v[68:71], v[148:151], v[196:199], v[68:71]
    ds_read_b64 v[212:213], v237 offset:33792
    v_mfma_f32_16x16x32_bf16 v[20:23], v[136:139], v[196:199], v[20:23]
    ds_read_b64 v[214:215], v237 offset:38400
    v_mfma_f32_16x16x32_bf16 v[24:27], v[136:139], v[200:203], v[24:27]
    ds_read_b64_tr_b16 v[164:165], v232 offset:33792
    v_mfma_f32_16x16x32_bf16 v[28:31], v[136:139], v[204:207], v[28:31]
    ds_read_b64_tr_b16 v[166:167], v232 offset:37888
    v_mfma_f32_16x16x32_bf16 v[32:35], v[136:139], v[208:211], v[32:35]
    ds_read_b64 v[216:217], v237 offset:33920
    v_mfma_f32_16x16x32_bf16 v[96:99], v[152:155], v[208:211], v[96:99]
    ds_read_b64 v[218:219], v237 offset:38528
    v_mfma_f32_16x16x32_bf16 v[92:95], v[152:155], v[204:207], v[92:95]
    ds_read_b64 v[220:221], v237 offset:34048
    v_mfma_f32_16x16x32_bf16 v[88:91], v[152:155], v[200:203], v[88:91]
    ds_read_b64 v[222:223], v237 offset:38656
    v_mfma_f32_16x16x32_bf16 v[84:87], v[152:155], v[196:199], v[84:87]
    ds_read_b64 v[224:225], v237 offset:34176
    v_mfma_f32_16x16x32_bf16 v[36:39], v[140:143], v[196:199], v[36:39]
    ds_read_b64 v[226:227], v237 offset:38784
    v_mfma_f32_16x16x32_bf16 v[40:43], v[140:143], v[200:203], v[40:43]
    ds_read_b64_tr_b16 v[180:181], v232 offset:41984
    v_mfma_f32_16x16x32_bf16 v[44:47], v[140:143], v[204:207], v[44:47]
    ds_read_b64_tr_b16 v[182:183], v232 offset:46080
    v_mfma_f32_16x16x32_bf16 v[48:51], v[140:143], v[208:211], v[48:51]
    ds_read_b64_tr_b16 v[168:169], v233 offset:33792
    v_mfma_f32_16x16x32_bf16 v[112:115], v[156:159], v[208:211], v[112:115]
    ds_read_b64_tr_b16 v[170:171], v233 offset:37888
    v_mfma_f32_16x16x32_bf16 v[108:111], v[156:159], v[204:207], v[108:111]
    ds_read_b64_tr_b16 v[184:185], v233 offset:41984
    v_mfma_f32_16x16x32_bf16 v[104:107], v[156:159], v[200:203], v[104:107]
    ds_read_b64_tr_b16 v[186:187], v233 offset:46080
    v_mfma_f32_16x16x32_bf16 v[100:103], v[156:159], v[196:199], v[100:103]
    ds_read_b64_tr_b16 v[172:173], v234 offset:33792
    v_mfma_f32_16x16x32_bf16 v[52:55], v[144:147], v[196:199], v[52:55]
    ds_read_b64_tr_b16 v[174:175], v234 offset:37888
    v_mfma_f32_16x16x32_bf16 v[56:59], v[144:147], v[200:203], v[56:59]
    ds_read_b64_tr_b16 v[188:189], v234 offset:41984
    v_mfma_f32_16x16x32_bf16 v[60:63], v[144:147], v[204:207], v[60:63]
    ds_read_b64_tr_b16 v[190:191], v234 offset:46080
    v_mfma_f32_16x16x32_bf16 v[64:67], v[144:147], v[208:211], v[64:67]
    ds_read_b64_tr_b16 v[176:177], v235 offset:33792
    v_mfma_f32_16x16x32_bf16 v[128:131], v[160:163], v[208:211], v[128:131]
    ds_read_b64_tr_b16 v[178:179], v235 offset:37888
    v_mfma_f32_16x16x32_bf16 v[124:127], v[160:163], v[204:207], v[124:127]
    ds_read_b64_tr_b16 v[192:193], v235 offset:41984
    v_mfma_f32_16x16x32_bf16 v[120:123], v[160:163], v[200:203], v[120:123]
    ds_read_b64_tr_b16 v[194:195], v235 offset:46080
    v_mfma_f32_16x16x32_bf16 v[116:119], v[160:163], v[196:199], v[116:119]
    s_waitcnt lgkmcnt(14)
    v_mfma_f32_16x16x32_bf16 v[4:7], v[164:167], v[212:215], v[4:7]
    v_mfma_f32_16x16x32_bf16 v[8:11], v[164:167], v[216:219], v[8:11]
    v_mfma_f32_16x16x32_bf16 v[12:15], v[164:167], v[220:223], v[12:15]
    v_mfma_f32_16x16x32_bf16 v[16:19], v[164:167], v[224:227], v[16:19]
    s_waitcnt lgkmcnt(0)
    v_mfma_f32_16x16x32_bf16 v[80:83], v[180:183], v[224:227], v[80:83]
    v_mfma_f32_16x16x32_bf16 v[76:79], v[180:183], v[220:223], v[76:79]
    v_mfma_f32_16x16x32_bf16 v[72:75], v[180:183], v[216:219], v[72:75]
    s_barrier
    v_mfma_f32_16x16x32_bf16 v[68:71], v[180:183], v[212:215], v[68:71]
    ds_read_b64 v[196:197], v236 offset:0
    v_mfma_f32_16x16x32_bf16 v[20:23], v[168:171], v[212:215], v[20:23]
    ds_read_b64 v[198:199], v236 offset:4608
    v_mfma_f32_16x16x32_bf16 v[24:27], v[168:171], v[216:219], v[24:27]
    ds_read_b64_tr_b16 v[132:133], v228 offset:0
    v_mfma_f32_16x16x32_bf16 v[28:31], v[168:171], v[220:223], v[28:31]
    ds_read_b64_tr_b16 v[134:135], v228 offset:4096
    v_mfma_f32_16x16x32_bf16 v[32:35], v[168:171], v[224:227], v[32:35]
    ds_read_b64 v[200:201], v236 offset:128
    v_mfma_f32_16x16x32_bf16 v[96:99], v[184:187], v[224:227], v[96:99]
    ds_read_b64 v[202:203], v236 offset:4736
    v_mfma_f32_16x16x32_bf16 v[92:95], v[184:187], v[220:223], v[92:95]
    ds_read_b64 v[204:205], v236 offset:256
    v_mfma_f32_16x16x32_bf16 v[88:91], v[184:187], v[216:219], v[88:91]
    ds_read_b64 v[206:207], v236 offset:4864
    v_mfma_f32_16x16x32_bf16 v[84:87], v[184:187], v[212:215], v[84:87]
    ds_read_b64 v[208:209], v236 offset:384
    v_mfma_f32_16x16x32_bf16 v[36:39], v[172:175], v[212:215], v[36:39]
    ds_read_b64 v[210:211], v236 offset:4992
    v_mfma_f32_16x16x32_bf16 v[40:43], v[172:175], v[216:219], v[40:43]
    ds_read_b64_tr_b16 v[148:149], v228 offset:8192
    v_mfma_f32_16x16x32_bf16 v[44:47], v[172:175], v[220:223], v[44:47]
    ds_read_b64_tr_b16 v[150:151], v228 offset:12288
    v_mfma_f32_16x16x32_bf16 v[48:51], v[172:175], v[224:227], v[48:51]
    ds_read_b64_tr_b16 v[136:137], v229 offset:0
    v_mfma_f32_16x16x32_bf16 v[112:115], v[188:191], v[224:227], v[112:115]
    ds_read_b64_tr_b16 v[138:139], v229 offset:4096
    v_mfma_f32_16x16x32_bf16 v[108:111], v[188:191], v[220:223], v[108:111]
    ds_read_b64_tr_b16 v[152:153], v229 offset:8192
    v_mfma_f32_16x16x32_bf16 v[104:107], v[188:191], v[216:219], v[104:107]
    ds_read_b64_tr_b16 v[154:155], v229 offset:12288
    v_mfma_f32_16x16x32_bf16 v[100:103], v[188:191], v[212:215], v[100:103]
    ds_read_b64_tr_b16 v[140:141], v230 offset:0
    v_mfma_f32_16x16x32_bf16 v[52:55], v[176:179], v[212:215], v[52:55]
    ds_read_b64_tr_b16 v[142:143], v230 offset:4096
    v_mfma_f32_16x16x32_bf16 v[56:59], v[176:179], v[216:219], v[56:59]
    ds_read_b64_tr_b16 v[156:157], v230 offset:8192
    v_mfma_f32_16x16x32_bf16 v[60:63], v[176:179], v[220:223], v[60:63]
    ds_read_b64_tr_b16 v[158:159], v230 offset:12288
    v_mfma_f32_16x16x32_bf16 v[64:67], v[176:179], v[224:227], v[64:67]
    ds_read_b64_tr_b16 v[144:145], v231 offset:0
    v_mfma_f32_16x16x32_bf16 v[128:131], v[192:195], v[224:227], v[128:131]
    ds_read_b64_tr_b16 v[146:147], v231 offset:4096
    v_mfma_f32_16x16x32_bf16 v[124:127], v[192:195], v[220:223], v[124:127]
    ds_read_b64_tr_b16 v[160:161], v231 offset:8192
    v_mfma_f32_16x16x32_bf16 v[120:123], v[192:195], v[216:219], v[120:123]
    ds_read_b64_tr_b16 v[162:163], v231 offset:12288
    v_mfma_f32_16x16x32_bf16 v[116:119], v[192:195], v[212:215], v[116:119]
    s_waitcnt lgkmcnt(14)
    v_mfma_f32_16x16x32_bf16 v[4:7], v[132:135], v[196:199], v[4:7]
    v_mfma_f32_16x16x32_bf16 v[8:11], v[132:135], v[200:203], v[8:11]
    v_mfma_f32_16x16x32_bf16 v[12:15], v[132:135], v[204:207], v[12:15]
    v_mfma_f32_16x16x32_bf16 v[16:19], v[132:135], v[208:211], v[16:19]
    s_waitcnt lgkmcnt(0)
    v_mfma_f32_16x16x32_bf16 v[80:83], v[148:151], v[208:211], v[80:83]
    v_mfma_f32_16x16x32_bf16 v[76:79], v[148:151], v[204:207], v[76:79]
    v_mfma_f32_16x16x32_bf16 v[72:75], v[148:151], v[200:203], v[72:75]
    s_barrier
    v_mfma_f32_16x16x32_bf16 v[68:71], v[148:151], v[196:199], v[68:71]
    ds_read_b64 v[212:213], v236 offset:33792
    v_mfma_f32_16x16x32_bf16 v[20:23], v[136:139], v[196:199], v[20:23]
    ds_read_b64 v[214:215], v236 offset:38400
    v_mfma_f32_16x16x32_bf16 v[24:27], v[136:139], v[200:203], v[24:27]
    ds_read_b64_tr_b16 v[164:165], v228 offset:33792
    v_mfma_f32_16x16x32_bf16 v[28:31], v[136:139], v[204:207], v[28:31]
    ds_read_b64_tr_b16 v[166:167], v228 offset:37888
    v_mfma_f32_16x16x32_bf16 v[32:35], v[136:139], v[208:211], v[32:35]
    ds_read_b64 v[216:217], v236 offset:33920
    v_mfma_f32_16x16x32_bf16 v[96:99], v[152:155], v[208:211], v[96:99]
    ds_read_b64 v[218:219], v236 offset:38528
    v_mfma_f32_16x16x32_bf16 v[92:95], v[152:155], v[204:207], v[92:95]
    ds_read_b64 v[220:221], v236 offset:34048
    v_mfma_f32_16x16x32_bf16 v[88:91], v[152:155], v[200:203], v[88:91]
    ds_read_b64 v[222:223], v236 offset:38656
    v_mfma_f32_16x16x32_bf16 v[84:87], v[152:155], v[196:199], v[84:87]
    ds_read_b64 v[224:225], v236 offset:34176
    v_mfma_f32_16x16x32_bf16 v[36:39], v[140:143], v[196:199], v[36:39]
    ds_read_b64 v[226:227], v236 offset:38784
    v_mfma_f32_16x16x32_bf16 v[40:43], v[140:143], v[200:203], v[40:43]
    ds_read_b64_tr_b16 v[180:181], v228 offset:41984
    v_mfma_f32_16x16x32_bf16 v[44:47], v[140:143], v[204:207], v[44:47]
    ds_read_b64_tr_b16 v[182:183], v228 offset:46080
    v_mfma_f32_16x16x32_bf16 v[48:51], v[140:143], v[208:211], v[48:51]
    ds_read_b64_tr_b16 v[168:169], v229 offset:33792
    v_mfma_f32_16x16x32_bf16 v[112:115], v[156:159], v[208:211], v[112:115]
    ds_read_b64_tr_b16 v[170:171], v229 offset:37888
    v_mfma_f32_16x16x32_bf16 v[108:111], v[156:159], v[204:207], v[108:111]
    ds_read_b64_tr_b16 v[184:185], v229 offset:41984
    v_mfma_f32_16x16x32_bf16 v[104:107], v[156:159], v[200:203], v[104:107]
    ds_read_b64_tr_b16 v[186:187], v229 offset:46080
    v_mfma_f32_16x16x32_bf16 v[100:103], v[156:159], v[196:199], v[100:103]
    ds_read_b64_tr_b16 v[172:173], v230 offset:33792
    v_mfma_f32_16x16x32_bf16 v[52:55], v[144:147], v[196:199], v[52:55]
    ds_read_b64_tr_b16 v[174:175], v230 offset:37888
    v_mfma_f32_16x16x32_bf16 v[56:59], v[144:147], v[200:203], v[56:59]
    ds_read_b64_tr_b16 v[188:189], v230 offset:41984
    v_mfma_f32_16x16x32_bf16 v[60:63], v[144:147], v[204:207], v[60:63]
    ds_read_b64_tr_b16 v[190:191], v230 offset:46080
    v_mfma_f32_16x16x32_bf16 v[64:67], v[144:147], v[208:211], v[64:67]
    ds_read_b64_tr_b16 v[176:177], v231 offset:33792
    v_mfma_f32_16x16x32_bf16 v[128:131], v[160:163], v[208:211], v[128:131]
    ds_read_b64_tr_b16 v[178:179], v231 offset:37888
    v_mfma_f32_16x16x32_bf16 v[124:127], v[160:163], v[204:207], v[124:127]
    ds_read_b64_tr_b16 v[192:193], v231 offset:41984
    v_mfma_f32_16x16x32_bf16 v[120:123], v[160:163], v[200:203], v[120:123]
    ds_read_b64_tr_b16 v[194:195], v231 offset:46080
    v_mfma_f32_16x16x32_bf16 v[116:119], v[160:163], v[196:199], v[116:119]
    s_waitcnt lgkmcnt(14)
    v_mfma_f32_16x16x32_bf16 v[4:7], v[164:167], v[212:215], v[4:7]
    v_mfma_f32_16x16x32_bf16 v[8:11], v[164:167], v[216:219], v[8:11]
    v_mfma_f32_16x16x32_bf16 v[12:15], v[164:167], v[220:223], v[12:15]
    v_mfma_f32_16x16x32_bf16 v[16:19], v[164:167], v[224:227], v[16:19]
    s_waitcnt lgkmcnt(0)
    v_mfma_f32_16x16x32_bf16 v[80:83], v[180:183], v[224:227], v[80:83]
    v_mfma_f32_16x16x32_bf16 v[76:79], v[180:183], v[220:223], v[76:79]
    v_mfma_f32_16x16x32_bf16 v[72:75], v[180:183], v[216:219], v[72:75]
    s_barrier
    v_mfma_f32_16x16x32_bf16 v[68:71], v[180:183], v[212:215], v[68:71]
    ds_read_b64 v[196:197], v237 offset:0
    v_mfma_f32_16x16x32_bf16 v[20:23], v[168:171], v[212:215], v[20:23]
    ds_read_b64 v[198:199], v237 offset:4608
    v_mfma_f32_16x16x32_bf16 v[24:27], v[168:171], v[216:219], v[24:27]
    ds_read_b64_tr_b16 v[132:133], v232 offset:0
    v_mfma_f32_16x16x32_bf16 v[28:31], v[168:171], v[220:223], v[28:31]
    ds_read_b64_tr_b16 v[134:135], v232 offset:4096
    v_mfma_f32_16x16x32_bf16 v[32:35], v[168:171], v[224:227], v[32:35]
    ds_read_b64 v[200:201], v237 offset:128
    v_mfma_f32_16x16x32_bf16 v[96:99], v[184:187], v[224:227], v[96:99]
    ds_read_b64 v[202:203], v237 offset:4736
    v_mfma_f32_16x16x32_bf16 v[92:95], v[184:187], v[220:223], v[92:95]
    ds_read_b64 v[204:205], v237 offset:256
    v_mfma_f32_16x16x32_bf16 v[88:91], v[184:187], v[216:219], v[88:91]
    ds_read_b64 v[206:207], v237 offset:4864
    v_mfma_f32_16x16x32_bf16 v[84:87], v[184:187], v[212:215], v[84:87]
    ds_read_b64 v[208:209], v237 offset:384
    v_mfma_f32_16x16x32_bf16 v[36:39], v[172:175], v[212:215], v[36:39]
    ds_read_b64 v[210:211], v237 offset:4992
    v_mfma_f32_16x16x32_bf16 v[40:43], v[172:175], v[216:219], v[40:43]
    ds_read_b64_tr_b16 v[148:149], v232 offset:8192
    v_mfma_f32_16x16x32_bf16 v[44:47], v[172:175], v[220:223], v[44:47]
    ds_read_b64_tr_b16 v[150:151], v232 offset:12288
    v_mfma_f32_16x16x32_bf16 v[48:51], v[172:175], v[224:227], v[48:51]
    ds_read_b64_tr_b16 v[136:137], v233 offset:0
    v_mfma_f32_16x16x32_bf16 v[112:115], v[188:191], v[224:227], v[112:115]
    ds_read_b64_tr_b16 v[138:139], v233 offset:4096
    v_mfma_f32_16x16x32_bf16 v[108:111], v[188:191], v[220:223], v[108:111]
    ds_read_b64_tr_b16 v[152:153], v233 offset:8192
    v_mfma_f32_16x16x32_bf16 v[104:107], v[188:191], v[216:219], v[104:107]
    ds_read_b64_tr_b16 v[154:155], v233 offset:12288
    v_mfma_f32_16x16x32_bf16 v[100:103], v[188:191], v[212:215], v[100:103]
    ds_read_b64_tr_b16 v[140:141], v234 offset:0
    v_mfma_f32_16x16x32_bf16 v[52:55], v[176:179], v[212:215], v[52:55]
    ds_read_b64_tr_b16 v[142:143], v234 offset:4096
    v_mfma_f32_16x16x32_bf16 v[56:59], v[176:179], v[216:219], v[56:59]
    ds_read_b64_tr_b16 v[156:157], v234 offset:8192
    v_mfma_f32_16x16x32_bf16 v[60:63], v[176:179], v[220:223], v[60:63]
    ds_read_b64_tr_b16 v[158:159], v234 offset:12288
    v_mfma_f32_16x16x32_bf16 v[64:67], v[176:179], v[224:227], v[64:67]
    ds_read_b64_tr_b16 v[144:145], v235 offset:0
    v_mfma_f32_16x16x32_bf16 v[128:131], v[192:195], v[224:227], v[128:131]
    ds_read_b64_tr_b16 v[146:147], v235 offset:4096
    v_mfma_f32_16x16x32_bf16 v[124:127], v[192:195], v[220:223], v[124:127]
    ds_read_b64_tr_b16 v[160:161], v235 offset:8192
    v_mfma_f32_16x16x32_bf16 v[120:123], v[192:195], v[216:219], v[120:123]
    ds_read_b64_tr_b16 v[162:163], v235 offset:12288
    v_mfma_f32_16x16x32_bf16 v[116:119], v[192:195], v[212:215], v[116:119]
    s_waitcnt lgkmcnt(14)
    v_mfma_f32_16x16x32_bf16 v[4:7], v[132:135], v[196:199], v[4:7]
    v_mfma_f32_16x16x32_bf16 v[8:11], v[132:135], v[200:203], v[8:11]
    v_mfma_f32_16x16x32_bf16 v[12:15], v[132:135], v[204:207], v[12:15]
    v_mfma_f32_16x16x32_bf16 v[16:19], v[132:135], v[208:211], v[16:19]
    s_waitcnt lgkmcnt(0)
    v_mfma_f32_16x16x32_bf16 v[80:83], v[148:151], v[208:211], v[80:83]
    v_mfma_f32_16x16x32_bf16 v[76:79], v[148:151], v[204:207], v[76:79]
    v_mfma_f32_16x16x32_bf16 v[72:75], v[148:151], v[200:203], v[72:75]
    s_barrier
    v_mfma_f32_16x16x32_bf16 v[68:71], v[148:151], v[196:199], v[68:71]
    ds_read_b64 v[212:213], v237 offset:33792
    v_mfma_f32_16x16x32_bf16 v[20:23], v[136:139], v[196:199], v[20:23]
    ds_read_b64 v[214:215], v237 offset:38400
    v_mfma_f32_16x16x32_bf16 v[24:27], v[136:139], v[200:203], v[24:27]
    ds_read_b64_tr_b16 v[164:165], v232 offset:33792
    v_mfma_f32_16x16x32_bf16 v[28:31], v[136:139], v[204:207], v[28:31]
    ds_read_b64_tr_b16 v[166:167], v232 offset:37888
    v_mfma_f32_16x16x32_bf16 v[32:35], v[136:139], v[208:211], v[32:35]
    ds_read_b64 v[216:217], v237 offset:33920
    v_mfma_f32_16x16x32_bf16 v[96:99], v[152:155], v[208:211], v[96:99]
    ds_read_b64 v[218:219], v237 offset:38528
    v_mfma_f32_16x16x32_bf16 v[92:95], v[152:155], v[204:207], v[92:95]
    ds_read_b64 v[220:221], v237 offset:34048
    v_mfma_f32_16x16x32_bf16 v[88:91], v[152:155], v[200:203], v[88:91]
    ds_read_b64 v[222:223], v237 offset:38656
    v_mfma_f32_16x16x32_bf16 v[84:87], v[152:155], v[196:199], v[84:87]
    ds_read_b64 v[224:225], v237 offset:34176
    v_mfma_f32_16x16x32_bf16 v[36:39], v[140:143], v[196:199], v[36:39]
    ds_read_b64 v[226:227], v237 offset:38784
    v_mfma_f32_16x16x32_bf16 v[40:43], v[140:143], v[200:203], v[40:43]
    ds_read_b64_tr_b16 v[180:181], v232 offset:41984
    v_mfma_f32_16x16x32_bf16 v[44:47], v[140:143], v[204:207], v[44:47]
    ds_read_b64_tr_b16 v[182:183], v232 offset:46080
    v_mfma_f32_16x16x32_bf16 v[48:51], v[140:143], v[208:211], v[48:51]
    ds_read_b64_tr_b16 v[168:169], v233 offset:33792
    v_mfma_f32_16x16x32_bf16 v[112:115], v[156:159], v[208:211], v[112:115]
    ds_read_b64_tr_b16 v[170:171], v233 offset:37888
    v_mfma_f32_16x16x32_bf16 v[108:111], v[156:159], v[204:207], v[108:111]
    ds_read_b64_tr_b16 v[184:185], v233 offset:41984
    v_mfma_f32_16x16x32_bf16 v[104:107], v[156:159], v[200:203], v[104:107]
    ds_read_b64_tr_b16 v[186:187], v233 offset:46080
    v_mfma_f32_16x16x32_bf16 v[100:103], v[156:159], v[196:199], v[100:103]
    ds_read_b64_tr_b16 v[172:173], v234 offset:33792
    v_mfma_f32_16x16x32_bf16 v[52:55], v[144:147], v[196:199], v[52:55]
    ds_read_b64_tr_b16 v[174:175], v234 offset:37888
    v_mfma_f32_16x16x32_bf16 v[56:59], v[144:147], v[200:203], v[56:59]
    ds_read_b64_tr_b16 v[188:189], v234 offset:41984
    v_mfma_f32_16x16x32_bf16 v[60:63], v[144:147], v[204:207], v[60:63]
    ds_read_b64_tr_b16 v[190:191], v234 offset:46080
    v_mfma_f32_16x16x32_bf16 v[64:67], v[144:147], v[208:211], v[64:67]
    ds_read_b64_tr_b16 v[176:177], v235 offset:33792
    v_mfma_f32_16x16x32_bf16 v[128:131], v[160:163], v[208:211], v[128:131]
    ds_read_b64_tr_b16 v[178:179], v235 offset:37888
    v_mfma_f32_16x16x32_bf16 v[124:127], v[160:163], v[204:207], v[124:127]
    ds_read_b64_tr_b16 v[192:193], v235 offset:41984
    v_mfma_f32_16x16x32_bf16 v[120:123], v[160:163], v[200:203], v[120:123]
    ds_read_b64_tr_b16 v[194:195], v235 offset:46080
    v_mfma_f32_16x16x32_bf16 v[116:119], v[160:163], v[196:199], v[116:119]
    s_waitcnt lgkmcnt(14)
    v_mfma_f32_16x16x32_bf16 v[4:7], v[164:167], v[212:215], v[4:7]
    v_mfma_f32_16x16x32_bf16 v[8:11], v[164:167], v[216:219], v[8:11]
    v_mfma_f32_16x16x32_bf16 v[12:15], v[164:167], v[220:223], v[12:15]
    v_mfma_f32_16x16x32_bf16 v[16:19], v[164:167], v[224:227], v[16:19]
    s_waitcnt lgkmcnt(0)
    v_mfma_f32_16x16x32_bf16 v[80:83], v[180:183], v[224:227], v[80:83]
    v_mfma_f32_16x16x32_bf16 v[76:79], v[180:183], v[220:223], v[76:79]
    v_mfma_f32_16x16x32_bf16 v[72:75], v[180:183], v[216:219], v[72:75]
    s_barrier
    v_mfma_f32_16x16x32_bf16 v[68:71], v[180:183], v[212:215], v[68:71]
    ds_read_b64 v[196:197], v236 offset:0
    v_mfma_f32_16x16x32_bf16 v[20:23], v[168:171], v[212:215], v[20:23]
    ds_read_b64 v[198:199], v236 offset:4608
    v_mfma_f32_16x16x32_bf16 v[24:27], v[168:171], v[216:219], v[24:27]
    ds_read_b64_tr_b16 v[132:133], v228 offset:0
    v_mfma_f32_16x16x32_bf16 v[28:31], v[168:171], v[220:223], v[28:31]
    ds_read_b64_tr_b16 v[134:135], v228 offset:4096
    v_mfma_f32_16x16x32_bf16 v[32:35], v[168:171], v[224:227], v[32:35]
    ds_read_b64 v[200:201], v236 offset:128
    v_mfma_f32_16x16x32_bf16 v[96:99], v[184:187], v[224:227], v[96:99]
    ds_read_b64 v[202:203], v236 offset:4736
    v_mfma_f32_16x16x32_bf16 v[92:95], v[184:187], v[220:223], v[92:95]
    ds_read_b64 v[204:205], v236 offset:256
    v_mfma_f32_16x16x32_bf16 v[88:91], v[184:187], v[216:219], v[88:91]
    ds_read_b64 v[206:207], v236 offset:4864
    v_mfma_f32_16x16x32_bf16 v[84:87], v[184:187], v[212:215], v[84:87]
    ds_read_b64 v[208:209], v236 offset:384
    v_mfma_f32_16x16x32_bf16 v[36:39], v[172:175], v[212:215], v[36:39]
    ds_read_b64 v[210:211], v236 offset:4992
    v_mfma_f32_16x16x32_bf16 v[40:43], v[172:175], v[216:219], v[40:43]
    ds_read_b64_tr_b16 v[148:149], v228 offset:8192
    v_mfma_f32_16x16x32_bf16 v[44:47], v[172:175], v[220:223], v[44:47]
    ds_read_b64_tr_b16 v[150:151], v228 offset:12288
    v_mfma_f32_16x16x32_bf16 v[48:51], v[172:175], v[224:227], v[48:51]
    ds_read_b64_tr_b16 v[136:137], v229 offset:0
    v_mfma_f32_16x16x32_bf16 v[112:115], v[188:191], v[224:227], v[112:115]
    ds_read_b64_tr_b16 v[138:139], v229 offset:4096
    v_mfma_f32_16x16x32_bf16 v[108:111], v[188:191], v[220:223], v[108:111]
    ds_read_b64_tr_b16 v[152:153], v229 offset:8192
    v_mfma_f32_16x16x32_bf16 v[104:107], v[188:191], v[216:219], v[104:107]
    ds_read_b64_tr_b16 v[154:155], v229 offset:12288
    v_mfma_f32_16x16x32_bf16 v[100:103], v[188:191], v[212:215], v[100:103]
    ds_read_b64_tr_b16 v[140:141], v230 offset:0
    v_mfma_f32_16x16x32_bf16 v[52:55], v[176:179], v[212:215], v[52:55]
    ds_read_b64_tr_b16 v[142:143], v230 offset:4096
    v_mfma_f32_16x16x32_bf16 v[56:59], v[176:179], v[216:219], v[56:59]
    ds_read_b64_tr_b16 v[156:157], v230 offset:8192
    v_mfma_f32_16x16x32_bf16 v[60:63], v[176:179], v[220:223], v[60:63]
    ds_read_b64_tr_b16 v[158:159], v230 offset:12288
    v_mfma_f32_16x16x32_bf16 v[64:67], v[176:179], v[224:227], v[64:67]
    ds_read_b64_tr_b16 v[144:145], v231 offset:0
    v_mfma_f32_16x16x32_bf16 v[128:131], v[192:195], v[224:227], v[128:131]
    ds_read_b64_tr_b16 v[146:147], v231 offset:4096
    v_mfma_f32_16x16x32_bf16 v[124:127], v[192:195], v[220:223], v[124:127]
    ds_read_b64_tr_b16 v[160:161], v231 offset:8192
    v_mfma_f32_16x16x32_bf16 v[120:123], v[192:195], v[216:219], v[120:123]
    ds_read_b64_tr_b16 v[162:163], v231 offset:12288
    v_mfma_f32_16x16x32_bf16 v[116:119], v[192:195], v[212:215], v[116:119]
    s_waitcnt lgkmcnt(14)
    v_mfma_f32_16x16x32_bf16 v[4:7], v[132:135], v[196:199], v[4:7]
    v_mfma_f32_16x16x32_bf16 v[8:11], v[132:135], v[200:203], v[8:11]
    v_mfma_f32_16x16x32_bf16 v[12:15], v[132:135], v[204:207], v[12:15]
    v_mfma_f32_16x16x32_bf16 v[16:19], v[132:135], v[208:211], v[16:19]
    s_waitcnt lgkmcnt(0)
    v_mfma_f32_16x16x32_bf16 v[80:83], v[148:151], v[208:211], v[80:83]
    v_mfma_f32_16x16x32_bf16 v[76:79], v[148:151], v[204:207], v[76:79]
    v_mfma_f32_16x16x32_bf16 v[72:75], v[148:151], v[200:203], v[72:75]
    s_barrier
    v_mfma_f32_16x16x32_bf16 v[68:71], v[148:151], v[196:199], v[68:71]
    ds_read_b64 v[212:213], v236 offset:33792
    v_mfma_f32_16x16x32_bf16 v[20:23], v[136:139], v[196:199], v[20:23]
    ds_read_b64 v[214:215], v236 offset:38400
    v_mfma_f32_16x16x32_bf16 v[24:27], v[136:139], v[200:203], v[24:27]
    ds_read_b64_tr_b16 v[164:165], v228 offset:33792
    v_mfma_f32_16x16x32_bf16 v[28:31], v[136:139], v[204:207], v[28:31]
    ds_read_b64_tr_b16 v[166:167], v228 offset:37888
    v_mfma_f32_16x16x32_bf16 v[32:35], v[136:139], v[208:211], v[32:35]
    ds_read_b64 v[216:217], v236 offset:33920
    v_mfma_f32_16x16x32_bf16 v[96:99], v[152:155], v[208:211], v[96:99]
    ds_read_b64 v[218:219], v236 offset:38528
    v_mfma_f32_16x16x32_bf16 v[92:95], v[152:155], v[204:207], v[92:95]
    ds_read_b64 v[220:221], v236 offset:34048
    v_mfma_f32_16x16x32_bf16 v[88:91], v[152:155], v[200:203], v[88:91]
    ds_read_b64 v[222:223], v236 offset:38656
    v_mfma_f32_16x16x32_bf16 v[84:87], v[152:155], v[196:199], v[84:87]
    ds_read_b64 v[224:225], v236 offset:34176
    v_mfma_f32_16x16x32_bf16 v[36:39], v[140:143], v[196:199], v[36:39]
    ds_read_b64 v[226:227], v236 offset:38784
    v_mfma_f32_16x16x32_bf16 v[40:43], v[140:143], v[200:203], v[40:43]
    ds_read_b64_tr_b16 v[180:181], v228 offset:41984
    v_mfma_f32_16x16x32_bf16 v[44:47], v[140:143], v[204:207], v[44:47]
    ds_read_b64_tr_b16 v[182:183], v228 offset:46080
    v_mfma_f32_16x16x32_bf16 v[48:51], v[140:143], v[208:211], v[48:51]
    ds_read_b64_tr_b16 v[168:169], v229 offset:33792
    v_mfma_f32_16x16x32_bf16 v[112:115], v[156:159], v[208:211], v[112:115]
    ds_read_b64_tr_b16 v[170:171], v229 offset:37888
    v_mfma_f32_16x16x32_bf16 v[108:111], v[156:159], v[204:207], v[108:111]
    ds_read_b64_tr_b16 v[184:185], v229 offset:41984
    v_mfma_f32_16x16x32_bf16 v[104:107], v[156:159], v[200:203], v[104:107]
    ds_read_b64_tr_b16 v[186:187], v229 offset:46080
    v_mfma_f32_16x16x32_bf16 v[100:103], v[156:159], v[196:199], v[100:103]
    ds_read_b64_tr_b16 v[172:173], v230 offset:33792
    v_mfma_f32_16x16x32_bf16 v[52:55], v[144:147], v[196:199], v[52:55]
    ds_read_b64_tr_b16 v[174:175], v230 offset:37888
    v_mfma_f32_16x16x32_bf16 v[56:59], v[144:147], v[200:203], v[56:59]
    ds_read_b64_tr_b16 v[188:189], v230 offset:41984
    v_mfma_f32_16x16x32_bf16 v[60:63], v[144:147], v[204:207], v[60:63]
    ds_read_b64_tr_b16 v[190:191], v230 offset:46080
    v_mfma_f32_16x16x32_bf16 v[64:67], v[144:147], v[208:211], v[64:67]
    ds_read_b64_tr_b16 v[176:177], v231 offset:33792
    v_mfma_f32_16x16x32_bf16 v[128:131], v[160:163], v[208:211], v[128:131]
    ds_read_b64_tr_b16 v[178:179], v231 offset:37888
    v_mfma_f32_16x16x32_bf16 v[124:127], v[160:163], v[204:207], v[124:127]
    ds_read_b64_tr_b16 v[192:193], v231 offset:41984
    v_mfma_f32_16x16x32_bf16 v[120:123], v[160:163], v[200:203], v[120:123]
    ds_read_b64_tr_b16 v[194:195], v231 offset:46080
    v_mfma_f32_16x16x32_bf16 v[116:119], v[160:163], v[196:199], v[116:119]
    s_waitcnt lgkmcnt(14)
    v_mfma_f32_16x16x32_bf16 v[4:7], v[164:167], v[212:215], v[4:7]
    v_mfma_f32_16x16x32_bf16 v[8:11], v[164:167], v[216:219], v[8:11]
    v_mfma_f32_16x16x32_bf16 v[12:15], v[164:167], v[220:223], v[12:15]
    v_mfma_f32_16x16x32_bf16 v[16:19], v[164:167], v[224:227], v[16:19]
    s_waitcnt lgkmcnt(0)
    v_mfma_f32_16x16x32_bf16 v[80:83], v[180:183], v[224:227], v[80:83]
    v_mfma_f32_16x16x32_bf16 v[76:79], v[180:183], v[220:223], v[76:79]
    v_mfma_f32_16x16x32_bf16 v[72:75], v[180:183], v[216:219], v[72:75]
    s_barrier
    v_mfma_f32_16x16x32_bf16 v[68:71], v[180:183], v[212:215], v[68:71]
    ds_read_b64 v[196:197], v237 offset:0
    v_mfma_f32_16x16x32_bf16 v[20:23], v[168:171], v[212:215], v[20:23]
    ds_read_b64 v[198:199], v237 offset:4608
    v_mfma_f32_16x16x32_bf16 v[24:27], v[168:171], v[216:219], v[24:27]
    ds_read_b64_tr_b16 v[132:133], v232 offset:0
    v_mfma_f32_16x16x32_bf16 v[28:31], v[168:171], v[220:223], v[28:31]
    ds_read_b64_tr_b16 v[134:135], v232 offset:4096
    v_mfma_f32_16x16x32_bf16 v[32:35], v[168:171], v[224:227], v[32:35]
    ds_read_b64 v[200:201], v237 offset:128
    v_mfma_f32_16x16x32_bf16 v[96:99], v[184:187], v[224:227], v[96:99]
    ds_read_b64 v[202:203], v237 offset:4736
    v_mfma_f32_16x16x32_bf16 v[92:95], v[184:187], v[220:223], v[92:95]
    ds_read_b64 v[204:205], v237 offset:256
    v_mfma_f32_16x16x32_bf16 v[88:91], v[184:187], v[216:219], v[88:91]
    ds_read_b64 v[206:207], v237 offset:4864
    v_mfma_f32_16x16x32_bf16 v[84:87], v[184:187], v[212:215], v[84:87]
    ds_read_b64 v[208:209], v237 offset:384
    v_mfma_f32_16x16x32_bf16 v[36:39], v[172:175], v[212:215], v[36:39]
    ds_read_b64 v[210:211], v237 offset:4992
    v_mfma_f32_16x16x32_bf16 v[40:43], v[172:175], v[216:219], v[40:43]
    ds_read_b64_tr_b16 v[148:149], v232 offset:8192
    v_mfma_f32_16x16x32_bf16 v[44:47], v[172:175], v[220:223], v[44:47]
    ds_read_b64_tr_b16 v[150:151], v232 offset:12288
    v_mfma_f32_16x16x32_bf16 v[48:51], v[172:175], v[224:227], v[48:51]
    ds_read_b64_tr_b16 v[136:137], v233 offset:0
    v_mfma_f32_16x16x32_bf16 v[112:115], v[188:191], v[224:227], v[112:115]
    ds_read_b64_tr_b16 v[138:139], v233 offset:4096
    v_mfma_f32_16x16x32_bf16 v[108:111], v[188:191], v[220:223], v[108:111]
    ds_read_b64_tr_b16 v[152:153], v233 offset:8192
    v_mfma_f32_16x16x32_bf16 v[104:107], v[188:191], v[216:219], v[104:107]
    ds_read_b64_tr_b16 v[154:155], v233 offset:12288
    v_mfma_f32_16x16x32_bf16 v[100:103], v[188:191], v[212:215], v[100:103]
    ds_read_b64_tr_b16 v[140:141], v234 offset:0
    v_mfma_f32_16x16x32_bf16 v[52:55], v[176:179], v[212:215], v[52:55]
    ds_read_b64_tr_b16 v[142:143], v234 offset:4096
    v_mfma_f32_16x16x32_bf16 v[56:59], v[176:179], v[216:219], v[56:59]
    ds_read_b64_tr_b16 v[156:157], v234 offset:8192
    v_mfma_f32_16x16x32_bf16 v[60:63], v[176:179], v[220:223], v[60:63]
    ds_read_b64_tr_b16 v[158:159], v234 offset:12288
    v_mfma_f32_16x16x32_bf16 v[64:67], v[176:179], v[224:227], v[64:67]
    ds_read_b64_tr_b16 v[144:145], v235 offset:0
    v_mfma_f32_16x16x32_bf16 v[128:131], v[192:195], v[224:227], v[128:131]
    ds_read_b64_tr_b16 v[146:147], v235 offset:4096
    v_mfma_f32_16x16x32_bf16 v[124:127], v[192:195], v[220:223], v[124:127]
    ds_read_b64_tr_b16 v[160:161], v235 offset:8192
    v_mfma_f32_16x16x32_bf16 v[120:123], v[192:195], v[216:219], v[120:123]
    ds_read_b64_tr_b16 v[162:163], v235 offset:12288
    v_mfma_f32_16x16x32_bf16 v[116:119], v[192:195], v[212:215], v[116:119]
    s_waitcnt lgkmcnt(14)
    v_mfma_f32_16x16x32_bf16 v[4:7], v[132:135], v[196:199], v[4:7]
    v_mfma_f32_16x16x32_bf16 v[8:11], v[132:135], v[200:203], v[8:11]
    v_mfma_f32_16x16x32_bf16 v[12:15], v[132:135], v[204:207], v[12:15]
    v_mfma_f32_16x16x32_bf16 v[16:19], v[132:135], v[208:211], v[16:19]
    s_waitcnt lgkmcnt(0)
    v_mfma_f32_16x16x32_bf16 v[80:83], v[148:151], v[208:211], v[80:83]
    v_mfma_f32_16x16x32_bf16 v[76:79], v[148:151], v[204:207], v[76:79]
    v_mfma_f32_16x16x32_bf16 v[72:75], v[148:151], v[200:203], v[72:75]
    s_barrier
    v_mfma_f32_16x16x32_bf16 v[68:71], v[148:151], v[196:199], v[68:71]
    ds_read_b64 v[212:213], v237 offset:33792
    v_mfma_f32_16x16x32_bf16 v[20:23], v[136:139], v[196:199], v[20:23]
    ds_read_b64 v[214:215], v237 offset:38400
    v_mfma_f32_16x16x32_bf16 v[24:27], v[136:139], v[200:203], v[24:27]
    ds_read_b64_tr_b16 v[164:165], v232 offset:33792
    v_mfma_f32_16x16x32_bf16 v[28:31], v[136:139], v[204:207], v[28:31]
    ds_read_b64_tr_b16 v[166:167], v232 offset:37888
    v_mfma_f32_16x16x32_bf16 v[32:35], v[136:139], v[208:211], v[32:35]
    ds_read_b64 v[216:217], v237 offset:33920
    v_mfma_f32_16x16x32_bf16 v[96:99], v[152:155], v[208:211], v[96:99]
    ds_read_b64 v[218:219], v237 offset:38528
    v_mfma_f32_16x16x32_bf16 v[92:95], v[152:155], v[204:207], v[92:95]
    ds_read_b64 v[220:221], v237 offset:34048
    v_mfma_f32_16x16x32_bf16 v[88:91], v[152:155], v[200:203], v[88:91]
    ds_read_b64 v[222:223], v237 offset:38656
    v_mfma_f32_16x16x32_bf16 v[84:87], v[152:155], v[196:199], v[84:87]
    ds_read_b64 v[224:225], v237 offset:34176
    v_mfma_f32_16x16x32_bf16 v[36:39], v[140:143], v[196:199], v[36:39]
    ds_read_b64 v[226:227], v237 offset:38784
    v_mfma_f32_16x16x32_bf16 v[40:43], v[140:143], v[200:203], v[40:43]
    ds_read_b64_tr_b16 v[180:181], v232 offset:41984
    v_mfma_f32_16x16x32_bf16 v[44:47], v[140:143], v[204:207], v[44:47]
    ds_read_b64_tr_b16 v[182:183], v232 offset:46080
    v_mfma_f32_16x16x32_bf16 v[48:51], v[140:143], v[208:211], v[48:51]
    ds_read_b64_tr_b16 v[168:169], v233 offset:33792
    v_mfma_f32_16x16x32_bf16 v[112:115], v[156:159], v[208:211], v[112:115]
    ds_read_b64_tr_b16 v[170:171], v233 offset:37888
    v_mfma_f32_16x16x32_bf16 v[108:111], v[156:159], v[204:207], v[108:111]
    ds_read_b64_tr_b16 v[184:185], v233 offset:41984
    v_mfma_f32_16x16x32_bf16 v[104:107], v[156:159], v[200:203], v[104:107]
    ds_read_b64_tr_b16 v[186:187], v233 offset:46080
    v_mfma_f32_16x16x32_bf16 v[100:103], v[156:159], v[196:199], v[100:103]
    ds_read_b64_tr_b16 v[172:173], v234 offset:33792
    v_mfma_f32_16x16x32_bf16 v[52:55], v[144:147], v[196:199], v[52:55]
    ds_read_b64_tr_b16 v[174:175], v234 offset:37888
    v_mfma_f32_16x16x32_bf16 v[56:59], v[144:147], v[200:203], v[56:59]
    ds_read_b64_tr_b16 v[188:189], v234 offset:41984
    v_mfma_f32_16x16x32_bf16 v[60:63], v[144:147], v[204:207], v[60:63]
    ds_read_b64_tr_b16 v[190:191], v234 offset:46080
    v_mfma_f32_16x16x32_bf16 v[64:67], v[144:147], v[208:211], v[64:67]
    ds_read_b64_tr_b16 v[176:177], v235 offset:33792
    v_mfma_f32_16x16x32_bf16 v[128:131], v[160:163], v[208:211], v[128:131]
    ds_read_b64_tr_b16 v[178:179], v235 offset:37888
    v_mfma_f32_16x16x32_bf16 v[124:127], v[160:163], v[204:207], v[124:127]
    ds_read_b64_tr_b16 v[192:193], v235 offset:41984
    v_mfma_f32_16x16x32_bf16 v[120:123], v[160:163], v[200:203], v[120:123]
    ds_read_b64_tr_b16 v[194:195], v235 offset:46080
    v_mfma_f32_16x16x32_bf16 v[116:119], v[160:163], v[196:199], v[116:119]
    s_waitcnt lgkmcnt(14)
    v_mfma_f32_16x16x32_bf16 v[4:7], v[164:167], v[212:215], v[4:7]
    v_mfma_f32_16x16x32_bf16 v[8:11], v[164:167], v[216:219], v[8:11]
    v_mfma_f32_16x16x32_bf16 v[12:15], v[164:167], v[220:223], v[12:15]
    v_mfma_f32_16x16x32_bf16 v[16:19], v[164:167], v[224:227], v[16:19]
    s_waitcnt lgkmcnt(0)
    v_mfma_f32_16x16x32_bf16 v[80:83], v[180:183], v[224:227], v[80:83]
    v_mfma_f32_16x16x32_bf16 v[76:79], v[180:183], v[220:223], v[76:79]
    v_mfma_f32_16x16x32_bf16 v[72:75], v[180:183], v[216:219], v[72:75]
    s_barrier
    v_mfma_f32_16x16x32_bf16 v[68:71], v[180:183], v[212:215], v[68:71]
    ds_read_b64 v[196:197], v236 offset:0
    v_mfma_f32_16x16x32_bf16 v[20:23], v[168:171], v[212:215], v[20:23]
    ds_read_b64 v[198:199], v236 offset:4608
    v_mfma_f32_16x16x32_bf16 v[24:27], v[168:171], v[216:219], v[24:27]
    ds_read_b64_tr_b16 v[132:133], v228 offset:0
    v_mfma_f32_16x16x32_bf16 v[28:31], v[168:171], v[220:223], v[28:31]
    ds_read_b64_tr_b16 v[134:135], v228 offset:4096
    v_mfma_f32_16x16x32_bf16 v[32:35], v[168:171], v[224:227], v[32:35]
    ds_read_b64 v[200:201], v236 offset:128
    v_mfma_f32_16x16x32_bf16 v[96:99], v[184:187], v[224:227], v[96:99]
    ds_read_b64 v[202:203], v236 offset:4736
    v_mfma_f32_16x16x32_bf16 v[92:95], v[184:187], v[220:223], v[92:95]
    ds_read_b64 v[204:205], v236 offset:256
    v_mfma_f32_16x16x32_bf16 v[88:91], v[184:187], v[216:219], v[88:91]
    ds_read_b64 v[206:207], v236 offset:4864
    v_mfma_f32_16x16x32_bf16 v[84:87], v[184:187], v[212:215], v[84:87]
    ds_read_b64 v[208:209], v236 offset:384
    v_mfma_f32_16x16x32_bf16 v[36:39], v[172:175], v[212:215], v[36:39]
    ds_read_b64 v[210:211], v236 offset:4992
    v_mfma_f32_16x16x32_bf16 v[40:43], v[172:175], v[216:219], v[40:43]
    ds_read_b64_tr_b16 v[148:149], v228 offset:8192
    v_mfma_f32_16x16x32_bf16 v[44:47], v[172:175], v[220:223], v[44:47]
    ds_read_b64_tr_b16 v[150:151], v228 offset:12288
    v_mfma_f32_16x16x32_bf16 v[48:51], v[172:175], v[224:227], v[48:51]
    ds_read_b64_tr_b16 v[136:137], v229 offset:0
    v_mfma_f32_16x16x32_bf16 v[112:115], v[188:191], v[224:227], v[112:115]
    ds_read_b64_tr_b16 v[138:139], v229 offset:4096
    v_mfma_f32_16x16x32_bf16 v[108:111], v[188:191], v[220:223], v[108:111]
    ds_read_b64_tr_b16 v[152:153], v229 offset:8192
    v_mfma_f32_16x16x32_bf16 v[104:107], v[188:191], v[216:219], v[104:107]
    ds_read_b64_tr_b16 v[154:155], v229 offset:12288
    v_mfma_f32_16x16x32_bf16 v[100:103], v[188:191], v[212:215], v[100:103]
    ds_read_b64_tr_b16 v[140:141], v230 offset:0
    v_mfma_f32_16x16x32_bf16 v[52:55], v[176:179], v[212:215], v[52:55]
    ds_read_b64_tr_b16 v[142:143], v230 offset:4096
    v_mfma_f32_16x16x32_bf16 v[56:59], v[176:179], v[216:219], v[56:59]
    ds_read_b64_tr_b16 v[156:157], v230 offset:8192
    v_mfma_f32_16x16x32_bf16 v[60:63], v[176:179], v[220:223], v[60:63]
    ds_read_b64_tr_b16 v[158:159], v230 offset:12288
    v_mfma_f32_16x16x32_bf16 v[64:67], v[176:179], v[224:227], v[64:67]
    ds_read_b64_tr_b16 v[144:145], v231 offset:0
    v_mfma_f32_16x16x32_bf16 v[128:131], v[192:195], v[224:227], v[128:131]
    ds_read_b64_tr_b16 v[146:147], v231 offset:4096
    v_mfma_f32_16x16x32_bf16 v[124:127], v[192:195], v[220:223], v[124:127]
    ds_read_b64_tr_b16 v[160:161], v231 offset:8192
    v_mfma_f32_16x16x32_bf16 v[120:123], v[192:195], v[216:219], v[120:123]
    ds_read_b64_tr_b16 v[162:163], v231 offset:12288
    v_mfma_f32_16x16x32_bf16 v[116:119], v[192:195], v[212:215], v[116:119]
    s_waitcnt lgkmcnt(14)
    v_mfma_f32_16x16x32_bf16 v[4:7], v[132:135], v[196:199], v[4:7]
    v_mfma_f32_16x16x32_bf16 v[8:11], v[132:135], v[200:203], v[8:11]
    v_mfma_f32_16x16x32_bf16 v[12:15], v[132:135], v[204:207], v[12:15]
    v_mfma_f32_16x16x32_bf16 v[16:19], v[132:135], v[208:211], v[16:19]
    s_waitcnt lgkmcnt(0)
    v_mfma_f32_16x16x32_bf16 v[80:83], v[148:151], v[208:211], v[80:83]
    v_mfma_f32_16x16x32_bf16 v[76:79], v[148:151], v[204:207], v[76:79]
    v_mfma_f32_16x16x32_bf16 v[72:75], v[148:151], v[200:203], v[72:75]
    s_barrier
    v_mfma_f32_16x16x32_bf16 v[68:71], v[148:151], v[196:199], v[68:71]
    ds_read_b64 v[212:213], v236 offset:33792
    v_mfma_f32_16x16x32_bf16 v[20:23], v[136:139], v[196:199], v[20:23]
    ds_read_b64 v[214:215], v236 offset:38400
    v_mfma_f32_16x16x32_bf16 v[24:27], v[136:139], v[200:203], v[24:27]
    ds_read_b64_tr_b16 v[164:165], v228 offset:33792
    v_mfma_f32_16x16x32_bf16 v[28:31], v[136:139], v[204:207], v[28:31]
    ds_read_b64_tr_b16 v[166:167], v228 offset:37888
    v_mfma_f32_16x16x32_bf16 v[32:35], v[136:139], v[208:211], v[32:35]
    ds_read_b64 v[216:217], v236 offset:33920
    v_mfma_f32_16x16x32_bf16 v[96:99], v[152:155], v[208:211], v[96:99]
    ds_read_b64 v[218:219], v236 offset:38528
    v_mfma_f32_16x16x32_bf16 v[92:95], v[152:155], v[204:207], v[92:95]
    ds_read_b64 v[220:221], v236 offset:34048
    v_mfma_f32_16x16x32_bf16 v[88:91], v[152:155], v[200:203], v[88:91]
    ds_read_b64 v[222:223], v236 offset:38656
    v_mfma_f32_16x16x32_bf16 v[84:87], v[152:155], v[196:199], v[84:87]
    ds_read_b64 v[224:225], v236 offset:34176
    v_mfma_f32_16x16x32_bf16 v[36:39], v[140:143], v[196:199], v[36:39]
    ds_read_b64 v[226:227], v236 offset:38784
    v_mfma_f32_16x16x32_bf16 v[40:43], v[140:143], v[200:203], v[40:43]
    ds_read_b64_tr_b16 v[180:181], v228 offset:41984
    v_mfma_f32_16x16x32_bf16 v[44:47], v[140:143], v[204:207], v[44:47]
    ds_read_b64_tr_b16 v[182:183], v228 offset:46080
    v_mfma_f32_16x16x32_bf16 v[48:51], v[140:143], v[208:211], v[48:51]
    ds_read_b64_tr_b16 v[168:169], v229 offset:33792
    v_mfma_f32_16x16x32_bf16 v[112:115], v[156:159], v[208:211], v[112:115]
    ds_read_b64_tr_b16 v[170:171], v229 offset:37888
    v_mfma_f32_16x16x32_bf16 v[108:111], v[156:159], v[204:207], v[108:111]
    ds_read_b64_tr_b16 v[184:185], v229 offset:41984
    v_mfma_f32_16x16x32_bf16 v[104:107], v[156:159], v[200:203], v[104:107]
    ds_read_b64_tr_b16 v[186:187], v229 offset:46080
    v_mfma_f32_16x16x32_bf16 v[100:103], v[156:159], v[196:199], v[100:103]
    ds_read_b64_tr_b16 v[172:173], v230 offset:33792
    v_mfma_f32_16x16x32_bf16 v[52:55], v[144:147], v[196:199], v[52:55]
    ds_read_b64_tr_b16 v[174:175], v230 offset:37888
    v_mfma_f32_16x16x32_bf16 v[56:59], v[144:147], v[200:203], v[56:59]
    ds_read_b64_tr_b16 v[188:189], v230 offset:41984
    v_mfma_f32_16x16x32_bf16 v[60:63], v[144:147], v[204:207], v[60:63]
    ds_read_b64_tr_b16 v[190:191], v230 offset:46080
    v_mfma_f32_16x16x32_bf16 v[64:67], v[144:147], v[208:211], v[64:67]
    ds_read_b64_tr_b16 v[176:177], v231 offset:33792
    v_mfma_f32_16x16x32_bf16 v[128:131], v[160:163], v[208:211], v[128:131]
    ds_read_b64_tr_b16 v[178:179], v231 offset:37888
    v_mfma_f32_16x16x32_bf16 v[124:127], v[160:163], v[204:207], v[124:127]
    ds_read_b64_tr_b16 v[192:193], v231 offset:41984
    v_mfma_f32_16x16x32_bf16 v[120:123], v[160:163], v[200:203], v[120:123]
    ds_read_b64_tr_b16 v[194:195], v231 offset:46080
    v_mfma_f32_16x16x32_bf16 v[116:119], v[160:163], v[196:199], v[116:119]
    s_waitcnt lgkmcnt(14)
    v_mfma_f32_16x16x32_bf16 v[4:7], v[164:167], v[212:215], v[4:7]
    v_mfma_f32_16x16x32_bf16 v[8:11], v[164:167], v[216:219], v[8:11]
    v_mfma_f32_16x16x32_bf16 v[12:15], v[164:167], v[220:223], v[12:15]
    v_mfma_f32_16x16x32_bf16 v[16:19], v[164:167], v[224:227], v[16:19]
    s_waitcnt lgkmcnt(0)
    v_mfma_f32_16x16x32_bf16 v[80:83], v[180:183], v[224:227], v[80:83]
    v_mfma_f32_16x16x32_bf16 v[76:79], v[180:183], v[220:223], v[76:79]
    v_mfma_f32_16x16x32_bf16 v[72:75], v[180:183], v[216:219], v[72:75]
    s_barrier
    v_mfma_f32_16x16x32_bf16 v[68:71], v[180:183], v[212:215], v[68:71]
    ds_read_b64 v[196:197], v237 offset:0
    v_mfma_f32_16x16x32_bf16 v[20:23], v[168:171], v[212:215], v[20:23]
    ds_read_b64 v[198:199], v237 offset:4608
    v_mfma_f32_16x16x32_bf16 v[24:27], v[168:171], v[216:219], v[24:27]
    ds_read_b64_tr_b16 v[132:133], v232 offset:0
    v_mfma_f32_16x16x32_bf16 v[28:31], v[168:171], v[220:223], v[28:31]
    ds_read_b64_tr_b16 v[134:135], v232 offset:4096
    v_mfma_f32_16x16x32_bf16 v[32:35], v[168:171], v[224:227], v[32:35]
    ds_read_b64 v[200:201], v237 offset:128
    v_mfma_f32_16x16x32_bf16 v[96:99], v[184:187], v[224:227], v[96:99]
    ds_read_b64 v[202:203], v237 offset:4736
    v_mfma_f32_16x16x32_bf16 v[92:95], v[184:187], v[220:223], v[92:95]
    ds_read_b64 v[204:205], v237 offset:256
    v_mfma_f32_16x16x32_bf16 v[88:91], v[184:187], v[216:219], v[88:91]
    ds_read_b64 v[206:207], v237 offset:4864
    v_mfma_f32_16x16x32_bf16 v[84:87], v[184:187], v[212:215], v[84:87]
    ds_read_b64 v[208:209], v237 offset:384
    v_mfma_f32_16x16x32_bf16 v[36:39], v[172:175], v[212:215], v[36:39]
    ds_read_b64 v[210:211], v237 offset:4992
    v_mfma_f32_16x16x32_bf16 v[40:43], v[172:175], v[216:219], v[40:43]
    ds_read_b64_tr_b16 v[148:149], v232 offset:8192
    v_mfma_f32_16x16x32_bf16 v[44:47], v[172:175], v[220:223], v[44:47]
    ds_read_b64_tr_b16 v[150:151], v232 offset:12288
    v_mfma_f32_16x16x32_bf16 v[48:51], v[172:175], v[224:227], v[48:51]
    ds_read_b64_tr_b16 v[136:137], v233 offset:0
    v_mfma_f32_16x16x32_bf16 v[112:115], v[188:191], v[224:227], v[112:115]
    ds_read_b64_tr_b16 v[138:139], v233 offset:4096
    v_mfma_f32_16x16x32_bf16 v[108:111], v[188:191], v[220:223], v[108:111]
    ds_read_b64_tr_b16 v[152:153], v233 offset:8192
    v_mfma_f32_16x16x32_bf16 v[104:107], v[188:191], v[216:219], v[104:107]
    ds_read_b64_tr_b16 v[154:155], v233 offset:12288
    v_mfma_f32_16x16x32_bf16 v[100:103], v[188:191], v[212:215], v[100:103]
    ds_read_b64_tr_b16 v[140:141], v234 offset:0
    v_mfma_f32_16x16x32_bf16 v[52:55], v[176:179], v[212:215], v[52:55]
    ds_read_b64_tr_b16 v[142:143], v234 offset:4096
    v_mfma_f32_16x16x32_bf16 v[56:59], v[176:179], v[216:219], v[56:59]
    ds_read_b64_tr_b16 v[156:157], v234 offset:8192
    v_mfma_f32_16x16x32_bf16 v[60:63], v[176:179], v[220:223], v[60:63]
    ds_read_b64_tr_b16 v[158:159], v234 offset:12288
    v_mfma_f32_16x16x32_bf16 v[64:67], v[176:179], v[224:227], v[64:67]
    ds_read_b64_tr_b16 v[144:145], v235 offset:0
    v_mfma_f32_16x16x32_bf16 v[128:131], v[192:195], v[224:227], v[128:131]
    ds_read_b64_tr_b16 v[146:147], v235 offset:4096
    v_mfma_f32_16x16x32_bf16 v[124:127], v[192:195], v[220:223], v[124:127]
    ds_read_b64_tr_b16 v[160:161], v235 offset:8192
    v_mfma_f32_16x16x32_bf16 v[120:123], v[192:195], v[216:219], v[120:123]
    ds_read_b64_tr_b16 v[162:163], v235 offset:12288
    v_mfma_f32_16x16x32_bf16 v[116:119], v[192:195], v[212:215], v[116:119]
    s_waitcnt lgkmcnt(14)
    v_mfma_f32_16x16x32_bf16 v[4:7], v[132:135], v[196:199], v[4:7]
    v_mfma_f32_16x16x32_bf16 v[8:11], v[132:135], v[200:203], v[8:11]
    v_mfma_f32_16x16x32_bf16 v[12:15], v[132:135], v[204:207], v[12:15]
    v_mfma_f32_16x16x32_bf16 v[16:19], v[132:135], v[208:211], v[16:19]
    s_waitcnt lgkmcnt(0)
    v_mfma_f32_16x16x32_bf16 v[80:83], v[148:151], v[208:211], v[80:83]
    v_mfma_f32_16x16x32_bf16 v[76:79], v[148:151], v[204:207], v[76:79]
    v_mfma_f32_16x16x32_bf16 v[72:75], v[148:151], v[200:203], v[72:75]
    s_barrier
    v_mfma_f32_16x16x32_bf16 v[68:71], v[148:151], v[196:199], v[68:71]
    ds_read_b64 v[212:213], v237 offset:33792
    v_mfma_f32_16x16x32_bf16 v[20:23], v[136:139], v[196:199], v[20:23]
    ds_read_b64 v[214:215], v237 offset:38400
    v_mfma_f32_16x16x32_bf16 v[24:27], v[136:139], v[200:203], v[24:27]
    ds_read_b64_tr_b16 v[164:165], v232 offset:33792
    v_mfma_f32_16x16x32_bf16 v[28:31], v[136:139], v[204:207], v[28:31]
    ds_read_b64_tr_b16 v[166:167], v232 offset:37888
    v_mfma_f32_16x16x32_bf16 v[32:35], v[136:139], v[208:211], v[32:35]
    ds_read_b64 v[216:217], v237 offset:33920
    v_mfma_f32_16x16x32_bf16 v[96:99], v[152:155], v[208:211], v[96:99]
    ds_read_b64 v[218:219], v237 offset:38528
    v_mfma_f32_16x16x32_bf16 v[92:95], v[152:155], v[204:207], v[92:95]
    ds_read_b64 v[220:221], v237 offset:34048
    v_mfma_f32_16x16x32_bf16 v[88:91], v[152:155], v[200:203], v[88:91]
    ds_read_b64 v[222:223], v237 offset:38656
    v_mfma_f32_16x16x32_bf16 v[84:87], v[152:155], v[196:199], v[84:87]
    ds_read_b64 v[224:225], v237 offset:34176
    v_mfma_f32_16x16x32_bf16 v[36:39], v[140:143], v[196:199], v[36:39]
    ds_read_b64 v[226:227], v237 offset:38784
    v_mfma_f32_16x16x32_bf16 v[40:43], v[140:143], v[200:203], v[40:43]
    ds_read_b64_tr_b16 v[180:181], v232 offset:41984
    v_mfma_f32_16x16x32_bf16 v[44:47], v[140:143], v[204:207], v[44:47]
    ds_read_b64_tr_b16 v[182:183], v232 offset:46080
    v_mfma_f32_16x16x32_bf16 v[48:51], v[140:143], v[208:211], v[48:51]
    ds_read_b64_tr_b16 v[168:169], v233 offset:33792
    v_mfma_f32_16x16x32_bf16 v[112:115], v[156:159], v[208:211], v[112:115]
    ds_read_b64_tr_b16 v[170:171], v233 offset:37888
    v_mfma_f32_16x16x32_bf16 v[108:111], v[156:159], v[204:207], v[108:111]
    ds_read_b64_tr_b16 v[184:185], v233 offset:41984
    v_mfma_f32_16x16x32_bf16 v[104:107], v[156:159], v[200:203], v[104:107]
    ds_read_b64_tr_b16 v[186:187], v233 offset:46080
    v_mfma_f32_16x16x32_bf16 v[100:103], v[156:159], v[196:199], v[100:103]
    ds_read_b64_tr_b16 v[172:173], v234 offset:33792
    v_mfma_f32_16x16x32_bf16 v[52:55], v[144:147], v[196:199], v[52:55]
    ds_read_b64_tr_b16 v[174:175], v234 offset:37888
    v_mfma_f32_16x16x32_bf16 v[56:59], v[144:147], v[200:203], v[56:59]
    ds_read_b64_tr_b16 v[188:189], v234 offset:41984
    v_mfma_f32_16x16x32_bf16 v[60:63], v[144:147], v[204:207], v[60:63]
    ds_read_b64_tr_b16 v[190:191], v234 offset:46080
    v_mfma_f32_16x16x32_bf16 v[64:67], v[144:147], v[208:211], v[64:67]
    ds_read_b64_tr_b16 v[176:177], v235 offset:33792
    v_mfma_f32_16x16x32_bf16 v[128:131], v[160:163], v[208:211], v[128:131]
    ds_read_b64_tr_b16 v[178:179], v235 offset:37888
    v_mfma_f32_16x16x32_bf16 v[124:127], v[160:163], v[204:207], v[124:127]
    ds_read_b64_tr_b16 v[192:193], v235 offset:41984
    v_mfma_f32_16x16x32_bf16 v[120:123], v[160:163], v[200:203], v[120:123]
    ds_read_b64_tr_b16 v[194:195], v235 offset:46080
    v_mfma_f32_16x16x32_bf16 v[116:119], v[160:163], v[196:199], v[116:119]
    s_waitcnt lgkmcnt(14)
    v_mfma_f32_16x16x32_bf16 v[4:7], v[164:167], v[212:215], v[4:7]
    v_mfma_f32_16x16x32_bf16 v[8:11], v[164:167], v[216:219], v[8:11]
    v_mfma_f32_16x16x32_bf16 v[12:15], v[164:167], v[220:223], v[12:15]
    v_mfma_f32_16x16x32_bf16 v[16:19], v[164:167], v[224:227], v[16:19]
    s_waitcnt lgkmcnt(0)
    v_mfma_f32_16x16x32_bf16 v[80:83], v[180:183], v[224:227], v[80:83]
    v_mfma_f32_16x16x32_bf16 v[76:79], v[180:183], v[220:223], v[76:79]
    v_mfma_f32_16x16x32_bf16 v[72:75], v[180:183], v[216:219], v[72:75]
    v_mfma_f32_16x16x32_bf16 v[68:71], v[180:183], v[212:215], v[68:71]
    ds_read_b32 v242, v240 offset:0
    v_mfma_f32_16x16x32_bf16 v[20:23], v[168:171], v[212:215], v[20:23]
    ds_read_b32 v243, v240 offset:64
    v_mfma_f32_16x16x32_bf16 v[24:27], v[168:171], v[216:219], v[24:27]
    ds_read_b32 v244, v240 offset:128
    v_mfma_f32_16x16x32_bf16 v[28:31], v[168:171], v[220:223], v[28:31]
    ds_read_b32 v245, v240 offset:192
    v_mfma_f32_16x16x32_bf16 v[32:35], v[168:171], v[224:227], v[32:35]
    ds_read_b128 v[132:135], v239 offset:0
    v_mfma_f32_16x16x32_bf16 v[96:99], v[184:187], v[224:227], v[96:99]
    ds_read_b128 v[148:151], v239 offset:512
    v_mfma_f32_16x16x32_bf16 v[92:95], v[184:187], v[220:223], v[92:95]
    ds_read_b128 v[136:139], v239 offset:64
    v_mfma_f32_16x16x32_bf16 v[88:91], v[184:187], v[216:219], v[88:91]
    ds_read_b128 v[152:155], v239 offset:576
    v_mfma_f32_16x16x32_bf16 v[84:87], v[184:187], v[212:215], v[84:87]
    ds_read_b128 v[140:143], v239 offset:128
    v_mfma_f32_16x16x32_bf16 v[36:39], v[172:175], v[212:215], v[36:39]
    ds_read_b128 v[156:159], v239 offset:640
    v_mfma_f32_16x16x32_bf16 v[40:43], v[172:175], v[216:219], v[40:43]
    ds_read_b128 v[144:147], v239 offset:192
    v_mfma_f32_16x16x32_bf16 v[44:47], v[172:175], v[220:223], v[44:47]
    ds_read_b128 v[160:163], v239 offset:704
    v_mfma_f32_16x16x32_bf16 v[48:51], v[172:175], v[224:227], v[48:51]
    v_mfma_f32_16x16x32_bf16 v[112:115], v[188:191], v[224:227], v[112:115]
    v_mfma_f32_16x16x32_bf16 v[108:111], v[188:191], v[220:223], v[108:111]
    v_mfma_f32_16x16x32_bf16 v[104:107], v[188:191], v[216:219], v[104:107]
    v_mfma_f32_16x16x32_bf16 v[100:103], v[188:191], v[212:215], v[100:103]
    v_mfma_f32_16x16x32_bf16 v[52:55], v[176:179], v[212:215], v[52:55]
    v_mfma_f32_16x16x32_bf16 v[56:59], v[176:179], v[216:219], v[56:59]
    v_mfma_f32_16x16x32_bf16 v[60:63], v[176:179], v[220:223], v[60:63]
    v_mfma_f32_16x16x32_bf16 v[64:67], v[176:179], v[224:227], v[64:67]
    v_mfma_f32_16x16x32_bf16 v[128:131], v[192:195], v[224:227], v[128:131]
    v_mfma_f32_16x16x32_bf16 v[124:127], v[192:195], v[220:223], v[124:127]
    v_mfma_f32_16x16x32_bf16 v[120:123], v[192:195], v[216:219], v[120:123]
    v_mfma_f32_16x16x32_bf16 v[116:119], v[192:195], v[212:215], v[116:119]
L_g1epi:
L_wg1_0_0:
    s_cbranch_execz L_wg1_0_1
    s_cmp_eq_u32 s74, 27
    s_cbranch_scc1 L_g1none
    s_waitcnt lgkmcnt(0)
    v_pk_fma_f32 v[4:5], v[132:133], v[242:243], v[4:5] op_sel:[0,0,0] op_sel_hi:[1,0,1] neg_lo:[1,0,0] neg_hi:[1,0,0]
    v_pk_fma_f32 v[6:7], v[134:135], v[242:243], v[6:7] op_sel:[0,0,0] op_sel_hi:[1,0,1] neg_lo:[1,0,0] neg_hi:[1,0,0]
    v_pk_fma_f32 v[68:69], v[148:149], v[242:243], v[68:69] op_sel:[0,0,0] op_sel_hi:[1,0,1] neg_lo:[1,0,0] neg_hi:[1,0,0]
    v_pk_fma_f32 v[70:71], v[150:151], v[242:243], v[70:71] op_sel:[0,0,0] op_sel_hi:[1,0,1] neg_lo:[1,0,0] neg_hi:[1,0,0]
    v_pk_fma_f32 v[8:9], v[132:133], v[242:243], v[8:9] op_sel:[0,1,0] op_sel_hi:[1,1,1] neg_lo:[1,0,0] neg_hi:[1,0,0]
    v_pk_fma_f32 v[10:11], v[134:135], v[242:243], v[10:11] op_sel:[0,1,0] op_sel_hi:[1,1,1] neg_lo:[1,0,0] neg_hi:[1,0,0]
    v_pk_fma_f32 v[72:73], v[148:149], v[242:243], v[72:73] op_sel:[0,1,0] op_sel_hi:[1,1,1] neg_lo:[1,0,0] neg_hi:[1,0,0]
    v_pk_fma_f32 v[74:75], v[150:151], v[242:243], v[74:75] op_sel:[0,1,0] op_sel_hi:[1,1,1] neg_lo:[1,0,0] neg_hi:[1,0,0]
    v_max_f32 v4, 0, v4
    v_max_f32 v5, 0, v5
    v_max_f32 v6, 0, v6
    v_max_f32 v7, 0, v7
    v_pk_mul_f32 v[4:5], v[4:5], v[68:69]
    v_pk_mul_f32 v[6:7], v[6:7], v[70:71]
    v_cvt_pk_bf16_f32 v164, v4, v5
    v_cvt_pk_bf16_f32 v165, v6, v7
    v_max_f32 v8, 0, v8
    v_max_f32 v9, 0, v9
    v_max_f32 v10, 0, v10
    v_max_f32 v11, 0, v11
    v_pk_mul_f32 v[8:9], v[8:9], v[72:73]
    v_pk_mul_f32 v[10:11], v[10:11], v[74:75]
    v_cvt_pk_bf16_f32 v166, v8, v9
    v_cvt_pk_bf16_f32 v167, v10, v11
    v_pk_fma_f32 v[12:13], v[132:133], v[244:245], v[12:13] op_sel:[0,0,0] op_sel_hi:[1,0,1] neg_lo:[1,0,0] neg_hi:[1,0,0]
    v_pk_fma_f32 v[14:15], v[134:135], v[244:245], v[14:15] op_sel:[0,0,0] op_sel_hi:[1,0,1] neg_lo:[1,0,0] neg_hi:[1,0,0]
    v_permlane16_swap_b32 v164, v166
    v_permlane16_swap_b32 v165, v167
    buffer_store_dwordx4 v[164:167], v238, s[28:31], s12 offen offset:0 sc1
    v_pk_fma_f32 v[76:77], v[148:149], v[244:245], v[76:77] op_sel:[0,0,0] op_sel_hi:[1,0,1] neg_lo:[1,0,0] neg_hi:[1,0,0]
    v_pk_fma_f32 v[78:79], v[150:151], v[244:245], v[78:79] op_sel:[0,0,0] op_sel_hi:[1,0,1] neg_lo:[1,0,0] neg_hi:[1,0,0]
    v_pk_fma_f32 v[16:17], v[132:133], v[244:245], v[16:17] op_sel:[0,1,0] op_sel_hi:[1,1,1] neg_lo:[1,0,0] neg_hi:[1,0,0]
    v_pk_fma_f32 v[18:19], v[134:135], v[244:245], v[18:19] op_sel:[0,1,0] op_sel_hi:[1,1,1] neg_lo:[1,0,0] neg_hi:[1,0,0]
    v_pk_fma_f32 v[80:81], v[148:149], v[244:245], v[80:81] op_sel:[0,1,0] op_sel_hi:[1,1,1] neg_lo:[1,0,0] neg_hi:[1,0,0]
    v_pk_fma_f32 v[82:83], v[150:151], v[244:245], v[82:83] op_sel:[0,1,0] op_sel_hi:[1,1,1] neg_lo:[1,0,0] neg_hi:[1,0,0]
L_wg1_0_1:
    s_cbranch_execz L_wretg1
    v_max_f32 v12, 0, v12
    v_max_f32 v13, 0, v13
    v_max_f32 v14, 0, v14
    v_max_f32 v15, 0, v15
    v_pk_mul_f32 v[12:13], v[12:13], v[76:77]
    v_pk_mul_f32 v[14:15], v[14:15], v[78:79]
    v_cvt_pk_bf16_f32 v168, v12, v13
    v_cvt_pk_bf16_f32 v169, v14, v15
    v_max_f32 v16, 0, v16
    v_max_f32 v17, 0, v17
    v_max_f32 v18, 0, v18
    v_max_f32 v19, 0, v19
    v_pk_mul_f32 v[16:17], v[16:17], v[80:81]
    v_pk_mul_f32 v[18:19], v[18:19], v[82:83]
    v_cvt_pk_bf16_f32 v170, v16, v17
    v_cvt_pk_bf16_f32 v171, v18, v19
    v_pk_fma_f32 v[20:21], v[136:137], v[242:243], v[20:21] op_sel:[0,0,0] op_sel_hi:[1,0,1] neg_lo:[1,0,0] neg_hi:[1,0,0]
    v_pk_fma_f32 v[22:23], v[138:139], v[242:243], v[22:23] op_sel:[0,0,0] op_sel_hi:[1,0,1] neg_lo:[1,0,0] neg_hi:[1,0,0]
    v_permlane16_swap_b32 v168, v170
    v_permlane16_swap_b32 v169, v171
    buffer_store_dwordx4 v[168:171], v238, s[28:31], s12 offen offset:512 sc1
    v_pk_fma_f32 v[84:85], v[152:153], v[242:243], v[84:85] op_sel:[0,0,0] op_sel_hi:[1,0,1] neg_lo:[1,0,0] neg_hi:[1,0,0]
    v_pk_fma_f32 v[86:87], v[154:155], v[242:243], v[86:87] op_sel:[0,0,0] op_sel_hi:[1,0,1] neg_lo:[1,0,0] neg_hi:[1,0,0]
    v_pk_fma_f32 v[24:25], v[136:137], v[242:243], v[24:25] op_sel:[0,1,0] op_sel_hi:[1,1,1] neg_lo:[1,0,0] neg_hi:[1,0,0]
    v_pk_fma_f32 v[26:27], v[138:139], v[242:243], v[26:27] op_sel:[0,1,0] op_sel_hi:[1,1,1] neg_lo:[1,0,0] neg_hi:[1,0,0]
    v_pk_fma_f32 v[88:89], v[152:153], v[242:243], v[88:89] op_sel:[0,1,0] op_sel_hi:[1,1,1] neg_lo:[1,0,0] neg_hi:[1,0,0]
    v_pk_fma_f32 v[90:91], v[154:155], v[242:243], v[90:91] op_sel:[0,1,0] op_sel_hi:[1,1,1] neg_lo:[1,0,0] neg_hi:[1,0,0]
    v_max_f32 v20, 0, v20
    v_max_f32 v21, 0, v21
    v_max_f32 v22, 0, v22
    v_max_f32 v23, 0, v23
    v_pk_mul_f32 v[20:21], v[20:21], v[84:85]
    v_pk_mul_f32 v[22:23], v[22:23], v[86:87]
    v_cvt_pk_bf16_f32 v172, v20, v21
    v_cvt_pk_bf16_f32 v173, v22, v23
    v_max_f32 v24, 0, v24
    v_max_f32 v25, 0, v25
    v_max_f32 v26, 0, v26
    v_max_f32 v27, 0, v27
    v_pk_mul_f32 v[24:25], v[24:25], v[88:89]
    v_pk_mul_f32 v[26:27], v[26:27], v[90:91]
L_wg1_1_0:
    s_cbranch_execz L_wretg1
    v_cvt_pk_bf16_f32 v174, v24, v25
    v_cvt_pk_bf16_f32 v175, v26, v27
    v_pk_fma_f32 v[28:29], v[136:137], v[244:245], v[28:29] op_sel:[0,0,0] op_sel_hi:[1,0,1] neg_lo:[1,0,0] neg_hi:[1,0,0]
    v_pk_fma_f32 v[30:31], v[138:139], v[244:245], v[30:31] op_sel:[0,0,0] op_sel_hi:[1,0,1] neg_lo:[1,0,0] neg_hi:[1,0,0]
    v_permlane16_swap_b32 v172, v174
    v_permlane16_swap_b32 v173, v175
    buffer_store_dwordx4 v[172:175], v238, s[28:31], s13 offen offset:0 sc1
    v_pk_fma_f32 v[92:93], v[152:153], v[244:245], v[92:93] op_sel:[0,0,0] op_sel_hi:[1,0,1] neg_lo:[1,0,0] neg_hi:[1,0,0]
    v_pk_fma_f32 v[94:95], v[154:155], v[244:245], v[94:95] op_sel:[0,0,0] op_sel_hi:[1,0,1] neg_lo:[1,0,0] neg_hi:[1,0,0]
    v_pk_fma_f32 v[32:33], v[136:137], v[244:245], v[32:33] op_sel:[0,1,0] op_sel_hi:[1,1,1] neg_lo:[1,0,0] neg_hi:[1,0,0]
    v_pk_fma_f32 v[34:35], v[138:139], v[244:245], v[34:35] op_sel:[0,1,0] op_sel_hi:[1,1,1] neg_lo:[1,0,0] neg_hi:[1,0,0]
    v_pk_fma_f32 v[96:97], v[152:153], v[244:245], v[96:97] op_sel:[0,1,0] op_sel_hi:[1,1,1] neg_lo:[1,0,0] neg_hi:[1,0,0]
    v_pk_fma_f32 v[98:99], v[154:155], v[244:245], v[98:99] op_sel:[0,1,0] op_sel_hi:[1,1,1] neg_lo:[1,0,0] neg_hi:[1,0,0]
    v_max_f32 v28, 0, v28
    v_max_f32 v29, 0, v29
    v_max_f32 v30, 0, v30
    v_max_f32 v31, 0, v31
    v_pk_mul_f32 v[28:29], v[28:29], v[92:93]
    v_pk_mul_f32 v[30:31], v[30:31], v[94:95]
    v_cvt_pk_bf16_f32 v176, v28, v29
    v_cvt_pk_bf16_f32 v177, v30, v31
    v_max_f32 v32, 0, v32
    v_max_f32 v33, 0, v33
    v_max_f32 v34, 0, v34
    v_max_f32 v35, 0, v35
    v_pk_mul_f32 v[32:33], v[32:33], v[96:97]
    v_pk_mul_f32 v[34:35], v[34:35], v[98:99]
    v_cvt_pk_bf16_f32 v178, v32, v33
    v_cvt_pk_bf16_f32 v179, v34, v35
    v_pk_fma_f32 v[36:37], v[140:141], v[242:243], v[36:37] op_sel:[0,0,0] op_sel_hi:[1,0,1] neg_lo:[1,0,0] neg_hi:[1,0,0]
    v_pk_fma_f32 v[38:39], v[142:143], v[242:243], v[38:39] op_sel:[0,0,0] op_sel_hi:[1,0,1] neg_lo:[1,0,0] neg_hi:[1,0,0]
    v_permlane16_swap_b32 v176, v178
    v_permlane16_swap_b32 v177, v179
    buffer_store_dwordx4 v[176:179], v238, s[28:31], s13 offen offset:512 sc1
    v_pk_fma_f32 v[100:101], v[156:157], v[242:243], v[100:101] op_sel:[0,0,0] op_sel_hi:[1,0,1] neg_lo:[1,0,0] neg_hi:[1,0,0]
    v_pk_fma_f32 v[102:103], v[158:159], v[242:243], v[102:103] op_sel:[0,0,0] op_sel_hi:[1,0,1] neg_lo:[1,0,0] neg_hi:[1,0,0]
    v_pk_fma_f32 v[40:41], v[140:141], v[242:243], v[40:41] op_sel:[0,1,0] op_sel_hi:[1,1,1] neg_lo:[1,0,0] neg_hi:[1,0,0]
    v_pk_fma_f32 v[42:43], v[142:143], v[242:243], v[42:43] op_sel:[0,1,0] op_sel_hi:[1,1,1] neg_lo:[1,0,0] neg_hi:[1,0,0]
L_wg1_2_0:
    s_cbranch_execz L_wg1_2_1
    v_pk_fma_f32 v[104:105], v[156:157], v[242:243], v[104:105] op_sel:[0,1,0] op_sel_hi:[1,1,1] neg_lo:[1,0,0] neg_hi:[1,0,0]
    v_pk_fma_f32 v[106:107], v[158:159], v[242:243], v[106:107] op_sel:[0,1,0] op_sel_hi:[1,1,1] neg_lo:[1,0,0] neg_hi:[1,0,0]
    v_max_f32 v36, 0, v36
    v_max_f32 v37, 0, v37
    v_max_f32 v38, 0, v38
    v_max_f32 v39, 0, v39
    v_pk_mul_f32 v[36:37], v[36:37], v[100:101]
    v_pk_mul_f32 v[38:39], v[38:39], v[102:103]
    v_cvt_pk_bf16_f32 v180, v36, v37
    v_cvt_pk_bf16_f32 v181, v38, v39
    v_max_f32 v40, 0, v40
    v_max_f32 v41, 0, v41
    v_max_f32 v42, 0, v42
    v_max_f32 v43, 0, v43
    v_pk_mul_f32 v[40:41], v[40:41], v[104:105]
    v_pk_mul_f32 v[42:43], v[42:43], v[106:107]
    v_cvt_pk_bf16_f32 v182, v40, v41
    v_cvt_pk_bf16_f32 v183, v42, v43
    v_pk_fma_f32 v[44:45], v[140:141], v[244:245], v[44:45] op_sel:[0,0,0] op_sel_hi:[1,0,1] neg_lo:[1,0,0] neg_hi:[1,0,0]
    v_pk_fma_f32 v[46:47], v[142:143], v[244:245], v[46:47] op_sel:[0,0,0] op_sel_hi:[1,0,1] neg_lo:[1,0,0] neg_hi:[1,0,0]
    v_permlane16_swap_b32 v180, v182
    v_permlane16_swap_b32 v181, v183
    buffer_store_dwordx4 v[180:183], v238, s[28:31], s14 offen offset:0 sc1
    v_pk_fma_f32 v[108:109], v[156:157], v[244:245], v[108:109] op_sel:[0,0,0] op_sel_hi:[1,0,1] neg_lo:[1,0,0] neg_hi:[1,0,0]
    v_pk_fma_f32 v[110:111], v[158:159], v[244:245], v[110:111] op_sel:[0,0,0] op_sel_hi:[1,0,1] neg_lo:[1,0,0] neg_hi:[1,0,0]
    v_pk_fma_f32 v[48:49], v[140:141], v[244:245], v[48:49] op_sel:[0,1,0] op_sel_hi:[1,1,1] neg_lo:[1,0,0] neg_hi:[1,0,0]
    v_pk_fma_f32 v[50:51], v[142:143], v[244:245], v[50:51] op_sel:[0,1,0] op_sel_hi:[1,1,1] neg_lo:[1,0,0] neg_hi:[1,0,0]
    v_pk_fma_f32 v[112:113], v[156:157], v[244:245], v[112:113] op_sel:[0,1,0] op_sel_hi:[1,1,1] neg_lo:[1,0,0] neg_hi:[1,0,0]
    v_pk_fma_f32 v[114:115], v[158:159], v[244:245], v[114:115] op_sel:[0,1,0] op_sel_hi:[1,1,1] neg_lo:[1,0,0] neg_hi:[1,0,0]
    v_max_f32 v44, 0, v44
    v_max_f32 v45, 0, v45
    v_max_f32 v46, 0, v46
    v_max_f32 v47, 0, v47
    v_pk_mul_f32 v[44:45], v[44:45], v[108:109]
    v_pk_mul_f32 v[46:47], v[46:47], v[110:111]
    v_cvt_pk_bf16_f32 v184, v44, v45
    v_cvt_pk_bf16_f32 v185, v46, v47
    v_max_f32 v48, 0, v48
    v_max_f32 v49, 0, v49
    v_max_f32 v50, 0, v50
L_wg1_2_1:
    s_cbranch_execz L_wretg1
    v_max_f32 v51, 0, v51
    v_pk_mul_f32 v[48:49], v[48:49], v[112:113]
    v_pk_mul_f32 v[50:51], v[50:51], v[114:115]
    v_cvt_pk_bf16_f32 v186, v48, v49
    v_cvt_pk_bf16_f32 v187, v50, v51
    v_pk_fma_f32 v[52:53], v[144:145], v[242:243], v[52:53] op_sel:[0,0,0] op_sel_hi:[1,0,1] neg_lo:[1,0,0] neg_hi:[1,0,0]
    v_pk_fma_f32 v[54:55], v[146:147], v[242:243], v[54:55] op_sel:[0,0,0] op_sel_hi:[1,0,1] neg_lo:[1,0,0] neg_hi:[1,0,0]
    v_permlane16_swap_b32 v184, v186
    v_permlane16_swap_b32 v185, v187
    buffer_store_dwordx4 v[184:187], v238, s[28:31], s14 offen offset:512 sc1
    v_pk_fma_f32 v[116:117], v[160:161], v[242:243], v[116:117] op_sel:[0,0,0] op_sel_hi:[1,0,1] neg_lo:[1,0,0] neg_hi:[1,0,0]
    v_pk_fma_f32 v[118:119], v[162:163], v[242:243], v[118:119] op_sel:[0,0,0] op_sel_hi:[1,0,1] neg_lo:[1,0,0] neg_hi:[1,0,0]
    v_pk_fma_f32 v[56:57], v[144:145], v[242:243], v[56:57] op_sel:[0,1,0] op_sel_hi:[1,1,1] neg_lo:[1,0,0] neg_hi:[1,0,0]
    v_pk_fma_f32 v[58:59], v[146:147], v[242:243], v[58:59] op_sel:[0,1,0] op_sel_hi:[1,1,1] neg_lo:[1,0,0] neg_hi:[1,0,0]
    v_pk_fma_f32 v[120:121], v[160:161], v[242:243], v[120:121] op_sel:[0,1,0] op_sel_hi:[1,1,1] neg_lo:[1,0,0] neg_hi:[1,0,0]
    v_pk_fma_f32 v[122:123], v[162:163], v[242:243], v[122:123] op_sel:[0,1,0] op_sel_hi:[1,1,1] neg_lo:[1,0,0] neg_hi:[1,0,0]
    v_max_f32 v52, 0, v52
    v_max_f32 v53, 0, v53
    v_max_f32 v54, 0, v54
    v_max_f32 v55, 0, v55
    v_pk_mul_f32 v[52:53], v[52:53], v[116:117]
    v_pk_mul_f32 v[54:55], v[54:55], v[118:119]
    v_cvt_pk_bf16_f32 v188, v52, v53
    v_cvt_pk_bf16_f32 v189, v54, v55
    v_max_f32 v56, 0, v56
    v_max_f32 v57, 0, v57
    v_max_f32 v58, 0, v58
    v_max_f32 v59, 0, v59
    v_pk_mul_f32 v[56:57], v[56:57], v[120:121]
    v_pk_mul_f32 v[58:59], v[58:59], v[122:123]
    v_cvt_pk_bf16_f32 v190, v56, v57
    v_cvt_pk_bf16_f32 v191, v58, v59
    v_pk_fma_f32 v[60:61], v[144:145], v[244:245], v[60:61] op_sel:[0,0,0] op_sel_hi:[1,0,1] neg_lo:[1,0,0] neg_hi:[1,0,0]
    v_pk_fma_f32 v[62:63], v[146:147], v[244:245], v[62:63] op_sel:[0,0,0] op_sel_hi:[1,0,1] neg_lo:[1,0,0] neg_hi:[1,0,0]
    v_permlane16_swap_b32 v188, v190
    v_permlane16_swap_b32 v189, v191
    buffer_store_dwordx4 v[188:191], v238, s[28:31], s15 offen offset:0 sc1
    v_pk_fma_f32 v[124:125], v[160:161], v[244:245], v[124:125] op_sel:[0,0,0] op_sel_hi:[1,0,1] neg_lo:[1,0,0] neg_hi:[1,0,0]
L_wg1_3_0:
    s_cbranch_execz L_wretg1
    v_pk_fma_f32 v[126:127], v[162:163], v[244:245], v[126:127] op_sel:[0,0,0] op_sel_hi:[1,0,1] neg_lo:[1,0,0] neg_hi:[1,0,0]
    v_pk_fma_f32 v[64:65], v[144:145], v[244:245], v[64:65] op_sel:[0,1,0] op_sel_hi:[1,1,1] neg_lo:[1,0,0] neg_hi:[1,0,0]
    v_pk_fma_f32 v[66:67], v[146:147], v[244:245], v[66:67] op_sel:[0,1,0] op_sel_hi:[1,1,1] neg_lo:[1,0,0] neg_hi:[1,0,0]
    v_pk_fma_f32 v[128:129], v[160:161], v[244:245], v[128:129] op_sel:[0,1,0] op_sel_hi:[1,1,1] neg_lo:[1,0,0] neg_hi:[1,0,0]
    v_pk_fma_f32 v[130:131], v[162:163], v[244:245], v[130:131] op_sel:[0,1,0] op_sel_hi:[1,1,1] neg_lo:[1,0,0] neg_hi:[1,0,0]
    v_max_f32 v60, 0, v60
    v_max_f32 v61, 0, v61
    v_max_f32 v62, 0, v62
    v_max_f32 v63, 0, v63
    v_pk_mul_f32 v[60:61], v[60:61], v[124:125]
    v_pk_mul_f32 v[62:63], v[62:63], v[126:127]
    v_cvt_pk_bf16_f32 v192, v60, v61
    v_cvt_pk_bf16_f32 v193, v62, v63
    v_max_f32 v64, 0, v64
    v_max_f32 v65, 0, v65
    v_max_f32 v66, 0, v66
    v_max_f32 v67, 0, v67
    v_pk_mul_f32 v[64:65], v[64:65], v[128:129]
    v_pk_mul_f32 v[66:67], v[66:67], v[130:131]
    v_cvt_pk_bf16_f32 v194, v64, v65
    v_cvt_pk_bf16_f32 v195, v66, v67
    s_lshl_b32 s4, s68, 1
    s_add_u32 s4, s4, s72
    s_mul_i32 s4, s4, 27
    s_add_u32 s4, s4, s74
    s_lshl_b32 s4, s4, 7
    s_add_u32 s4, s4, 327680
    v_permlane16_swap_b32 v192, v194
    v_permlane16_swap_b32 v193, v195
    buffer_store_dwordx4 v[192:195], v238, s[28:31], s15 offen offset:512 sc1
    v_mov_b32 v248, s34
    v_mov_b32 v249, 0
    s_waitcnt vmcnt(0)
    s_mov_b64 exec, 1
    buffer_store_dword v248, v249, s[28:31], s4 offen sc1
    s_mov_b64 exec, -1
L_g1none:
    s_barrier
L_g2:
    s_lshr_b32 s72, s3, 1
    s_and_b32 s73, s3, 1
    s_and_b32 s4, s2, 7
    s_lshl_b32 s76, s4, 2
    s_bfe_u32 s4, s2, 0x20003
    s_add_u32 s76, s76, s4
    s_lshr_b32 s78, s2, 5
    v_lshrrev_b32 v156, 4, v1
    v_and_b32 v157, 15, v1
    s_lshl_b32 s4, s76, 6
    s_lshl_b32 s5, s73, 5
    s_add_u32 s4, s4, s5
    s_lshl_b32 s5, s72, 4
    s_add_u32 s74, s4, s5
    v_add_u32 v157, s74, v157
    v_lshlrev_b32 v151, 15, v156
    v_lshl_add_u32 v151, v157, 4, v151
    v_xor_b32 v152, 256, v151
    s_mul_i32 s75, s72, 3538944
    s_add_u32 s75, s75, 4194304
    s_mul_i32 s4, s72, 10240
    v_lshl_add_u32 v148, v1, 4, s4
    v_add_u32 v149, 61440, v148
    v_add_u32 v150, 122880, v148
    s_mov_b32 s20, s62
    s_mov_b32 s21, s63
    s_mov_b32 s22, 2621440
    s_mov_b32 s23, 0x00020000
    v_mul_u32_u24 v173, 1280, v157
    v_lshl_add_u32 v172, v156, 3, v173
    s_mul_i32 s77, s78, 160
    v_and_b32 v158, 1, v156
    v_lshl_add_u32 v173, v158, 5, v173
    v_lshrrev_b32 v158, 1, v156
    v_lshl_add_u32 v173, v158, 4, v173
    s_xor_b32 s4, s3, 2
    s_mul_i32 s4, s4, 5120
    s_add_u32 s4, s4, 102400
    v_lshl_add_u32 v174, v1, 4, s4
    s_mul_i32 s4, s3, 5120
    s_add_u32 s4, s4, 102400
    v_lshl_add_u32 v175, v1, 4, s4
    v_lshlrev_b32 v178, 14, v156
    v_lshl_add_u32 v178, v157, 3, v178
    s_mul_i32 s4, s78, 327680
    s_add_u32 s4, s4, 1048576
    v_lshlrev_b32 v159, 3, v157
    buffer_load_dwordx2 v[160:161], v178, s[28:31], s4 offen sc1
    s_add_u32 s4, s4, 0x10000
    buffer_load_dwordx2 v[162:163], v178, s[28:31], s4 offen sc1
    s_add_u32 s4, s4, 0x10000
    buffer_load_dwordx2 v[164:165], v178, s[28:31], s4 offen sc1
    s_add_u32 s4, s4, 0x10000
    buffer_load_dwordx2 v[166:167], v178, s[28:31], s4 offen sc1
    s_add_u32 s4, s4, 0x10000
    buffer_load_dwordx2 v[168:169], v178, s[28:31], s4 offen sc1
    s_mov_b32 s18, 32768
    buffer_load_dwordx2 v[170:171], v159, s[28:31], s18 offen sc1
    s_cmp_lg_u32 s3, 0
    s_cbranch_scc1 L_mf_3
    s_mul_i32 s79, s76, 3456
    s_add_u32 s79, s79, 327680
    v_lshlrev_b32 v158, 7, v1
    s_cmp_lg_u32 s70, 0
    s_cbranch_scc1 L_mf_3_d
    v_mul_u32_u24 v177, 1792, v1
    s_mov_b32 s35, 0
    s_mov_b64 exec, 3
L_pl_4:
    buffer_load_dword v176, v177, s[28:31], s79 offen sc1
    s_add_u32 s35, s35, 1
    s_waitcnt vmcnt(0)
    v_cmp_eq_u32 vcc, s34, v176
    s_cmp_ge_u32 s35, 262144
    s_cbranch_scc1 L_pl_4_ok
    s_nop 1
    s_cbranch_vccnz L_pl_4_ok
    s_sleep 4
    s_branch L_pl_4
L_pl_4_ok:
    s_mov_b64 exec, -1
L_mf_3_d:
    s_sleep 2
    s_mov_b32 s35, 0
    s_mov_b32 s7, 0
    s_mov_b32 s6, 134217727
    v_mov_b32 v176, s34
L_pn_5:
    s_mov_b32 s5, s79
    s_mov_b64 exec, s[6:7]
    buffer_load_dword v176, v158, s[28:31], s5 offen sc1
    s_mov_b64 exec, -1
    s_add_u32 s35, s35, 1
    s_waitcnt vmcnt(0)
    v_xor_b32 v177, s34, v176
    v_cmp_ne_u32 vcc, 0, v177
    s_cmp_ge_u32 s35, 262144
    s_cbranch_scc1 L_pn_5_ok
    s_nop 1
    s_cbranch_vccz L_pn_5_ok
    s_sleep 1
    s_branch L_pn_5
L_pn_5_ok:
L_mf_3:
    s_mov_b32 s35, 0
L_sq_2:
    s_waitcnt vmcnt(0)
    v_cmp_ne_u32 vcc, s34, v171
    s_add_u32 s35, s35, 1
    s_cmp_ge_u32 s35, 262144
    s_cbranch_scc1 L_sq_2_ok
    s_cbranch_vccz L_sq_2_ok
    s_sleep 16
    buffer_load_dwordx2 v[170:171], v159, s[28:31], s18 offen sc1
    s_branch L_sq_2
L_sq_2_ok:
    s_barrier
    s_add_u32 s16, s75, 0
    s_add_u32 s17, s16, 0x20000
    buffer_load_dwordx4 v[84:87], v151, s[28:31], s16 offen sc1
    buffer_load_dwordx4 v[88:91], v152, s[28:31], s16 offen sc1
    buffer_load_dwordx4 v[92:95], v151, s[28:31], s17 offen sc1
    buffer_load_dwordx4 v[96:99], v152, s[28:31], s17 offen sc1
    s_add_u32 s16, s75, 262144
    s_add_u32 s17, s16, 0x20000
    buffer_load_dwordx4 v[100:103], v151, s[28:31], s16 offen sc1
    buffer_load_dwordx4 v[104:107], v152, s[28:31], s16 offen sc1
    buffer_load_dwordx4 v[108:111], v151, s[28:31], s17 offen sc1
    buffer_load_dwordx4 v[112:115], v152, s[28:31], s17 offen sc1
    s_add_u32 s16, s75, 524288
    s_add_u32 s17, s16, 0x20000
    buffer_load_dwordx4 v[116:119], v151, s[28:31], s16 offen sc1
    buffer_load_dwordx4 v[120:123], v152, s[28:31], s16 offen sc1
    buffer_load_dwordx4 v[124:127], v151, s[28:31], s17 offen sc1
    buffer_load_dwordx4 v[128:131], v152, s[28:31], s17 offen sc1
    ds_read_b128 v[44:47], v150 offset:20480
    ds_read_b128 v[48:51], v150 offset:21504
    ds_read_b128 v[52:55], v150 offset:22528
    ds_read_b128 v[56:59], v150 offset:23552
    ds_read_b128 v[60:63], v150 offset:24576
    s_waitcnt vmcnt(8) lgkmcnt(0)
    v_mfma_f32_16x16x32_bf16 v[4:7], v[44:47], v[84:87], 0
    s_add_u32 s16, s75, 786432
    s_add_u32 s17, s16, 0x20000
    v_mfma_f32_16x16x32_bf16 v[8:11], v[44:47], v[88:91], 0
    ds_read_b128 v[64:67], v150 offset:25600
    v_mfma_f32_16x16x32_bf16 v[12:15], v[48:51], v[84:87], 0
    ds_read_b128 v[68:71], v150 offset:26624
    v_mfma_f32_16x16x32_bf16 v[16:19], v[48:51], v[88:91], 0
    ds_read_b128 v[72:75], v150 offset:27648
    v_mfma_f32_16x16x32_bf16 v[20:23], v[52:55], v[84:87], 0
    ds_read_b128 v[76:79], v150 offset:28672
    v_mfma_f32_16x16x32_bf16 v[24:27], v[52:55], v[88:91], 0
    ds_read_b128 v[80:83], v150 offset:29696
    v_mfma_f32_16x16x32_bf16 v[28:31], v[56:59], v[84:87], 0
    buffer_load_dwordx4 v[132:135], v151, s[28:31], s16 offen sc1
    v_mfma_f32_16x16x32_bf16 v[32:35], v[56:59], v[88:91], 0
    buffer_load_dwordx4 v[136:139], v152, s[28:31], s16 offen sc1
    v_mfma_f32_16x16x32_bf16 v[36:39], v[60:63], v[84:87], 0
    buffer_load_dwordx4 v[140:143], v151, s[28:31], s17 offen sc1
    v_mfma_f32_16x16x32_bf16 v[40:43], v[60:63], v[88:91], 0
    buffer_load_dwordx4 v[144:147], v152, s[28:31], s17 offen sc1
    s_waitcnt lgkmcnt(0)
    v_mfma_f32_16x16x32_bf16 v[4:7], v[64:67], v[92:95], v[4:7]
    s_barrier
    v_mfma_f32_16x16x32_bf16 v[8:11], v[64:67], v[96:99], v[8:11]
    ds_read_b128 v[44:47], v148 offset:0
    v_mfma_f32_16x16x32_bf16 v[12:15], v[68:71], v[92:95], v[12:15]
    ds_read_b128 v[48:51], v148 offset:1024
    v_mfma_f32_16x16x32_bf16 v[16:19], v[68:71], v[96:99], v[16:19]
    ds_read_b128 v[52:55], v148 offset:2048
    v_mfma_f32_16x16x32_bf16 v[20:23], v[72:75], v[92:95], v[20:23]
    ds_read_b128 v[56:59], v148 offset:3072
    v_mfma_f32_16x16x32_bf16 v[24:27], v[72:75], v[96:99], v[24:27]
    ds_read_b128 v[60:63], v148 offset:4096
    v_mfma_f32_16x16x32_bf16 v[28:31], v[76:79], v[92:95], v[28:31]
    v_mfma_f32_16x16x32_bf16 v[32:35], v[76:79], v[96:99], v[32:35]
    v_mfma_f32_16x16x32_bf16 v[36:39], v[80:83], v[92:95], v[36:39]
    v_mfma_f32_16x16x32_bf16 v[40:43], v[80:83], v[96:99], v[40:43]
    s_waitcnt vmcnt(8) lgkmcnt(0)
    v_mfma_f32_16x16x32_bf16 v[4:7], v[44:47], v[100:103], v[4:7]
    s_add_u32 s16, s75, 1048576
    s_add_u32 s17, s16, 0x20000
    v_mfma_f32_16x16x32_bf16 v[8:11], v[44:47], v[104:107], v[8:11]
    ds_read_b128 v[64:67], v148 offset:5120
    v_mfma_f32_16x16x32_bf16 v[12:15], v[48:51], v[100:103], v[12:15]
    ds_read_b128 v[68:71], v148 offset:6144
    v_mfma_f32_16x16x32_bf16 v[16:19], v[48:51], v[104:107], v[16:19]
    ds_read_b128 v[72:75], v148 offset:7168
    v_mfma_f32_16x16x32_bf16 v[20:23], v[52:55], v[100:103], v[20:23]
    ds_read_b128 v[76:79], v148 offset:8192
    v_mfma_f32_16x16x32_bf16 v[24:27], v[52:55], v[104:107], v[24:27]
    ds_read_b128 v[80:83], v148 offset:9216
    v_mfma_f32_16x16x32_bf16 v[28:31], v[56:59], v[100:103], v[28:31]
    buffer_load_dwordx4 v[84:87], v151, s[28:31], s16 offen sc1
    v_mfma_f32_16x16x32_bf16 v[32:35], v[56:59], v[104:107], v[32:35]
    buffer_load_dwordx4 v[88:91], v152, s[28:31], s16 offen sc1
    v_mfma_f32_16x16x32_bf16 v[36:39], v[60:63], v[100:103], v[36:39]
    buffer_load_dwordx4 v[92:95], v151, s[28:31], s17 offen sc1
    v_mfma_f32_16x16x32_bf16 v[40:43], v[60:63], v[104:107], v[40:43]
    buffer_load_dwordx4 v[96:99], v152, s[28:31], s17 offen sc1
    s_waitcnt lgkmcnt(0)
    v_mfma_f32_16x16x32_bf16 v[4:7], v[64:67], v[108:111], v[4:7]
    s_barrier
    v_mfma_f32_16x16x32_bf16 v[8:11], v[64:67], v[112:115], v[8:11]
    ds_read_b128 v[44:47], v148 offset:20480
    v_mfma_f32_16x16x32_bf16 v[12:15], v[68:71], v[108:111], v[12:15]
    ds_read_b128 v[48:51], v148 offset:21504
    v_mfma_f32_16x16x32_bf16 v[16:19], v[68:71], v[112:115], v[16:19]
    ds_read_b128 v[52:55], v148 offset:22528
    v_mfma_f32_16x16x32_bf16 v[20:23], v[72:75], v[108:111], v[20:23]
    ds_read_b128 v[56:59], v148 offset:23552
    v_mfma_f32_16x16x32_bf16 v[24:27], v[72:75], v[112:115], v[24:27]
    ds_read_b128 v[60:63], v148 offset:24576
    v_mfma_f32_16x16x32_bf16 v[28:31], v[76:79], v[108:111], v[28:31]
    v_mfma_f32_16x16x32_bf16 v[32:35], v[76:79], v[112:115], v[32:35]
    v_mfma_f32_16x16x32_bf16 v[36:39], v[80:83], v[108:111], v[36:39]
    v_mfma_f32_16x16x32_bf16 v[40:43], v[80:83], v[112:115], v[40:43]
    s_waitcnt vmcnt(8) lgkmcnt(0)
    v_mfma_f32_16x16x32_bf16 v[4:7], v[44:47], v[116:119], v[4:7]
    s_add_u32 s16, s75, 1310720
    s_add_u32 s17, s16, 0x20000
    v_mfma_f32_16x16x32_bf16 v[8:11], v[44:47], v[120:123], v[8:11]
    ds_read_b128 v[64:67], v148 offset:25600
    v_mfma_f32_16x16x32_bf16 v[12:15], v[48:51], v[116:119], v[12:15]
    ds_read_b128 v[68:71], v148 offset:26624
    v_mfma_f32_16x16x32_bf16 v[16:19], v[48:51], v[120:123], v[16:19]
    ds_read_b128 v[72:75], v148 offset:27648
    v_mfma_f32_16x16x32_bf16 v[20:23], v[52:55], v[116:119], v[20:23]
    ds_read_b128 v[76:79], v148 offset:28672
    v_mfma_f32_16x16x32_bf16 v[24:27], v[52:55], v[120:123], v[24:27]
    ds_read_b128 v[80:83], v148 offset:29696
    v_mfma_f32_16x16x32_bf16 v[28:31], v[56:59], v[116:119], v[28:31]
    buffer_load_dwordx4 v[100:103], v151, s[28:31], s16 offen sc1
    v_mfma_f32_16x16x32_bf16 v[32:35], v[56:59], v[120:123], v[32:35]
    buffer_load_dwordx4 v[104:107], v152, s[28:31], s16 offen sc1
    v_mfma_f32_16x16x32_bf16 v[36:39], v[60:63], v[116:119], v[36:39]
    buffer_load_dwordx4 v[108:111], v151, s[28:31], s17 offen sc1
    v_mfma_f32_16x16x32_bf16 v[40:43], v[60:63], v[120:123], v[40:43]
    buffer_load_dwordx4 v[112:115], v152, s[28:31], s17 offen sc1
    s_waitcnt lgkmcnt(0)
    v_mfma_f32_16x16x32_bf16 v[4:7], v[64:67], v[124:127], v[4:7]
    s_barrier
    v_mfma_f32_16x16x32_bf16 v[8:11], v[64:67], v[128:131], v[8:11]
    ds_read_b128 v[44:47], v148 offset:40960
    v_mfma_f32_16x16x32_bf16 v[12:15], v[68:71], v[124:127], v[12:15]
    ds_read_b128 v[48:51], v148 offset:41984
    v_mfma_f32_16x16x32_bf16 v[16:19], v[68:71], v[128:131], v[16:19]
    ds_read_b128 v[52:55], v148 offset:43008
    v_mfma_f32_16x16x32_bf16 v[20:23], v[72:75], v[124:127], v[20:23]
    ds_read_b128 v[56:59], v148 offset:44032
    v_mfma_f32_16x16x32_bf16 v[24:27], v[72:75], v[128:131], v[24:27]
    ds_read_b128 v[60:63], v148 offset:45056
    v_mfma_f32_16x16x32_bf16 v[28:31], v[76:79], v[124:127], v[28:31]
    v_mfma_f32_16x16x32_bf16 v[32:35], v[76:79], v[128:131], v[32:35]
    v_mfma_f32_16x16x32_bf16 v[36:39], v[80:83], v[124:127], v[36:39]
    v_mfma_f32_16x16x32_bf16 v[40:43], v[80:83], v[128:131], v[40:43]
    s_waitcnt vmcnt(8) lgkmcnt(0)
    v_mfma_f32_16x16x32_bf16 v[4:7], v[44:47], v[132:135], v[4:7]
    s_add_u32 s16, s75, 1572864
    s_add_u32 s17, s16, 0x20000
    v_mfma_f32_16x16x32_bf16 v[8:11], v[44:47], v[136:139], v[8:11]
    ds_read_b128 v[64:67], v148 offset:46080
    v_mfma_f32_16x16x32_bf16 v[12:15], v[48:51], v[132:135], v[12:15]
    ds_read_b128 v[68:71], v148 offset:47104
    v_mfma_f32_16x16x32_bf16 v[16:19], v[48:51], v[136:139], v[16:19]
    ds_read_b128 v[72:75], v148 offset:48128
    v_mfma_f32_16x16x32_bf16 v[20:23], v[52:55], v[132:135], v[20:23]
    ds_read_b128 v[76:79], v148 offset:49152
    v_mfma_f32_16x16x32_bf16 v[24:27], v[52:55], v[136:139], v[24:27]
    ds_read_b128 v[80:83], v148 offset:50176
    v_mfma_f32_16x16x32_bf16 v[28:31], v[56:59], v[132:135], v[28:31]
    buffer_load_dwordx4 v[116:119], v151, s[28:31], s16 offen sc1
    v_mfma_f32_16x16x32_bf16 v[32:35], v[56:59], v[136:139], v[32:35]
    buffer_load_dwordx4 v[120:123], v152, s[28:31], s16 offen sc1
    v_mfma_f32_16x16x32_bf16 v[36:39], v[60:63], v[132:135], v[36:39]
    buffer_load_dwordx4 v[124:127], v151, s[28:31], s17 offen sc1
    v_mfma_f32_16x16x32_bf16 v[40:43], v[60:63], v[136:139], v[40:43]
    buffer_load_dwordx4 v[128:131], v152, s[28:31], s17 offen sc1
    s_waitcnt lgkmcnt(0)
    v_mfma_f32_16x16x32_bf16 v[4:7], v[64:67], v[140:143], v[4:7]
    s_barrier
    v_mfma_f32_16x16x32_bf16 v[8:11], v[64:67], v[144:147], v[8:11]
    ds_read_b128 v[44:47], v149 offset:0
    v_mfma_f32_16x16x32_bf16 v[12:15], v[68:71], v[140:143], v[12:15]
    ds_read_b128 v[48:51], v149 offset:1024
    v_mfma_f32_16x16x32_bf16 v[16:19], v[68:71], v[144:147], v[16:19]
    ds_read_b128 v[52:55], v149 offset:2048
    v_mfma_f32_16x16x32_bf16 v[20:23], v[72:75], v[140:143], v[20:23]
    ds_read_b128 v[56:59], v149 offset:3072
    v_mfma_f32_16x16x32_bf16 v[24:27], v[72:75], v[144:147], v[24:27]
    ds_read_b128 v[60:63], v149 offset:4096
    v_mfma_f32_16x16x32_bf16 v[28:31], v[76:79], v[140:143], v[28:31]
    v_mfma_f32_16x16x32_bf16 v[32:35], v[76:79], v[144:147], v[32:35]
    v_mfma_f32_16x16x32_bf16 v[36:39], v[80:83], v[140:143], v[36:39]
    v_mfma_f32_16x16x32_bf16 v[40:43], v[80:83], v[144:147], v[40:43]
    s_waitcnt vmcnt(8) lgkmcnt(0)
    v_mfma_f32_16x16x32_bf16 v[4:7], v[44:47], v[84:87], v[4:7]
    s_add_u32 s16, s75, 1835008
    s_add_u32 s17, s16, 0x20000
    v_mfma_f32_16x16x32_bf16 v[8:11], v[44:47], v[88:91], v[8:11]
    ds_read_b128 v[64:67], v149 offset:5120
    v_mfma_f32_16x16x32_bf16 v[12:15], v[48:51], v[84:87], v[12:15]
    ds_read_b128 v[68:71], v149 offset:6144
    v_mfma_f32_16x16x32_bf16 v[16:19], v[48:51], v[88:91], v[16:19]
    ds_read_b128 v[72:75], v149 offset:7168
    v_mfma_f32_16x16x32_bf16 v[20:23], v[52:55], v[84:87], v[20:23]
    ds_read_b128 v[76:79], v149 offset:8192
    v_mfma_f32_16x16x32_bf16 v[24:27], v[52:55], v[88:91], v[24:27]
    ds_read_b128 v[80:83], v149 offset:9216
    v_mfma_f32_16x16x32_bf16 v[28:31], v[56:59], v[84:87], v[28:31]
    buffer_load_dwordx4 v[132:135], v151, s[28:31], s16 offen sc1
    v_mfma_f32_16x16x32_bf16 v[32:35], v[56:59], v[88:91], v[32:35]
    buffer_load_dwordx4 v[136:139], v152, s[28:31], s16 offen sc1
    v_mfma_f32_16x16x32_bf16 v[36:39], v[60:63], v[84:87], v[36:39]
    buffer_load_dwordx4 v[140:143], v151, s[28:31], s17 offen sc1
    v_mfma_f32_16x16x32_bf16 v[40:43], v[60:63], v[88:91], v[40:43]
    buffer_load_dwordx4 v[144:147], v152, s[28:31], s17 offen sc1
    s_waitcnt lgkmcnt(0)
    v_mfma_f32_16x16x32_bf16 v[4:7], v[64:67], v[92:95], v[4:7]
    s_barrier
    v_mfma_f32_16x16x32_bf16 v[8:11], v[64:67], v[96:99], v[8:11]
    ds_read_b128 v[44:47], v149 offset:20480
    v_mfma_f32_16x16x32_bf16 v[12:15], v[68:71], v[92:95], v[12:15]
    ds_read_b128 v[48:51], v149 offset:21504
    v_mfma_f32_16x16x32_bf16 v[16:19], v[68:71], v[96:99], v[16:19]
    ds_read_b128 v[52:55], v149 offset:22528
    v_mfma_f32_16x16x32_bf16 v[20:23], v[72:75], v[92:95], v[20:23]
    ds_read_b128 v[56:59], v149 offset:23552
    v_mfma_f32_16x16x32_bf16 v[24:27], v[72:75], v[96:99], v[24:27]
    ds_read_b128 v[60:63], v149 offset:24576
    v_mfma_f32_16x16x32_bf16 v[28:31], v[76:79], v[92:95], v[28:31]
    v_mfma_f32_16x16x32_bf16 v[32:35], v[76:79], v[96:99], v[32:35]
    v_mfma_f32_16x16x32_bf16 v[36:39], v[80:83], v[92:95], v[36:39]
    v_mfma_f32_16x16x32_bf16 v[40:43], v[80:83], v[96:99], v[40:43]
    s_waitcnt vmcnt(8) lgkmcnt(0)
    v_mfma_f32_16x16x32_bf16 v[4:7], v[44:47], v[100:103], v[4:7]
    s_add_u32 s16, s75, 2097152
    s_add_u32 s17, s16, 0x20000
    v_mfma_f32_16x16x32_bf16 v[8:11], v[44:47], v[104:107], v[8:11]
    ds_read_b128 v[64:67], v149 offset:25600
    v_mfma_f32_16x16x32_bf16 v[12:15], v[48:51], v[100:103], v[12:15]
    ds_read_b128 v[68:71], v149 offset:26624
    v_mfma_f32_16x16x32_bf16 v[16:19], v[48:51], v[104:107], v[16:19]
    ds_read_b128 v[72:75], v149 offset:27648
    v_mfma_f32_16x16x32_bf16 v[20:23], v[52:55], v[100:103], v[20:23]
    ds_read_b128 v[76:79], v149 offset:28672
    v_mfma_f32_16x16x32_bf16 v[24:27], v[52:55], v[104:107], v[24:27]
    ds_read_b128 v[80:83], v149 offset:29696
    v_mfma_f32_16x16x32_bf16 v[28:31], v[56:59], v[100:103], v[28:31]
    buffer_load_dwordx4 v[84:87], v151, s[28:31], s16 offen sc1
    v_mfma_f32_16x16x32_bf16 v[32:35], v[56:59], v[104:107], v[32:35]
    buffer_load_dwordx4 v[88:91], v152, s[28:31], s16 offen sc1
    v_mfma_f32_16x16x32_bf16 v[36:39], v[60:63], v[100:103], v[36:39]
    buffer_load_dwordx4 v[92:95], v151, s[28:31], s17 offen sc1
    v_mfma_f32_16x16x32_bf16 v[40:43], v[60:63], v[104:107], v[40:43]
    buffer_load_dwordx4 v[96:99], v152, s[28:31], s17 offen sc1
    s_waitcnt lgkmcnt(0)
    v_mfma_f32_16x16x32_bf16 v[4:7], v[64:67], v[108:111], v[4:7]
    s_barrier
    v_mfma_f32_16x16x32_bf16 v[8:11], v[64:67], v[112:115], v[8:11]
    ds_read_b128 v[44:47], v149 offset:40960
    v_mfma_f32_16x16x32_bf16 v[12:15], v[68:71], v[108:111], v[12:15]
    ds_read_b128 v[48:51], v149 offset:41984
    v_mfma_f32_16x16x32_bf16 v[16:19], v[68:71], v[112:115], v[16:19]
    ds_read_b128 v[52:55], v149 offset:43008
    v_mfma_f32_16x16x32_bf16 v[20:23], v[72:75], v[108:111], v[20:23]
    ds_read_b128 v[56:59], v149 offset:44032
    v_mfma_f32_16x16x32_bf16 v[24:27], v[72:75], v[112:115], v[24:27]
    ds_read_b128 v[60:63], v149 offset:45056
    v_mfma_f32_16x16x32_bf16 v[28:31], v[76:79], v[108:111], v[28:31]
    v_mfma_f32_16x16x32_bf16 v[32:35], v[76:79], v[112:115], v[32:35]
    v_mfma_f32_16x16x32_bf16 v[36:39], v[80:83], v[108:111], v[36:39]
    v_mfma_f32_16x16x32_bf16 v[40:43], v[80:83], v[112:115], v[40:43]
    s_waitcnt vmcnt(8) lgkmcnt(0)
    v_mfma_f32_16x16x32_bf16 v[4:7], v[44:47], v[116:119], v[4:7]
    s_add_u32 s16, s75, 2359296
    s_add_u32 s17, s16, 0x20000
    v_mfma_f32_16x16x32_bf16 v[8:11], v[44:47], v[120:123], v[8:11]
    ds_read_b128 v[64:67], v149 offset:46080
    v_mfma_f32_16x16x32_bf16 v[12:15], v[48:51], v[116:119], v[12:15]
    ds_read_b128 v[68:71], v149 offset:47104
    v_mfma_f32_16x16x32_bf16 v[16:19], v[48:51], v[120:123], v[16:19]
    ds_read_b128 v[72:75], v149 offset:48128
    v_mfma_f32_16x16x32_bf16 v[20:23], v[52:55], v[116:119], v[20:23]
    ds_read_b128 v[76:79], v149 offset:49152
    v_mfma_f32_16x16x32_bf16 v[24:27], v[52:55], v[120:123], v[24:27]
    ds_read_b128 v[80:83], v149 offset:50176
    v_mfma_f32_16x16x32_bf16 v[28:31], v[56:59], v[116:119], v[28:31]
    buffer_load_dwordx4 v[100:103], v151, s[28:31], s16 offen sc1
    v_mfma_f32_16x16x32_bf16 v[32:35], v[56:59], v[120:123], v[32:35]
    buffer_load_dwordx4 v[104:107], v152, s[28:31], s16 offen sc1
    v_mfma_f32_16x16x32_bf16 v[36:39], v[60:63], v[116:119], v[36:39]
    buffer_load_dwordx4 v[108:111], v151, s[28:31], s17 offen sc1
    v_mfma_f32_16x16x32_bf16 v[40:43], v[60:63], v[120:123], v[40:43]
    buffer_load_dwordx4 v[112:115], v152, s[28:31], s17 offen sc1
    s_waitcnt lgkmcnt(0)
    v_mfma_f32_16x16x32_bf16 v[4:7], v[64:67], v[124:127], v[4:7]
    s_barrier
    v_mfma_f32_16x16x32_bf16 v[8:11], v[64:67], v[128:131], v[8:11]
    ds_read_b128 v[44:47], v150 offset:0
    v_mfma_f32_16x16x32_bf16 v[12:15], v[68:71], v[124:127], v[12:15]
    ds_read_b128 v[48:51], v150 offset:1024
    v_mfma_f32_16x16x32_bf16 v[16:19], v[68:71], v[128:131], v[16:19]
    ds_read_b128 v[52:55], v150 offset:2048
    v_mfma_f32_16x16x32_bf16 v[20:23], v[72:75], v[124:127], v[20:23]
    ds_read_b128 v[56:59], v150 offset:3072
    v_mfma_f32_16x16x32_bf16 v[24:27], v[72:75], v[128:131], v[24:27]
    ds_read_b128 v[60:63], v150 offset:4096
    v_mfma_f32_16x16x32_bf16 v[28:31], v[76:79], v[124:127], v[28:31]
    v_mfma_f32_16x16x32_bf16 v[32:35], v[76:79], v[128:131], v[32:35]
    v_mfma_f32_16x16x32_bf16 v[36:39], v[80:83], v[124:127], v[36:39]
    v_mfma_f32_16x16x32_bf16 v[40:43], v[80:83], v[128:131], v[40:43]
    s_waitcnt vmcnt(8) lgkmcnt(0)
    v_mfma_f32_16x16x32_bf16 v[4:7], v[44:47], v[132:135], v[4:7]
    s_add_u32 s16, s75, 2621440
    s_add_u32 s17, s16, 0x20000
    v_mfma_f32_16x16x32_bf16 v[8:11], v[44:47], v[136:139], v[8:11]
    ds_read_b128 v[64:67], v150 offset:5120
    v_mfma_f32_16x16x32_bf16 v[12:15], v[48:51], v[132:135], v[12:15]
    ds_read_b128 v[68:71], v150 offset:6144
    v_mfma_f32_16x16x32_bf16 v[16:19], v[48:51], v[136:139], v[16:19]
    ds_read_b128 v[72:75], v150 offset:7168
    v_mfma_f32_16x16x32_bf16 v[20:23], v[52:55], v[132:135], v[20:23]
    ds_read_b128 v[76:79], v150 offset:8192
    v_mfma_f32_16x16x32_bf16 v[24:27], v[52:55], v[136:139], v[24:27]
    ds_read_b128 v[80:83], v150 offset:9216
    v_mfma_f32_16x16x32_bf16 v[28:31], v[56:59], v[132:135], v[28:31]
    buffer_load_dwordx4 v[116:119], v151, s[28:31], s16 offen sc1
    v_mfma_f32_16x16x32_bf16 v[32:35], v[56:59], v[136:139], v[32:35]
    buffer_load_dwordx4 v[120:123], v152, s[28:31], s16 offen sc1
    v_mfma_f32_16x16x32_bf16 v[36:39], v[60:63], v[132:135], v[36:39]
    buffer_load_dwordx4 v[124:127], v151, s[28:31], s17 offen sc1
    v_mfma_f32_16x16x32_bf16 v[40:43], v[60:63], v[136:139], v[40:43]
    buffer_load_dwordx4 v[128:131], v152, s[28:31], s17 offen sc1
    s_waitcnt lgkmcnt(0)
    v_mfma_f32_16x16x32_bf16 v[4:7], v[64:67], v[140:143], v[4:7]
    s_barrier
    v_mfma_f32_16x16x32_bf16 v[8:11], v[64:67], v[144:147], v[8:11]
    ds_read_b128 v[44:47], v150 offset:20480
    v_mfma_f32_16x16x32_bf16 v[12:15], v[68:71], v[140:143], v[12:15]
    ds_read_b128 v[48:51], v150 offset:21504
    v_mfma_f32_16x16x32_bf16 v[16:19], v[68:71], v[144:147], v[16:19]
    ds_read_b128 v[52:55], v150 offset:22528
    v_mfma_f32_16x16x32_bf16 v[20:23], v[72:75], v[140:143], v[20:23]
    ds_read_b128 v[56:59], v150 offset:23552
    v_mfma_f32_16x16x32_bf16 v[24:27], v[72:75], v[144:147], v[24:27]
    ds_read_b128 v[60:63], v150 offset:24576
    v_mfma_f32_16x16x32_bf16 v[28:31], v[76:79], v[140:143], v[28:31]
    v_mfma_f32_16x16x32_bf16 v[32:35], v[76:79], v[144:147], v[32:35]
    v_mfma_f32_16x16x32_bf16 v[36:39], v[80:83], v[140:143], v[36:39]
    v_mfma_f32_16x16x32_bf16 v[40:43], v[80:83], v[144:147], v[40:43]
    s_waitcnt vmcnt(8) lgkmcnt(0)
    v_mfma_f32_16x16x32_bf16 v[4:7], v[44:47], v[84:87], v[4:7]
    s_add_u32 s16, s75, 2883584
    s_add_u32 s17, s16, 0x20000
    v_mfma_f32_16x16x32_bf16 v[8:11], v[44:47], v[88:91], v[8:11]
    ds_read_b128 v[64:67], v150 offset:25600
    v_mfma_f32_16x16x32_bf16 v[12:15], v[48:51], v[84:87], v[12:15]
    ds_read_b128 v[68:71], v150 offset:26624
    v_mfma_f32_16x16x32_bf16 v[16:19], v[48:51], v[88:91], v[16:19]
    ds_read_b128 v[72:75], v150 offset:27648
    v_mfma_f32_16x16x32_bf16 v[20:23], v[52:55], v[84:87], v[20:23]
    ds_read_b128 v[76:79], v150 offset:28672
    v_mfma_f32_16x16x32_bf16 v[24:27], v[52:55], v[88:91], v[24:27]
    ds_read_b128 v[80:83], v150 offset:29696
    v_mfma_f32_16x16x32_bf16 v[28:31], v[56:59], v[84:87], v[28:31]
    buffer_load_dwordx4 v[132:135], v151, s[28:31], s16 offen sc1
    v_mfma_f32_16x16x32_bf16 v[32:35], v[56:59], v[88:91], v[32:35]
    buffer_load_dwordx4 v[136:139], v152, s[28:31], s16 offen sc1
    v_mfma_f32_16x16x32_bf16 v[36:39], v[60:63], v[84:87], v[36:39]
    buffer_load_dwordx4 v[140:143], v151, s[28:31], s17 offen sc1
    v_mfma_f32_16x16x32_bf16 v[40:43], v[60:63], v[88:91], v[40:43]
    buffer_load_dwordx4 v[144:147], v152, s[28:31], s17 offen sc1
    s_waitcnt lgkmcnt(0)
    v_mfma_f32_16x16x32_bf16 v[4:7], v[64:67], v[92:95], v[4:7]
    s_barrier
    v_mfma_f32_16x16x32_bf16 v[8:11], v[64:67], v[96:99], v[8:11]
    ds_read_b128 v[44:47], v148 offset:0
    v_mfma_f32_16x16x32_bf16 v[12:15], v[68:71], v[92:95], v[12:15]
    ds_read_b128 v[48:51], v148 offset:1024
    v_mfma_f32_16x16x32_bf16 v[16:19], v[68:71], v[96:99], v[16:19]
    ds_read_b128 v[52:55], v148 offset:2048
    v_mfma_f32_16x16x32_bf16 v[20:23], v[72:75], v[92:95], v[20:23]
    ds_read_b128 v[56:59], v148 offset:3072
    v_mfma_f32_16x16x32_bf16 v[24:27], v[72:75], v[96:99], v[24:27]
    ds_read_b128 v[60:63], v148 offset:4096
    v_mfma_f32_16x16x32_bf16 v[28:31], v[76:79], v[92:95], v[28:31]
    v_mfma_f32_16x16x32_bf16 v[32:35], v[76:79], v[96:99], v[32:35]
    v_mfma_f32_16x16x32_bf16 v[36:39], v[80:83], v[92:95], v[36:39]
    v_mfma_f32_16x16x32_bf16 v[40:43], v[80:83], v[96:99], v[40:43]
    s_waitcnt vmcnt(8) lgkmcnt(0)
    v_mfma_f32_16x16x32_bf16 v[4:7], v[44:47], v[100:103], v[4:7]
    s_add_u32 s16, s75, 3145728
    s_add_u32 s17, s16, 0x20000
    v_mfma_f32_16x16x32_bf16 v[8:11], v[44:47], v[104:107], v[8:11]
    ds_read_b128 v[64:67], v148 offset:5120
    v_mfma_f32_16x16x32_bf16 v[12:15], v[48:51], v[100:103], v[12:15]
    ds_read_b128 v[68:71], v148 offset:6144
    v_mfma_f32_16x16x32_bf16 v[16:19], v[48:51], v[104:107], v[16:19]
    ds_read_b128 v[72:75], v148 offset:7168
    v_mfma_f32_16x16x32_bf16 v[20:23], v[52:55], v[100:103], v[20:23]
    ds_read_b128 v[76:79], v148 offset:8192
    v_mfma_f32_16x16x32_bf16 v[24:27], v[52:55], v[104:107], v[24:27]
    ds_read_b128 v[80:83], v148 offset:9216
    v_mfma_f32_16x16x32_bf16 v[28:31], v[56:59], v[100:103], v[28:31]
    buffer_load_dwordx4 v[84:87], v151, s[28:31], s16 offen sc1
    v_mfma_f32_16x16x32_bf16 v[32:35], v[56:59], v[104:107], v[32:35]
    buffer_load_dwordx4 v[88:91], v152, s[28:31], s16 offen sc1
    v_mfma_f32_16x16x32_bf16 v[36:39], v[60:63], v[100:103], v[36:39]
    buffer_load_dwordx4 v[92:95], v151, s[28:31], s17 offen sc1
    v_mfma_f32_16x16x32_bf16 v[40:43], v[60:63], v[104:107], v[40:43]
    buffer_load_dwordx4 v[96:99], v152, s[28:31], s17 offen sc1
    s_waitcnt lgkmcnt(0)
    v_mfma_f32_16x16x32_bf16 v[4:7], v[64:67], v[108:111], v[4:7]
    s_barrier
    v_mfma_f32_16x16x32_bf16 v[8:11], v[64:67], v[112:115], v[8:11]
    ds_read_b128 v[44:47], v148 offset:20480
    v_mfma_f32_16x16x32_bf16 v[12:15], v[68:71], v[108:111], v[12:15]
    ds_read_b128 v[48:51], v148 offset:21504
    v_mfma_f32_16x16x32_bf16 v[16:19], v[68:71], v[112:115], v[16:19]
    ds_read_b128 v[52:55], v148 offset:22528
    v_mfma_f32_16x16x32_bf16 v[20:23], v[72:75], v[108:111], v[20:23]
    ds_read_b128 v[56:59], v148 offset:23552
    v_mfma_f32_16x16x32_bf16 v[24:27], v[72:75], v[112:115], v[24:27]
    ds_read_b128 v[60:63], v148 offset:24576
    v_mfma_f32_16x16x32_bf16 v[28:31], v[76:79], v[108:111], v[28:31]
    v_mfma_f32_16x16x32_bf16 v[32:35], v[76:79], v[112:115], v[32:35]
    v_mfma_f32_16x16x32_bf16 v[36:39], v[80:83], v[108:111], v[36:39]
    v_mfma_f32_16x16x32_bf16 v[40:43], v[80:83], v[112:115], v[40:43]
    s_waitcnt vmcnt(8) lgkmcnt(0)
    v_mfma_f32_16x16x32_bf16 v[4:7], v[44:47], v[116:119], v[4:7]
    s_add_u32 s16, s75, 3407872
    s_add_u32 s17, s16, 0x20000
    v_mfma_f32_16x16x32_bf16 v[8:11], v[44:47], v[120:123], v[8:11]
    ds_read_b128 v[64:67], v148 offset:25600
    v_mfma_f32_16x16x32_bf16 v[12:15], v[48:51], v[116:119], v[12:15]
    ds_read_b128 v[68:71], v148 offset:26624
    v_mfma_f32_16x16x32_bf16 v[16:19], v[48:51], v[120:123], v[16:19]
    ds_read_b128 v[72:75], v148 offset:27648
    v_mfma_f32_16x16x32_bf16 v[20:23], v[52:55], v[116:119], v[20:23]
    ds_read_b128 v[76:79], v148 offset:28672
    v_mfma_f32_16x16x32_bf16 v[24:27], v[52:55], v[120:123], v[24:27]
    ds_read_b128 v[80:83], v148 offset:29696
    v_mfma_f32_16x16x32_bf16 v[28:31], v[56:59], v[116:119], v[28:31]
    buffer_load_dwordx4 v[100:103], v151, s[28:31], s16 offen sc1
    v_mfma_f32_16x16x32_bf16 v[32:35], v[56:59], v[120:123], v[32:35]
    buffer_load_dwordx4 v[104:107], v152, s[28:31], s16 offen sc1
    v_mfma_f32_16x16x32_bf16 v[36:39], v[60:63], v[116:119], v[36:39]
    v_mfma_f32_16x16x32_bf16 v[40:43], v[60:63], v[120:123], v[40:43]
    s_waitcnt lgkmcnt(0)
    v_mfma_f32_16x16x32_bf16 v[4:7], v[64:67], v[124:127], v[4:7]
    s_barrier
    v_mfma_f32_16x16x32_bf16 v[8:11], v[64:67], v[128:131], v[8:11]
    ds_read_b128 v[44:47], v148 offset:40960
    v_and_b32 v170, 0xffff0000, v170
    v_mfma_f32_16x16x32_bf16 v[12:15], v[68:71], v[124:127], v[12:15]
    ds_read_b128 v[48:51], v148 offset:41984
    v_mul_f32 v170, v170, v170
    v_mfma_f32_16x16x32_bf16 v[16:19], v[68:71], v[128:131], v[16:19]
    ds_read_b128 v[52:55], v148 offset:43008
    v_rcp_f32 v170, v170
    v_mfma_f32_16x16x32_bf16 v[20:23], v[72:75], v[124:127], v[20:23]
    ds_read_b128 v[56:59], v148 offset:44032
    ds_read_b128 v[60:63], v148 offset:45056
    v_mfma_f32_16x16x32_bf16 v[24:27], v[72:75], v[128:131], v[24:27]
    v_mfma_f32_16x16x32_bf16 v[28:31], v[76:79], v[124:127], v[28:31]
    v_mfma_f32_16x16x32_bf16 v[32:35], v[76:79], v[128:131], v[32:35]
    v_mfma_f32_16x16x32_bf16 v[36:39], v[80:83], v[124:127], v[36:39]
    v_mfma_f32_16x16x32_bf16 v[40:43], v[80:83], v[128:131], v[40:43]
    s_waitcnt vmcnt(6) lgkmcnt(0)
    v_mfma_f32_16x16x32_bf16 v[4:7], v[44:47], v[132:135], v[4:7]
    ds_read_b128 v[64:67], v148 offset:46080
    v_mfma_f32_16x16x32_bf16 v[8:11], v[44:47], v[136:139], v[8:11]
    ds_read_b128 v[68:71], v148 offset:47104
    v_mfma_f32_16x16x32_bf16 v[12:15], v[48:51], v[132:135], v[12:15]
    ds_read_b128 v[72:75], v148 offset:48128
    v_mfma_f32_16x16x32_bf16 v[16:19], v[48:51], v[136:139], v[16:19]
    ds_read_b128 v[76:79], v148 offset:49152
    v_mfma_f32_16x16x32_bf16 v[20:23], v[52:55], v[132:135], v[20:23]
    ds_read_b128 v[80:83], v148 offset:50176
    v_mfma_f32_16x16x32_bf16 v[24:27], v[52:55], v[136:139], v[24:27]
    v_mfma_f32_16x16x32_bf16 v[28:31], v[56:59], v[132:135], v[28:31]
    v_mfma_f32_16x16x32_bf16 v[32:35], v[56:59], v[136:139], v[32:35]
    v_mfma_f32_16x16x32_bf16 v[36:39], v[60:63], v[132:135], v[36:39]
    v_mfma_f32_16x16x32_bf16 v[40:43], v[60:63], v[136:139], v[40:43]
    s_waitcnt lgkmcnt(0)
    v_mfma_f32_16x16x32_bf16 v[4:7], v[64:67], v[140:143], v[4:7]
    s_barrier
    v_mfma_f32_16x16x32_bf16 v[8:11], v[64:67], v[144:147], v[8:11]
    ds_read_b128 v[44:47], v149 offset:0
    v_lshlrev_b32 v180, 16, v160
    v_mfma_f32_16x16x32_bf16 v[12:15], v[68:71], v[140:143], v[12:15]
    ds_read_b128 v[48:51], v149 offset:1024
    v_and_b32 v181, 0xffff0000, v160
    v_mfma_f32_16x16x32_bf16 v[16:19], v[68:71], v[144:147], v[16:19]
    ds_read_b128 v[52:55], v149 offset:2048
    v_lshlrev_b32 v182, 16, v161
    v_mfma_f32_16x16x32_bf16 v[20:23], v[72:75], v[140:143], v[20:23]
    ds_read_b128 v[56:59], v149 offset:3072
    v_and_b32 v183, 0xffff0000, v161
    v_mfma_f32_16x16x32_bf16 v[24:27], v[72:75], v[144:147], v[24:27]
    ds_read_b128 v[60:63], v149 offset:4096
    v_lshlrev_b32 v184, 16, v162
    v_mfma_f32_16x16x32_bf16 v[28:31], v[76:79], v[140:143], v[28:31]
    v_and_b32 v185, 0xffff0000, v162
    v_lshlrev_b32 v186, 16, v163
    v_mfma_f32_16x16x32_bf16 v[32:35], v[76:79], v[144:147], v[32:35]
    v_and_b32 v187, 0xffff0000, v163
    v_lshlrev_b32 v188, 16, v164
    v_mfma_f32_16x16x32_bf16 v[36:39], v[80:83], v[140:143], v[36:39]
    v_and_b32 v189, 0xffff0000, v164
    v_mfma_f32_16x16x32_bf16 v[40:43], v[80:83], v[144:147], v[40:43]
    s_waitcnt vmcnt(2) lgkmcnt(0)
    v_mfma_f32_16x16x32_bf16 v[4:7], v[44:47], v[84:87], v[4:7]
    ds_read_b128 v[64:67], v149 offset:5120
    v_mfma_f32_16x16x32_bf16 v[8:11], v[44:47], v[88:91], v[8:11]
    ds_read_b128 v[68:71], v149 offset:6144
    v_mfma_f32_16x16x32_bf16 v[12:15], v[48:51], v[84:87], v[12:15]
    ds_read_b128 v[72:75], v149 offset:7168
    v_mfma_f32_16x16x32_bf16 v[16:19], v[48:51], v[88:91], v[16:19]
    ds_read_b128 v[76:79], v149 offset:8192
    v_mfma_f32_16x16x32_bf16 v[20:23], v[52:55], v[84:87], v[20:23]
    ds_read_b128 v[80:83], v149 offset:9216
    v_mfma_f32_16x16x32_bf16 v[24:27], v[52:55], v[88:91], v[24:27]
    v_mfma_f32_16x16x32_bf16 v[28:31], v[56:59], v[84:87], v[28:31]
    v_mfma_f32_16x16x32_bf16 v[32:35], v[56:59], v[88:91], v[32:35]
    v_mfma_f32_16x16x32_bf16 v[36:39], v[60:63], v[84:87], v[36:39]
    v_mfma_f32_16x16x32_bf16 v[40:43], v[60:63], v[88:91], v[40:43]
    s_waitcnt lgkmcnt(0)
    v_mfma_f32_16x16x32_bf16 v[4:7], v[64:67], v[92:95], v[4:7]
    s_barrier
    v_mfma_f32_16x16x32_bf16 v[8:11], v[64:67], v[96:99], v[8:11]
    ds_read_b128 v[44:47], v149 offset:20480
    v_lshlrev_b32 v190, 16, v165
    v_mfma_f32_16x16x32_bf16 v[12:15], v[68:71], v[92:95], v[12:15]
    ds_read_b128 v[48:51], v149 offset:21504
    v_and_b32 v191, 0xffff0000, v165
    v_mfma_f32_16x16x32_bf16 v[16:19], v[68:71], v[96:99], v[16:19]
    ds_read_b128 v[52:55], v149 offset:22528
    v_lshlrev_b32 v192, 16, v166
    v_mfma_f32_16x16x32_bf16 v[20:23], v[72:75], v[92:95], v[20:23]
    ds_read_b128 v[56:59], v149 offset:23552
    v_and_b32 v193, 0xffff0000, v166
    v_mfma_f32_16x16x32_bf16 v[24:27], v[72:75], v[96:99], v[24:27]
    ds_read_b128 v[60:63], v149 offset:24576
    v_lshlrev_b32 v194, 16, v167
    v_mfma_f32_16x16x32_bf16 v[28:31], v[76:79], v[92:95], v[28:31]
    v_and_b32 v195, 0xffff0000, v167
    v_lshlrev_b32 v196, 16, v168
    v_mfma_f32_16x16x32_bf16 v[32:35], v[76:79], v[96:99], v[32:35]
    v_and_b32 v197, 0xffff0000, v168
    v_lshlrev_b32 v198, 16, v169
    v_mfma_f32_16x16x32_bf16 v[36:39], v[80:83], v[92:95], v[36:39]
    v_and_b32 v199, 0xffff0000, v169
    v_mfma_f32_16x16x32_bf16 v[40:43], v[80:83], v[96:99], v[40:43]
    s_waitcnt vmcnt(0) lgkmcnt(0)
    v_mfma_f32_16x16x32_bf16 v[8:11], v[44:47], v[104:107], v[8:11]
    v_mfma_f32_16x16x32_bf16 v[16:19], v[48:51], v[104:107], v[16:19]
    v_mfma_f32_16x16x32_bf16 v[24:27], v[52:55], v[104:107], v[24:27]
    v_mfma_f32_16x16x32_bf16 v[32:35], v[56:59], v[104:107], v[32:35]
    v_mfma_f32_16x16x32_bf16 v[40:43], v[60:63], v[104:107], v[40:43]
    v_mfma_f32_16x16x32_bf16 v[4:7], v[44:47], v[100:103], v[4:7]
    v_mfma_f32_16x16x32_bf16 v[12:15], v[48:51], v[100:103], v[12:15]
    v_mfma_f32_16x16x32_bf16 v[20:23], v[52:55], v[100:103], v[20:23]
    v_mfma_f32_16x16x32_bf16 v[28:31], v[56:59], v[100:103], v[28:31]
    v_mfma_f32_16x16x32_bf16 v[36:39], v[60:63], v[100:103], v[36:39]
    ds_write_b128 v174, v[8:11] offset:0
    ds_write_b128 v174, v[16:19] offset:1024
    ds_write_b128 v174, v[24:27] offset:2048
    ds_write_b128 v174, v[32:35] offset:3072
    s_nop 0
    ds_write_b128 v174, v[40:43] offset:4096
    s_waitcnt lgkmcnt(0)
    s_barrier
    ds_read_b128 v[64:67], v175 offset:0
    ds_read_b128 v[68:71], v175 offset:1024
    ds_read_b128 v[72:75], v175 offset:2048
    ds_read_b128 v[76:79], v175 offset:3072
    ds_read_b128 v[80:83], v175 offset:4096
    s_waitcnt lgkmcnt(4)
    v_pk_add_f32 v[64:65], v[64:65], v[4:5]
    v_pk_add_f32 v[66:67], v[66:67], v[6:7]
    v_pk_fma_f32 v[64:65], v[64:65], v[170:171], v[180:181] op_sel_hi:[1,0,1]
    v_pk_fma_f32 v[66:67], v[66:67], v[170:171], v[182:183] op_sel_hi:[1,0,1]
    v_cvt_pk_bf16_f32 v160, v64, v65
    v_cvt_pk_bf16_f32 v161, v66, v67
    buffer_store_dwordx2 v[160:161], v172, s[20:23], s77 offen offset:0
    s_waitcnt lgkmcnt(3)
    v_pk_add_f32 v[68:69], v[68:69], v[12:13]
    v_pk_add_f32 v[70:71], v[70:71], v[14:15]
    v_pk_fma_f32 v[68:69], v[68:69], v[170:171], v[184:185] op_sel_hi:[1,0,1]
    v_pk_fma_f32 v[70:71], v[70:71], v[170:171], v[186:187] op_sel_hi:[1,0,1]
    v_cvt_pk_bf16_f32 v162, v68, v69
    v_cvt_pk_bf16_f32 v163, v70, v71
    buffer_store_dwordx2 v[162:163], v172, s[20:23], s77 offen offset:32
    s_waitcnt lgkmcnt(2)
    v_pk_add_f32 v[72:73], v[72:73], v[20:21]
    v_pk_add_f32 v[74:75], v[74:75], v[22:23]
    v_pk_fma_f32 v[72:73], v[72:73], v[170:171], v[188:189] op_sel_hi:[1,0,1]
    v_pk_fma_f32 v[74:75], v[74:75], v[170:171], v[190:191] op_sel_hi:[1,0,1]
    v_cvt_pk_bf16_f32 v164, v72, v73
    v_cvt_pk_bf16_f32 v165, v74, v75
    buffer_store_dwordx2 v[164:165], v172, s[20:23], s77 offen offset:64
    s_waitcnt lgkmcnt(1)
    v_pk_add_f32 v[76:77], v[76:77], v[28:29]
    v_pk_add_f32 v[78:79], v[78:79], v[30:31]
    v_pk_fma_f32 v[76:77], v[76:77], v[170:171], v[192:193] op_sel_hi:[1,0,1]
    v_pk_fma_f32 v[78:79], v[78:79], v[170:171], v[194:195] op_sel_hi:[1,0,1]
    v_cvt_pk_bf16_f32 v166, v76, v77
    v_cvt_pk_bf16_f32 v167, v78, v79
    buffer_store_dwordx2 v[166:167], v172, s[20:23], s77 offen offset:96
    s_waitcnt lgkmcnt(0)
    v_pk_add_f32 v[80:81], v[80:81], v[36:37]
    v_pk_add_f32 v[82:83], v[82:83], v[38:39]
    v_pk_fma_f32 v[80:81], v[80:81], v[170:171], v[196:197] op_sel_hi:[1,0,1]
    v_pk_fma_f32 v[82:83], v[82:83], v[170:171], v[198:199] op_sel_hi:[1,0,1]
    v_cvt_pk_bf16_f32 v168, v80, v81
    v_cvt_pk_bf16_f32 v169, v82, v83
    buffer_store_dwordx2 v[168:169], v172, s[20:23], s77 offen offset:128
    s_endpgm
L_g1idle:
    s_barrier
    s_barrier
    s_barrier
    s_barrier
    s_barrier
    s_barrier
    s_barrier
    s_barrier
    s_barrier
    s_barrier
    s_barrier
    s_barrier
    s_barrier
    s_barrier
    s_barrier
    s_barrier
    s_barrier
    s_barrier
    s_barrier
    s_barrier
    s_branch L_g1none
L_cold_ln1:
    s_waitcnt lgkmcnt(0)
    s_mov_b32 s28, s66
    s_mov_b32 s29, s67
    s_mov_b32 s30, 67108864
    s_mov_b32 s31, 0x00020000
    s_mov_b32 s24, s64
    s_mov_b32 s25, s65
    s_mov_b32 s26, 256
    s_mov_b32 s27, 0x00020000
    s_mov_b32 s6, 0x3f803f80
    v_mov_b32 v51, 0
    v_lshlrev_b32 v48, 3, v48
    v_mov_b32 v44, 0
    v_mov_b32 v45, 0
    v_mov_b32 v46, 0
    v_mov_b32 v47, 0
    s_waitcnt vmcnt(0)
    s_mov_b64 exec, 1
    buffer_load_dword v50, v51, s[24:27], 0 offen sc1
    s_mov_b64 exec, -1
    v_dot2c_f32_bf16 v44, s6, v4
    v_dot2c_f32_bf16 v46, v4, v4
    v_dot2c_f32_bf16 v45, s6, v5
    v_dot2c_f32_bf16 v47, v5, v5
    v_dot2c_f32_bf16 v44, s6, v6
    v_dot2c_f32_bf16 v46, v6, v6
    v_dot2c_f32_bf16 v45, s6, v7
    v_dot2c_f32_bf16 v47, v7, v7
    v_dot2c_f32_bf16 v44, s6, v8
    v_dot2c_f32_bf16 v46, v8, v8
    v_dot2c_f32_bf16 v45, s6, v9
    v_dot2c_f32_bf16 v47, v9, v9
    v_dot2c_f32_bf16 v44, s6, v10
    v_dot2c_f32_bf16 v46, v10, v10
    v_dot2c_f32_bf16 v45, s6, v11
    v_dot2c_f32_bf16 v47, v11, v11
    v_dot2c_f32_bf16 v44, s6, v12
    v_dot2c_f32_bf16 v46, v12, v12
    v_dot2c_f32_bf16 v45, s6, v13
    v_dot2c_f32_bf16 v47, v13, v13
    v_dot2c_f32_bf16 v44, s6, v14
    v_dot2c_f32_bf16 v46, v14, v14
    v_dot2c_f32_bf16 v45, s6, v15
    v_dot2c_f32_bf16 v47, v15, v15
    v_dot2c_f32_bf16 v44, s6, v16
    v_dot2c_f32_bf16 v46, v16, v16
    v_dot2c_f32_bf16 v45, s6, v17
    v_dot2c_f32_bf16 v47, v17, v17
    v_dot2c_f32_bf16 v44, s6, v18
    v_dot2c_f32_bf16 v46, v18, v18
    v_dot2c_f32_bf16 v45, s6, v19
    v_dot2c_f32_bf16 v47, v19, v19
    v_dot2c_f32_bf16 v44, s6, v20
    v_dot2c_f32_bf16 v46, v20, v20
    v_dot2c_f32_bf16 v45, s6, v21
    v_dot2c_f32_bf16 v47, v21, v21
    v_dot2c_f32_bf16 v44, s6, v22
    v_dot2c_f32_bf16 v46, v22, v22
    v_dot2c_f32_bf16 v45, s6, v23
    v_dot2c_f32_bf16 v47, v23, v23
    v_dot2c_f32_bf16 v44, s6, v24
    v_dot2c_f32_bf16 v46, v24, v24
    v_dot2c_f32_bf16 v45, s6, v25
    v_dot2c_f32_bf16 v47, v25, v25
    v_dot2c_f32_bf16 v44, s6, v26
    v_dot2c_f32_bf16 v46, v26, v26
    v_dot2c_f32_bf16 v45, s6, v27
    v_dot2c_f32_bf16 v47, v27, v27
    v_dot2c_f32_bf16 v44, s6, v28
    v_dot2c_f32_bf16 v46, v28, v28
    v_dot2c_f32_bf16 v45, s6, v29
    v_dot2c_f32_bf16 v47, v29, v29
    v_dot2c_f32_bf16 v44, s6, v30
    v_dot2c_f32_bf16 v46, v30, v30
    v_dot2c_f32_bf16 v45, s6, v31
    v_dot2c_f32_bf16 v47, v31, v31
    v_dot2c_f32_bf16 v44, s6, v32
    v_dot2c_f32_bf16 v46, v32, v32
    v_dot2c_f32_bf16 v45, s6, v33
    v_dot2c_f32_bf16 v47, v33, v33
    v_dot2c_f32_bf16 v44, s6, v34
    v_dot2c_f32_bf16 v46, v34, v34
    v_dot2c_f32_bf16 v45, s6, v35
    v_dot2c_f32_bf16 v47, v35, v35
    v_dot2c_f32_bf16 v44, s6, v36
    v_dot2c_f32_bf16 v46, v36, v36
    v_dot2c_f32_bf16 v45, s6, v37
    v_dot2c_f32_bf16 v47, v37, v37
    v_dot2c_f32_bf16 v44, s6, v38
    v_dot2c_f32_bf16 v46, v38, v38
    v_dot2c_f32_bf16 v45, s6, v39
    v_dot2c_f32_bf16 v47, v39, v39
    v_dot2c_f32_bf16 v44, s6, v40
    v_dot2c_f32_bf16 v46, v40, v40
    v_dot2c_f32_bf16 v45, s6, v41
    v_dot2c_f32_bf16 v47, v41, v41
    v_dot2c_f32_bf16 v44, s6, v42
    v_dot2c_f32_bf16 v46, v42, v42
    v_dot2c_f32_bf16 v45, s6, v43
    v_dot2c_f32_bf16 v47, v43, v43
    s_nop 2
    v_add_f32 v44, v44, v45
    v_add_f32 v46, v46, v47
    s_nop 1
    v_add_f32_dpp v44, v44, v44 quad_perm:[1,0,3,2] row_mask:0xf bank_mask:0xf
    v_add_f32_dpp v46, v46, v46 quad_perm:[1,0,3,2] row_mask:0xf bank_mask:0xf
    s_nop 1
    v_add_f32_dpp v44, v44, v44 quad_perm:[2,3,0,1] row_mask:0xf bank_mask:0xf
    v_add_f32_dpp v46, v46, v46 quad_perm:[2,3,0,1] row_mask:0xf bank_mask:0xf
    s_nop 1
    v_add_f32_dpp v44, v44, v44 row_half_mirror row_mask:0xf bank_mask:0xf
    v_add_f32_dpp v46, v46, v46 row_half_mirror row_mask:0xf bank_mask:0xf
    v_mul_f32 v44, 0x3acccccd, v44
    v_mul_f32 v46, 0x3acccccd, v46
    v_fma_f32 v46, -v44, v44, v46
    v_max_f32 v46, 0, v46
    v_cvt_pk_bf16_f32 v46, v46, v46
    v_lshlrev_b32 v46, 16, v46
    v_add_f32 v46, 0x3727c5ac, v46
    v_cvt_pk_bf16_f32 v46, v46, v46
    v_lshlrev_b32 v46, 16, v46
    v_sqrt_f32 v46, v46
    s_nop 0
    v_cvt_pk_bf16_f32 v52, v44, v46
    s_mov_b32 s35, 0
L_nq_7:
    s_waitcnt vmcnt(0)
    v_readfirstlane_b32 s34, v50
    s_add_u32 s35, s35, 1
    s_sub_u32 s5, s34, s32
    s_add_u32 s5, s5, 1000
    s_cmp_ge_u32 s35, 400
    s_cselect_b32 s5, 0, s5
    s_cmp_lt_u32 s5, 2000
    s_cselect_b32 s34, s34, 0
    s_cmp_lg_u32 s34, 0
    s_cbranch_scc1 L_nq_7_ok
    s_cmp_ge_u32 s35, 262144
    s_cbranch_scc1 L_nq_7_ok
    s_sleep 1
    s_mov_b64 exec, 1
    buffer_load_dword v50, v51, s[24:27], 0 offen sc1
    s_mov_b64 exec, -1
    s_branch L_nq_7
L_nq_7_ok:
    v_mov_b32 v53, s34
    v_cmp_eq_u32 vcc, 0, v49
    s_mov_b32 s4, 0
    s_mov_b64 exec, vcc
    buffer_store_dwordx2 v[52:53], v48, s[28:31], s4 offen sc1
    s_mov_b64 exec, -1
    s_branch L_l1e_6
L_l1e_6_n:
    s_waitcnt lgkmcnt(0)
    s_mov_b32 s28, s66
    s_mov_b32 s29, s67
    s_mov_b32 s30, 67108864
    s_mov_b32 s31, 0x00020000
    s_mov_b32 s24, s64
    s_mov_b32 s25, s65
    s_mov_b32 s26, 256
    s_mov_b32 s27, 0x00020000
    s_sleep 48
    v_mov_b32 v49, 0
    s_mov_b32 s35, 0
    s_mov_b64 exec, 1
L_gn_8:
    buffer_load_dword v48, v49, s[24:27], 0 offen sc1
    s_waitcnt vmcnt(0)
    v_readfirstlane_b32 s34, v48
    s_add_u32 s35, s35, 1
    s_sub_u32 s5, s34, s32
    s_add_u32 s5, s5, 1000
    s_cmp_ge_u32 s35, 400
    s_cselect_b32 s5, 0, s5
    s_cmp_lt_u32 s5, 2000
    s_cselect_b32 s34, s34, 0
    s_cmp_lg_u32 s34, 0
    s_cbranch_scc1 L_gn_8_ok
    s_sleep 2
    s_cmp_lt_u32 s35, 262144
    s_cbranch_scc1 L_gn_8
L_gn_8_ok:
    s_mov_b64 exec, -1
L_l1e_6:
    s_bfe_u32 s4, s2, 0x20001
    s_lshl_b32 s4, s4, 2
    s_bfe_u32 s5, s2, 0x20003
    s_add_u32 s68, s4, s5
    s_and_b32 s4, s2, 1
    s_mul_i32 s4, s4, 7
    s_lshr_b32 s5, s2, 5
    s_add_u32 s69, s4, s5
    s_cmp_lt_u32 s5, 7
    s_cselect_b32 s70, 1, 0
    s_cselect_b32 s4, 0, 64
    s_sub_u32 s71, s2, s4
    s_sub_u32 s71, s71, 160
    s_cmp_eq_u32 s70, 0
    s_cbranch_scc1 L_nog1
    s_cmp_ge_u32 s71, 54
    s_cbranch_scc1 L_cse_9
    s_cmp_ge_u32 s71, 27
    s_cselect_b32 s8, s58, s56
    s_cselect_b32 s9, s59, s57
    s_cselect_b32 s5, 27, 0
    s_sub_u32 s5, s71, s5
    s_lshl_b32 s5, s5, 7
    s_mul_i32 s6, s3, 552960
    s_add_u32 s5, s5, s6
    v_lshrrev_b32 v3, 3, v1
    v_mul_u32_u24 v2, 3456, v3
    v_and_b32 v4, 7, v1
    v_lshl_add_u32 v2, v4, 4, v2
    v_add_u32 v2, s5, v2
    global_load_dwordx4 v[8:11], v2, s[8:9]
    v_add_u32 v2, 27648, v2
    global_load_dwordx4 v[12:15], v2, s[8:9]
    v_add_u32 v2, 27648, v2
    global_load_dwordx4 v[16:19], v2, s[8:9]
    v_add_u32 v2, 27648, v2
    global_load_dwordx4 v[20:23], v2, s[8:9]
    v_add_u32 v2, 27648, v2
    global_load_dwordx4 v[24:27], v2, s[8:9]
    v_add_u32 v2, 27648, v2
    global_load_dwordx4 v[28:31], v2, s[8:9]
    v_add_u32 v2, 27648, v2
    global_load_dwordx4 v[32:35], v2, s[8:9]
    v_add_u32 v2, 27648, v2
    global_load_dwordx4 v[36:39], v2, s[8:9]
    v_add_u32 v2, 27648, v2
    global_load_dwordx4 v[40:43], v2, s[8:9]
    v_add_u32 v2, 27648, v2
    global_load_dwordx4 v[44:47], v2, s[8:9]
    v_add_u32 v2, 27648, v2
    global_load_dwordx4 v[48:51], v2, s[8:9]
    v_add_u32 v2, 27648, v2
    global_load_dwordx4 v[52:55], v2, s[8:9]
    v_add_u32 v2, 27648, v2
    global_load_dwordx4 v[56:59], v2, s[8:9]
    v_add_u32 v2, 27648, v2
    global_load_dwordx4 v[60:63], v2, s[8:9]
    v_add_u32 v2, 27648, v2
    global_load_dwordx4 v[64:67], v2, s[8:9]
    v_add_u32 v2, 27648, v2
    global_load_dwordx4 v[68:71], v2, s[8:9]
    v_add_u32 v2, 27648, v2
    global_load_dwordx4 v[72:75], v2, s[8:9]
    v_add_u32 v2, 27648, v2
    global_load_dwordx4 v[76:79], v2, s[8:9]
    v_add_u32 v2, 27648, v2
    global_load_dwordx4 v[80:83], v2, s[8:9]
    v_add_u32 v2, 27648, v2
    global_load_dwordx4 v[84:87], v2, s[8:9]
    s_mov_b32 s6, 0x00003f80
    s_mov_b32 s7, 0x3f800000
    v_mov_b32 v88, 0
    v_mov_b32 v89, 0
    v_mov_b32 v90, 0
    v_mov_b32 v91, 0
    v_mov_b32 v92, 0
    v_mov_b32 v93, 0
    v_mov_b32 v94, 0
    v_mov_b32 v95, 0
    s_waitcnt vmcnt(19)
    v_dot2c_f32_bf16 v88, s6, v8
    v_dot2c_f32_bf16 v89, s7, v8
    v_dot2c_f32_bf16 v90, s6, v9
    v_dot2c_f32_bf16 v91, s7, v9
    v_dot2c_f32_bf16 v92, s6, v10
    v_dot2c_f32_bf16 v93, s7, v10
    v_dot2c_f32_bf16 v94, s6, v11
    v_dot2c_f32_bf16 v95, s7, v11
    s_waitcnt vmcnt(18)
    v_dot2c_f32_bf16 v88, s6, v12
    v_dot2c_f32_bf16 v89, s7, v12
    v_dot2c_f32_bf16 v90, s6, v13
    v_dot2c_f32_bf16 v91, s7, v13
    v_dot2c_f32_bf16 v92, s6, v14
    v_dot2c_f32_bf16 v93, s7, v14
    v_dot2c_f32_bf16 v94, s6, v15
    v_dot2c_f32_bf16 v95, s7, v15
    s_waitcnt vmcnt(17)
    v_dot2c_f32_bf16 v88, s6, v16
    v_dot2c_f32_bf16 v89, s7, v16
    v_dot2c_f32_bf16 v90, s6, v17
    v_dot2c_f32_bf16 v91, s7, v17
    v_dot2c_f32_bf16 v92, s6, v18
    v_dot2c_f32_bf16 v93, s7, v18
    v_dot2c_f32_bf16 v94, s6, v19
    v_dot2c_f32_bf16 v95, s7, v19
    s_waitcnt vmcnt(16)
    v_dot2c_f32_bf16 v88, s6, v20
    v_dot2c_f32_bf16 v89, s7, v20
    v_dot2c_f32_bf16 v90, s6, v21
    v_dot2c_f32_bf16 v91, s7, v21
    v_dot2c_f32_bf16 v92, s6, v22
    v_dot2c_f32_bf16 v93, s7, v22
    v_dot2c_f32_bf16 v94, s6, v23
    v_dot2c_f32_bf16 v95, s7, v23
    s_waitcnt vmcnt(15)
    v_dot2c_f32_bf16 v88, s6, v24
    v_dot2c_f32_bf16 v89, s7, v24
    v_dot2c_f32_bf16 v90, s6, v25
    v_dot2c_f32_bf16 v91, s7, v25
    v_dot2c_f32_bf16 v92, s6, v26
    v_dot2c_f32_bf16 v93, s7, v26
    v_dot2c_f32_bf16 v94, s6, v27
    v_dot2c_f32_bf16 v95, s7, v27
    s_waitcnt vmcnt(14)
    v_dot2c_f32_bf16 v88, s6, v28
    v_dot2c_f32_bf16 v89, s7, v28
    v_dot2c_f32_bf16 v90, s6, v29
    v_dot2c_f32_bf16 v91, s7, v29
    v_dot2c_f32_bf16 v92, s6, v30
    v_dot2c_f32_bf16 v93, s7, v30
    v_dot2c_f32_bf16 v94, s6, v31
    v_dot2c_f32_bf16 v95, s7, v31
    s_waitcnt vmcnt(13)
    v_dot2c_f32_bf16 v88, s6, v32
    v_dot2c_f32_bf16 v89, s7, v32
    v_dot2c_f32_bf16 v90, s6, v33
    v_dot2c_f32_bf16 v91, s7, v33
    v_dot2c_f32_bf16 v92, s6, v34
    v_dot2c_f32_bf16 v93, s7, v34
    v_dot2c_f32_bf16 v94, s6, v35
    v_dot2c_f32_bf16 v95, s7, v35
    s_waitcnt vmcnt(12)
    v_dot2c_f32_bf16 v88, s6, v36
    v_dot2c_f32_bf16 v89, s7, v36
    v_dot2c_f32_bf16 v90, s6, v37
    v_dot2c_f32_bf16 v91, s7, v37
    v_dot2c_f32_bf16 v92, s6, v38
    v_dot2c_f32_bf16 v93, s7, v38
    v_dot2c_f32_bf16 v94, s6, v39
    v_dot2c_f32_bf16 v95, s7, v39
    s_waitcnt vmcnt(11)
    v_dot2c_f32_bf16 v88, s6, v40
    v_dot2c_f32_bf16 v89, s7, v40
    v_dot2c_f32_bf16 v90, s6, v41
    v_dot2c_f32_bf16 v91, s7, v41
    v_dot2c_f32_bf16 v92, s6, v42
    v_dot2c_f32_bf16 v93, s7, v42
    v_dot2c_f32_bf16 v94, s6, v43
    v_dot2c_f32_bf16 v95, s7, v43
    s_waitcnt vmcnt(10)
    v_dot2c_f32_bf16 v88, s6, v44
    v_dot2c_f32_bf16 v89, s7, v44
    v_dot2c_f32_bf16 v90, s6, v45
    v_dot2c_f32_bf16 v91, s7, v45
    v_dot2c_f32_bf16 v92, s6, v46
    v_dot2c_f32_bf16 v93, s7, v46
    v_dot2c_f32_bf16 v94, s6, v47
    v_dot2c_f32_bf16 v95, s7, v47
    s_waitcnt vmcnt(9)
    v_dot2c_f32_bf16 v88, s6, v48
    v_dot2c_f32_bf16 v89, s7, v48
    v_dot2c_f32_bf16 v90, s6, v49
    v_dot2c_f32_bf16 v91, s7, v49
    v_dot2c_f32_bf16 v92, s6, v50
    v_dot2c_f32_bf16 v93, s7, v50
    v_dot2c_f32_bf16 v94, s6, v51
    v_dot2c_f32_bf16 v95, s7, v51
    s_waitcnt vmcnt(8)
    v_dot2c_f32_bf16 v88, s6, v52
    v_dot2c_f32_bf16 v89, s7, v52
    v_dot2c_f32_bf16 v90, s6, v53
    v_dot2c_f32_bf16 v91, s7, v53
    v_dot2c_f32_bf16 v92, s6, v54
    v_dot2c_f32_bf16 v93, s7, v54
    v_dot2c_f32_bf16 v94, s6, v55
    v_dot2c_f32_bf16 v95, s7, v55
    s_waitcnt vmcnt(7)
    v_dot2c_f32_bf16 v88, s6, v56
    v_dot2c_f32_bf16 v89, s7, v56
    v_dot2c_f32_bf16 v90, s6, v57
    v_dot2c_f32_bf16 v91, s7, v57
    v_dot2c_f32_bf16 v92, s6, v58
    v_dot2c_f32_bf16 v93, s7, v58
    v_dot2c_f32_bf16 v94, s6, v59
    v_dot2c_f32_bf16 v95, s7, v59
    s_waitcnt vmcnt(6)
    v_dot2c_f32_bf16 v88, s6, v60
    v_dot2c_f32_bf16 v89, s7, v60
    v_dot2c_f32_bf16 v90, s6, v61
    v_dot2c_f32_bf16 v91, s7, v61
    v_dot2c_f32_bf16 v92, s6, v62
    v_dot2c_f32_bf16 v93, s7, v62
    v_dot2c_f32_bf16 v94, s6, v63
    v_dot2c_f32_bf16 v95, s7, v63
    s_waitcnt vmcnt(5)
    v_dot2c_f32_bf16 v88, s6, v64
    v_dot2c_f32_bf16 v89, s7, v64
    v_dot2c_f32_bf16 v90, s6, v65
    v_dot2c_f32_bf16 v91, s7, v65
    v_dot2c_f32_bf16 v92, s6, v66
    v_dot2c_f32_bf16 v93, s7, v66
    v_dot2c_f32_bf16 v94, s6, v67
    v_dot2c_f32_bf16 v95, s7, v67
    s_waitcnt vmcnt(4)
    v_dot2c_f32_bf16 v88, s6, v68
    v_dot2c_f32_bf16 v89, s7, v68
    v_dot2c_f32_bf16 v90, s6, v69
    v_dot2c_f32_bf16 v91, s7, v69
    v_dot2c_f32_bf16 v92, s6, v70
    v_dot2c_f32_bf16 v93, s7, v70
    v_dot2c_f32_bf16 v94, s6, v71
    v_dot2c_f32_bf16 v95, s7, v71
    s_waitcnt vmcnt(3)
    v_dot2c_f32_bf16 v88, s6, v72
    v_dot2c_f32_bf16 v89, s7, v72
    v_dot2c_f32_bf16 v90, s6, v73
    v_dot2c_f32_bf16 v91, s7, v73
    v_dot2c_f32_bf16 v92, s6, v74
    v_dot2c_f32_bf16 v93, s7, v74
    v_dot2c_f32_bf16 v94, s6, v75
    v_dot2c_f32_bf16 v95, s7, v75
    s_waitcnt vmcnt(2)
    v_dot2c_f32_bf16 v88, s6, v76
    v_dot2c_f32_bf16 v89, s7, v76
    v_dot2c_f32_bf16 v90, s6, v77
    v_dot2c_f32_bf16 v91, s7, v77
    v_dot2c_f32_bf16 v92, s6, v78
    v_dot2c_f32_bf16 v93, s7, v78
    v_dot2c_f32_bf16 v94, s6, v79
    v_dot2c_f32_bf16 v95, s7, v79
    s_waitcnt vmcnt(1)
    v_dot2c_f32_bf16 v88, s6, v80
    v_dot2c_f32_bf16 v89, s7, v80
    v_dot2c_f32_bf16 v90, s6, v81
    v_dot2c_f32_bf16 v91, s7, v81
    v_dot2c_f32_bf16 v92, s6, v82
    v_dot2c_f32_bf16 v93, s7, v82
    v_dot2c_f32_bf16 v94, s6, v83
    v_dot2c_f32_bf16 v95, s7, v83
    s_waitcnt vmcnt(0)
    v_dot2c_f32_bf16 v88, s6, v84
    v_dot2c_f32_bf16 v89, s7, v84
    v_dot2c_f32_bf16 v90, s6, v85
    v_dot2c_f32_bf16 v91, s7, v85
    v_dot2c_f32_bf16 v92, s6, v86
    v_dot2c_f32_bf16 v93, s7, v86
    v_dot2c_f32_bf16 v94, s6, v87
    v_dot2c_f32_bf16 v95, s7, v87
    s_nop 2
    v_add_f32_dpp v88, v88, v88 row_ror:8 row_mask:0xf bank_mask:0xf
    v_add_f32_dpp v89, v89, v89 row_ror:8 row_mask:0xf bank_mask:0xf
    v_add_f32_dpp v90, v90, v90 row_ror:8 row_mask:0xf bank_mask:0xf
    v_add_f32_dpp v91, v91, v91 row_ror:8 row_mask:0xf bank_mask:0xf
    v_add_f32_dpp v92, v92, v92 row_ror:8 row_mask:0xf bank_mask:0xf
    v_add_f32_dpp v93, v93, v93 row_ror:8 row_mask:0xf bank_mask:0xf
    v_add_f32_dpp v94, v94, v94 row_ror:8 row_mask:0xf bank_mask:0xf
    v_add_f32_dpp v95, v95, v95 row_ror:8 row_mask:0xf bank_mask:0xf
    v_mov_b32 v96, v88
    v_mov_b32 v97, v89
    v_mov_b32 v98, v90
    v_mov_b32 v99, v91
    v_mov_b32 v100, v92
    v_mov_b32 v101, v93
    v_mov_b32 v102, v94
    v_mov_b32 v103, v95
    v_permlane16_swap_b32 v88, v96
    v_permlane16_swap_b32 v89, v97
    v_permlane16_swap_b32 v90, v98
    v_permlane16_swap_b32 v91, v99
    v_permlane16_swap_b32 v92, v100
    v_permlane16_swap_b32 v93, v101
    v_permlane16_swap_b32 v94, v102
    v_permlane16_swap_b32 v95, v103
    v_add_f32 v88, v88, v96
    v_add_f32 v89, v89, v97
    v_add_f32 v90, v90, v98
    v_add_f32 v91, v91, v99
    v_add_f32 v92, v92, v100
    v_add_f32 v93, v93, v101
    v_add_f32 v94, v94, v102
    v_add_f32 v95, v95, v103
    v_mov_b32 v96, v88
    v_mov_b32 v97, v89
    v_mov_b32 v98, v90
    v_mov_b32 v99, v91
    v_mov_b32 v100, v92
    v_mov_b32 v101, v93
    v_mov_b32 v102, v94
    v_mov_b32 v103, v95
    v_permlane32_swap_b32 v88, v96
    v_permlane32_swap_b32 v89, v97
    v_permlane32_swap_b32 v90, v98
    v_permlane32_swap_b32 v91, v99
    v_permlane32_swap_b32 v92, v100
    v_permlane32_swap_b32 v93, v101
    v_permlane32_swap_b32 v94, v102
    v_permlane32_swap_b32 v95, v103
    v_add_f32 v88, v88, v96
    v_add_f32 v89, v89, v97
    v_add_f32 v90, v90, v98
    v_add_f32 v91, v91, v99
    v_add_f32 v92, v92, v100
    v_add_f32 v93, v93, v101
    v_add_f32 v94, v94, v102
    v_add_f32 v95, v95, v103
    s_mul_i32 s4, s3, 13824
    s_lshl_b32 s5, s71, 8
    s_add_u32 s4, s4, s5
    s_add_u32 s4, s4, 65536
    v_lshlrev_b32 v3, 5, v1
    s_mov_b64 exec, 0xff
    buffer_store_dwordx4 v[88:91], v3, s[28:31], s4 offen sc1
    buffer_store_dwordx4 v[92:95], v3, s[28:31], s4 offen offset:16 sc1
    s_mov_b64 exec, -1
    s_lshl_b32 s4, s71, 7
    s_lshl_b32 s5, s3, 2
    s_add_u32 s4, s4, s5
    s_add_u32 s4, s4, 262144
    v_mov_b32 v3, s34
    v_mov_b32 v4, 0
    s_waitcnt vmcnt(0)
    s_mov_b64 exec, 1
    buffer_store_dword v3, v4, s[28:31], s4 offen sc1
    s_mov_b64 exec, -1
L_cse_9:
    s_barrier
    s_branch L_g1
L_nog1:
    s_cmp_ge_u32 s3, 6
    s_cselect_b32 s4, 2, 0
    s_sub_u32 s4, s3, s4
    s_mul_i32 s20, s4, 10240
    s_mul_i32 s5, s71, 6
    s_add_u32 s21, s5, s4
    s_sub_u32 s5, 63, s71
    s_lshl_b32 s5, s5, 1
    s_add_u32 s5, s5, s4
    s_add_u32 s5, s5, 188
    s_add_u32 s4, s20, 94208
    s_cmp_lg_u32 s70, 0
    s_cselect_b32 s21, s5, s21
    s_cselect_b32 s20, s4, s20
    s_cmp_ge_u32 s21, 216
    s_cbranch_scc1 L_rte_10
    s_mov_b32 s8, s60
    s_mov_b32 s9, s61
    s_mov_b32 s10, 2211840
    s_mov_b32 s11, 0x00020000
    v_add_u32 v12, 0, v1
    v_mul_u32_u24 v13, 3277, v12
    v_lshrrev_b32 v13, 16, v13
    v_mul_u32_u24 v14, 20, v13
    v_sub_u32 v12, v12, v14
    v_mul_u32_u24 v13, 1280, v13
    v_lshl_add_u32 v2, v12, 4, v13
    v_add_u32 v12, 64, v1
    v_mul_u32_u24 v13, 3277, v12
    v_lshrrev_b32 v13, 16, v13
    v_mul_u32_u24 v14, 20, v13
    v_sub_u32 v12, v12, v14
    v_mul_u32_u24 v13, 1280, v13
    v_lshl_add_u32 v3, v12, 4, v13
    v_add_u32 v12, 128, v1
    v_mul_u32_u24 v13, 3277, v12
    v_lshrrev_b32 v13, 16, v13
    v_mul_u32_u24 v14, 20, v13
    v_sub_u32 v12, v12, v14
    v_mul_u32_u24 v13, 1280, v13
    v_lshl_add_u32 v4, v12, 4, v13
    v_add_u32 v12, 192, v1
    v_mul_u32_u24 v13, 3277, v12
    v_lshrrev_b32 v13, 16, v13
    v_mul_u32_u24 v14, 20, v13
    v_sub_u32 v12, v12, v14
    v_mul_u32_u24 v13, 1280, v13
    v_lshl_add_u32 v5, v12, 4, v13
    v_add_u32 v12, 256, v1
    v_mul_u32_u24 v13, 3277, v12
    v_lshrrev_b32 v13, 16, v13
    v_mul_u32_u24 v14, 20, v13
    v_sub_u32 v12, v12, v14
    v_mul_u32_u24 v13, 1280, v13
    v_lshl_add_u32 v6, v12, 4, v13
    v_add_u32 v12, 320, v1
    v_mul_u32_u24 v13, 3277, v12
    v_lshrrev_b32 v13, 16, v13
    v_mul_u32_u24 v14, 20, v13
    v_sub_u32 v12, v12, v14
    v_mul_u32_u24 v13, 1280, v13
    v_lshl_add_u32 v7, v12, 4, v13
    v_add_u32 v12, 384, v1
    v_mul_u32_u24 v13, 3277, v12
    v_lshrrev_b32 v13, 16, v13
    v_mul_u32_u24 v14, 20, v13
    v_sub_u32 v12, v12, v14
    v_mul_u32_u24 v13, 1280, v13
    v_lshl_add_u32 v8, v12, 4, v13
    v_add_u32 v12, 448, v1
    v_mul_u32_u24 v13, 3277, v12
    v_lshrrev_b32 v13, 16, v13
    v_mul_u32_u24 v14, 20, v13
    v_sub_u32 v12, v12, v14
    v_mul_u32_u24 v13, 1280, v13
    v_lshl_add_u32 v9, v12, 4, v13
    v_add_u32 v12, 512, v1
    v_mul_u32_u24 v13, 3277, v12
    v_lshrrev_b32 v13, 16, v13
    v_mul_u32_u24 v14, 20, v13
    v_sub_u32 v12, v12, v14
    v_mul_u32_u24 v13, 1280, v13
    v_lshl_add_u32 v10, v12, 4, v13
    v_add_u32 v12, 576, v1
    v_mul_u32_u24 v13, 3277, v12
    v_lshrrev_b32 v13, 16, v13
    v_mul_u32_u24 v14, 20, v13
    v_sub_u32 v12, v12, v14
    v_mul_u32_u24 v13, 1280, v13
    v_lshl_add_u32 v11, v12, 4, v13
    v_lshrrev_b32 v12, 4, v1
    v_bfe_u32 v13, v1, 2, 2
    v_lshl_add_u32 v12, v12, 3, v13
    v_mul_u32_u24 v12, 320, v12
    v_and_b32 v13, 3, v1
    v_lshl_add_u32 v12, v13, 3, v12
    v_add_u32 v16, s20, v12
    v_lshlrev_b32 v17, 4, v1
    s_lshr_b32 s22, s21, 2
    s_and_b32 s23, s21, 3
    s_mul_i32 s4, s22, 40960
    s_mul_i32 s5, s23, 320
    s_add_u32 s4, s4, s5
    s_add_u32 m0, s20, 0
    s_nop 0
    buffer_load_dwordx4 v2, s[8:11], s4 offen lds
    s_add_u32 m0, s20, 1024
    s_nop 0
    buffer_load_dwordx4 v3, s[8:11], s4 offen lds
    s_add_u32 m0, s20, 2048
    s_nop 0
    buffer_load_dwordx4 v4, s[8:11], s4 offen lds
    s_add_u32 m0, s20, 3072
    s_nop 0
    buffer_load_dwordx4 v5, s[8:11], s4 offen lds
    s_add_u32 m0, s20, 4096
    s_nop 0
    buffer_load_dwordx4 v6, s[8:11], s4 offen lds
    s_add_u32 m0, s20, 5120
    s_nop 0
    buffer_load_dwordx4 v7, s[8:11], s4 offen lds
    s_add_u32 m0, s20, 6144
    s_nop 0
    buffer_load_dwordx4 v8, s[8:11], s4 offen lds
    s_add_u32 m0, s20, 7168
    s_nop 0
    buffer_load_dwordx4 v9, s[8:11], s4 offen lds
    s_add_u32 m0, s20, 8192
    s_nop 0
    buffer_load_dwordx4 v10, s[8:11], s4 offen lds
    s_add_u32 m0, s20, 9216
    s_nop 0
    buffer_load_dwordx4 v11, s[8:11], s4 offen lds
    s_mul_i32 s4, s23, 108
    s_add_u32 s4, s4, s22
    s_mul_i32 s4, s4, 5120
    s_add_u32 s4, s4, 12582912
    s_waitcnt vmcnt(0)
    ds_read_b64_tr_b16 v[20:21], v16 offset:0
    ds_read_b64_tr_b16 v[22:23], v16 offset:1280
    ds_read_b64_tr_b16 v[24:25], v16 offset:32
    ds_read_b64_tr_b16 v[26:27], v16 offset:1312
    ds_read_b64_tr_b16 v[28:29], v16 offset:64
    ds_read_b64_tr_b16 v[30:31], v16 offset:1344
    ds_read_b64_tr_b16 v[32:33], v16 offset:96
    ds_read_b64_tr_b16 v[34:35], v16 offset:1376
    ds_read_b64_tr_b16 v[36:37], v16 offset:128
    ds_read_b64_tr_b16 v[38:39], v16 offset:1408
    s_waitcnt lgkmcnt(8)
    buffer_store_dwordx4 v[20:23], v17, s[28:31], s4 offen sc1
    s_add_u32 s4, s4, 1024
    ds_read_b64_tr_b16 v[40:41], v16 offset:160
    ds_read_b64_tr_b16 v[42:43], v16 offset:1440
    s_waitcnt lgkmcnt(8)
    buffer_store_dwordx4 v[24:27], v17, s[28:31], s4 offen sc1
    s_add_u32 s4, s4, 1024
    ds_read_b64_tr_b16 v[44:45], v16 offset:192
    ds_read_b64_tr_b16 v[46:47], v16 offset:1472
    s_waitcnt lgkmcnt(8)
    buffer_store_dwordx4 v[28:31], v17, s[28:31], s4 offen sc1
    s_add_u32 s4, s4, 1024
    ds_read_b64_tr_b16 v[48:49], v16 offset:224
    ds_read_b64_tr_b16 v[50:51], v16 offset:1504
    s_waitcnt lgkmcnt(8)
    buffer_store_dwordx4 v[32:35], v17, s[28:31], s4 offen sc1
    s_add_u32 s4, s4, 1024
    ds_read_b64_tr_b16 v[52:53], v16 offset:256
    ds_read_b64_tr_b16 v[54:55], v16 offset:1536
    s_waitcnt lgkmcnt(8)
    buffer_store_dwordx4 v[36:39], v17, s[28:31], s4 offen sc1
    s_add_u32 s4, s4, 272384
    ds_read_b64_tr_b16 v[56:57], v16 offset:288
    ds_read_b64_tr_b16 v[58:59], v16 offset:1568
    s_waitcnt lgkmcnt(8)
    buffer_store_dwordx4 v[40:43], v17, s[28:31], s4 offen sc1
    s_add_u32 s4, s4, 1024
    s_waitcnt lgkmcnt(6)
    buffer_store_dwordx4 v[44:47], v17, s[28:31], s4 offen sc1
    s_add_u32 s4, s4, 1024
    s_waitcnt lgkmcnt(4)
    buffer_store_dwordx4 v[48:51], v17, s[28:31], s4 offen sc1
    s_add_u32 s4, s4, 1024
    s_waitcnt lgkmcnt(2)
    buffer_store_dwordx4 v[52:55], v17, s[28:31], s4 offen sc1
    s_add_u32 s4, s4, 1024
    s_waitcnt lgkmcnt(0)
    buffer_store_dwordx4 v[56:59], v17, s[28:31], s4 offen sc1
    s_add_u32 s4, s4, 1024
    s_mul_i32 s4, s23, 54
    s_add_u32 s4, s4, s22
    s_lshl_b32 s4, s4, 7
    s_add_u32 s4, s4, 458752
    v_mov_b32 v12, s34
    v_mov_b32 v13, 0
    s_waitcnt vmcnt(0)
    s_mov_b64 exec, 1
    buffer_store_dword v12, v13, s[28:31], s4 offen sc1
    s_mov_b64 exec, -1
L_rte_10:
    s_lshl_b32 s4, s71, 2
    s_add_u32 s4, s4, s3
    s_lshl_b32 s4, s4, 7
    s_add_u32 s4, s4, 278528
    v_lshlrev_b32 v2, 7, v1
    s_mov_b32 s35, 0
    s_mov_b64 exec, 1
L_pl_12:
    buffer_load_dword v4, v2, s[28:31], s4 offen sc1
    s_add_u32 s35, s35, 1
    s_waitcnt vmcnt(0)
    v_cmp_ne_u32 vcc, s34, v4
    s_cmp_ge_u32 s35, 262144
    s_cbranch_scc1 L_pl_12_ok
    s_nop 1
    s_cbranch_vccz L_pl_12_ok
    s_sleep 4
    s_branch L_pl_12
L_pl_12_ok:
    s_mov_b64 exec, -1
    s_sleep 8
    s_mov_b32 s35, 0
    s_mov_b32 s7, 0
    s_mov_b32 s6, 4294967295
    v_mov_b32 v10, s34
L_pn_13:
    s_mov_b32 s5, 278528
    buffer_load_dword v8, v2, s[28:31], s5 offen sc1
    s_add_u32 s5, s5, 8192
    buffer_load_dword v9, v2, s[28:31], s5 offen sc1
    s_add_u32 s5, s5, 8192
    s_mov_b64 exec, s[6:7]
    buffer_load_dword v10, v2, s[28:31], s5 offen sc1
    s_mov_b64 exec, -1
    s_add_u32 s35, s35, 1
    s_waitcnt vmcnt(0)
    v_xor_b32 v11, s34, v8
    v_xor_b32 v12, s34, v9
    v_or_b32 v11, v11, v12
    v_xor_b32 v12, s34, v10
    v_or_b32 v11, v11, v12
    v_cmp_ne_u32 vcc, 0, v11
    s_cmp_ge_u32 s35, 262144
    s_cbranch_scc1 L_pn_13_ok
    s_nop 1
    s_cbranch_vccz L_pn_13_ok
    s_sleep 1
    s_branch L_pn_13
L_pn_13_ok:
    s_cmp_ge_u32 s71, 32
    s_cbranch_scc1 L_l2e_11
    s_and_b32 s5, s2, 7
    s_lshl_b32 s5, s5, 2
    s_bfe_u32 s6, s2, 0x20003
    s_add_u32 s5, s5, s6
    s_lshl_b32 s5, s5, 6
    s_lshl_b32 s6, s3, 4
    s_add_u32 s5, s5, s6
    s_lshl_b32 s5, s5, 3
    s_add_u32 s4, s5, 1048576
    v_lshrrev_b32 v4, 3, v1
    v_lshlrev_b32 v4, 14, v4
    v_and_b32 v5, 7, v1
    v_lshl_add_u32 v2, v5, 4, v4
    buffer_load_dwordx4 v[8:11], v2, s[28:31], s4 offen sc1
    s_add_u32 s4, s4, 0x20000
    buffer_load_dwordx4 v[12:15], v2, s[28:31], s4 offen sc1
    s_add_u32 s4, s4, 0x20000
    buffer_load_dwordx4 v[16:19], v2, s[28:31], s4 offen sc1
    s_add_u32 s4, s4, 0x20000
    buffer_load_dwordx4 v[20:23], v2, s[28:31], s4 offen sc1
    s_add_u32 s4, s4, 0x20000
    buffer_load_dwordx4 v[24:27], v2, s[28:31], s4 offen sc1
    s_add_u32 s4, s4, 0x20000
    buffer_load_dwordx4 v[28:31], v2, s[28:31], s4 offen sc1
    s_add_u32 s4, s4, 0x20000
    buffer_load_dwordx4 v[32:35], v2, s[28:31], s4 offen sc1
    s_add_u32 s4, s4, 0x20000
    buffer_load_dwordx4 v[36:39], v2, s[28:31], s4 offen sc1
    s_add_u32 s4, s4, 0x20000
    buffer_load_dwordx4 v[40:43], v2, s[28:31], s4 offen sc1
    s_add_u32 s4, s4, 0x20000
    buffer_load_dwordx4 v[44:47], v2, s[28:31], s4 offen sc1
    s_add_u32 s4, s4, 0x20000
    buffer_load_dwordx4 v[48:51], v2, s[28:31], s4 offen sc1
    s_add_u32 s4, s4, 0x20000
    buffer_load_dwordx4 v[52:55], v2, s[28:31], s4 offen sc1
    s_add_u32 s4, s4, 0x20000
    buffer_load_dwordx4 v[56:59], v2, s[28:31], s4 offen sc1
    s_add_u32 s4, s4, 0x20000
    buffer_load_dwordx4 v[60:63], v2, s[28:31], s4 offen sc1
    s_add_u32 s4, s4, 0x20000
    buffer_load_dwordx4 v[64:67], v2, s[28:31], s4 offen sc1
    s_add_u32 s4, s4, 0x20000
    buffer_load_dwordx4 v[68:71], v2, s[28:31], s4 offen sc1
    s_add_u32 s4, s4, 0x20000
    buffer_load_dwordx4 v[72:75], v2, s[28:31], s4 offen sc1
    s_add_u32 s4, s4, 0x20000
    buffer_load_dwordx4 v[76:79], v2, s[28:31], s4 offen sc1
    s_add_u32 s4, s4, 0x20000
    buffer_load_dwordx4 v[80:83], v2, s[28:31], s4 offen sc1
    s_add_u32 s4, s4, 0x20000
    buffer_load_dwordx4 v[84:87], v2, s[28:31], s4 offen sc1
    s_mov_b32 s6, 0x3f803f80
    v_mov_b32 v88, 0
    v_mov_b32 v89, 0
    v_mov_b32 v90, 0
    v_mov_b32 v91, 0
    s_waitcnt vmcnt(19)
    v_dot2c_f32_bf16 v88, s6, v8
    v_dot2c_f32_bf16 v89, v8, v8
    v_dot2c_f32_bf16 v90, s6, v10
    v_dot2c_f32_bf16 v91, v10, v10
    v_dot2c_f32_bf16 v88, s6, v9
    v_dot2c_f32_bf16 v89, v9, v9
    v_dot2c_f32_bf16 v90, s6, v11
    v_dot2c_f32_bf16 v91, v11, v11
    s_waitcnt vmcnt(18)
    v_dot2c_f32_bf16 v88, s6, v12
    v_dot2c_f32_bf16 v89, v12, v12
    v_dot2c_f32_bf16 v90, s6, v14
    v_dot2c_f32_bf16 v91, v14, v14
    v_dot2c_f32_bf16 v88, s6, v13
    v_dot2c_f32_bf16 v89, v13, v13
    v_dot2c_f32_bf16 v90, s6, v15
    v_dot2c_f32_bf16 v91, v15, v15
    s_waitcnt vmcnt(17)
    v_dot2c_f32_bf16 v88, s6, v16
    v_dot2c_f32_bf16 v89, v16, v16
    v_dot2c_f32_bf16 v90, s6, v18
    v_dot2c_f32_bf16 v91, v18, v18
    v_dot2c_f32_bf16 v88, s6, v17
    v_dot2c_f32_bf16 v89, v17, v17
    v_dot2c_f32_bf16 v90, s6, v19
    v_dot2c_f32_bf16 v91, v19, v19
    s_waitcnt vmcnt(16)
    v_dot2c_f32_bf16 v88, s6, v20
    v_dot2c_f32_bf16 v89, v20, v20
    v_dot2c_f32_bf16 v90, s6, v22
    v_dot2c_f32_bf16 v91, v22, v22
    v_dot2c_f32_bf16 v88, s6, v21
    v_dot2c_f32_bf16 v89, v21, v21
    v_dot2c_f32_bf16 v90, s6, v23
    v_dot2c_f32_bf16 v91, v23, v23
    s_waitcnt vmcnt(15)
    v_dot2c_f32_bf16 v88, s6, v24
    v_dot2c_f32_bf16 v89, v24, v24
    v_dot2c_f32_bf16 v90, s6, v26
    v_dot2c_f32_bf16 v91, v26, v26
    v_dot2c_f32_bf16 v88, s6, v25
    v_dot2c_f32_bf16 v89, v25, v25
    v_dot2c_f32_bf16 v90, s6, v27
    v_dot2c_f32_bf16 v91, v27, v27
    s_waitcnt vmcnt(14)
    v_dot2c_f32_bf16 v88, s6, v28
    v_dot2c_f32_bf16 v89, v28, v28
    v_dot2c_f32_bf16 v90, s6, v30
    v_dot2c_f32_bf16 v91, v30, v30
    v_dot2c_f32_bf16 v88, s6, v29
    v_dot2c_f32_bf16 v89, v29, v29
    v_dot2c_f32_bf16 v90, s6, v31
    v_dot2c_f32_bf16 v91, v31, v31
    s_waitcnt vmcnt(13)
    v_dot2c_f32_bf16 v88, s6, v32
    v_dot2c_f32_bf16 v89, v32, v32
    v_dot2c_f32_bf16 v90, s6, v34
    v_dot2c_f32_bf16 v91, v34, v34
    v_dot2c_f32_bf16 v88, s6, v33
    v_dot2c_f32_bf16 v89, v33, v33
    v_dot2c_f32_bf16 v90, s6, v35
    v_dot2c_f32_bf16 v91, v35, v35
    s_waitcnt vmcnt(12)
    v_dot2c_f32_bf16 v88, s6, v36
    v_dot2c_f32_bf16 v89, v36, v36
    v_dot2c_f32_bf16 v90, s6, v38
    v_dot2c_f32_bf16 v91, v38, v38
    v_dot2c_f32_bf16 v88, s6, v37
    v_dot2c_f32_bf16 v89, v37, v37
    v_dot2c_f32_bf16 v90, s6, v39
    v_dot2c_f32_bf16 v91, v39, v39
    s_waitcnt vmcnt(11)
    v_dot2c_f32_bf16 v88, s6, v40
    v_dot2c_f32_bf16 v89, v40, v40
    v_dot2c_f32_bf16 v90, s6, v42
    v_dot2c_f32_bf16 v91, v42, v42
    v_dot2c_f32_bf16 v88, s6, v41
    v_dot2c_f32_bf16 v89, v41, v41
    v_dot2c_f32_bf16 v90, s6, v43
    v_dot2c_f32_bf16 v91, v43, v43
    s_waitcnt vmcnt(10)
    v_dot2c_f32_bf16 v88, s6, v44
    v_dot2c_f32_bf16 v89, v44, v44
    v_dot2c_f32_bf16 v90, s6, v46
    v_dot2c_f32_bf16 v91, v46, v46
    v_dot2c_f32_bf16 v88, s6, v45
    v_dot2c_f32_bf16 v89, v45, v45
    v_dot2c_f32_bf16 v90, s6, v47
    v_dot2c_f32_bf16 v91, v47, v47
    s_waitcnt vmcnt(9)
    v_dot2c_f32_bf16 v88, s6, v48
    v_dot2c_f32_bf16 v89, v48, v48
    v_dot2c_f32_bf16 v90, s6, v50
    v_dot2c_f32_bf16 v91, v50, v50
    v_dot2c_f32_bf16 v88, s6, v49
    v_dot2c_f32_bf16 v89, v49, v49
    v_dot2c_f32_bf16 v90, s6, v51
    v_dot2c_f32_bf16 v91, v51, v51
    s_waitcnt vmcnt(8)
    v_dot2c_f32_bf16 v88, s6, v52
    v_dot2c_f32_bf16 v89, v52, v52
    v_dot2c_f32_bf16 v90, s6, v54
    v_dot2c_f32_bf16 v91, v54, v54
    v_dot2c_f32_bf16 v88, s6, v53
    v_dot2c_f32_bf16 v89, v53, v53
    v_dot2c_f32_bf16 v90, s6, v55
    v_dot2c_f32_bf16 v91, v55, v55
    s_waitcnt vmcnt(7)
    v_dot2c_f32_bf16 v88, s6, v56
    v_dot2c_f32_bf16 v89, v56, v56
    v_dot2c_f32_bf16 v90, s6, v58
    v_dot2c_f32_bf16 v91, v58, v58
    v_dot2c_f32_bf16 v88, s6, v57
    v_dot2c_f32_bf16 v89, v57, v57
    v_dot2c_f32_bf16 v90, s6, v59
    v_dot2c_f32_bf16 v91, v59, v59
    s_waitcnt vmcnt(6)
    v_dot2c_f32_bf16 v88, s6, v60
    v_dot2c_f32_bf16 v89, v60, v60
    v_dot2c_f32_bf16 v90, s6, v62
    v_dot2c_f32_bf16 v91, v62, v62
    v_dot2c_f32_bf16 v88, s6, v61
    v_dot2c_f32_bf16 v89, v61, v61
    v_dot2c_f32_bf16 v90, s6, v63
    v_dot2c_f32_bf16 v91, v63, v63
    s_waitcnt vmcnt(5)
    v_dot2c_f32_bf16 v88, s6, v64
    v_dot2c_f32_bf16 v89, v64, v64
    v_dot2c_f32_bf16 v90, s6, v66
    v_dot2c_f32_bf16 v91, v66, v66
    v_dot2c_f32_bf16 v88, s6, v65
    v_dot2c_f32_bf16 v89, v65, v65
    v_dot2c_f32_bf16 v90, s6, v67
    v_dot2c_f32_bf16 v91, v67, v67
    s_waitcnt vmcnt(4)
    v_dot2c_f32_bf16 v88, s6, v68
    v_dot2c_f32_bf16 v89, v68, v68
    v_dot2c_f32_bf16 v90, s6, v70
    v_dot2c_f32_bf16 v91, v70, v70
    v_dot2c_f32_bf16 v88, s6, v69
    v_dot2c_f32_bf16 v89, v69, v69
    v_dot2c_f32_bf16 v90, s6, v71
    v_dot2c_f32_bf16 v91, v71, v71
    s_waitcnt vmcnt(3)
    v_dot2c_f32_bf16 v88, s6, v72
    v_dot2c_f32_bf16 v89, v72, v72
    v_dot2c_f32_bf16 v90, s6, v74
    v_dot2c_f32_bf16 v91, v74, v74
    v_dot2c_f32_bf16 v88, s6, v73
    v_dot2c_f32_bf16 v89, v73, v73
    v_dot2c_f32_bf16 v90, s6, v75
    v_dot2c_f32_bf16 v91, v75, v75
    s_waitcnt vmcnt(2)
    v_dot2c_f32_bf16 v88, s6, v76
    v_dot2c_f32_bf16 v89, v76, v76
    v_dot2c_f32_bf16 v90, s6, v78
    v_dot2c_f32_bf16 v91, v78, v78
    v_dot2c_f32_bf16 v88, s6, v77
    v_dot2c_f32_bf16 v89, v77, v77
    v_dot2c_f32_bf16 v90, s6, v79
    v_dot2c_f32_bf16 v91, v79, v79
    s_waitcnt vmcnt(1)
    v_dot2c_f32_bf16 v88, s6, v80
    v_dot2c_f32_bf16 v89, v80, v80
    v_dot2c_f32_bf16 v90, s6, v82
    v_dot2c_f32_bf16 v91, v82, v82
    v_dot2c_f32_bf16 v88, s6, v81
    v_dot2c_f32_bf16 v89, v81, v81
    v_dot2c_f32_bf16 v90, s6, v83
    v_dot2c_f32_bf16 v91, v83, v83
    s_waitcnt vmcnt(0)
    v_dot2c_f32_bf16 v88, s6, v84
    v_dot2c_f32_bf16 v89, v84, v84
    v_dot2c_f32_bf16 v90, s6, v86
    v_dot2c_f32_bf16 v91, v86, v86
    v_dot2c_f32_bf16 v88, s6, v85
    v_dot2c_f32_bf16 v89, v85, v85
    v_dot2c_f32_bf16 v90, s6, v87
    v_dot2c_f32_bf16 v91, v87, v87
    s_nop 2
    v_add_f32_dpp v88, v88, v88 row_ror:8 row_mask:0xf bank_mask:0xf
    v_add_f32_dpp v89, v89, v89 row_ror:8 row_mask:0xf bank_mask:0xf
    v_add_f32_dpp v90, v90, v90 row_ror:8 row_mask:0xf bank_mask:0xf
    v_add_f32_dpp v91, v91, v91 row_ror:8 row_mask:0xf bank_mask:0xf
    v_mov_b32 v92, v88
    v_mov_b32 v93, v89
    v_mov_b32 v94, v90
    v_mov_b32 v95, v91
    v_permlane16_swap_b32 v88, v92
    v_permlane16_swap_b32 v89, v93
    v_permlane16_swap_b32 v90, v94
    v_permlane16_swap_b32 v91, v95
    v_add_f32 v88, v88, v92
    v_add_f32 v89, v89, v93
    v_add_f32 v90, v90, v94
    v_add_f32 v91, v91, v95
    v_mov_b32 v92, v88
    v_mov_b32 v93, v89
    v_mov_b32 v94, v90
    v_mov_b32 v95, v91
    v_permlane32_swap_b32 v88, v92
    v_permlane32_swap_b32 v89, v93
    v_permlane32_swap_b32 v90, v94
    v_permlane32_swap_b32 v91, v95
    v_add_f32 v88, v88, v92
    v_add_f32 v89, v89, v93
    v_add_f32 v90, v90, v94
    v_add_f32 v91, v91, v95
    v_mul_f32 v88, 0x3acccccd, v88
    v_mul_f32 v89, 0x3acccccd, v89
    v_fma_f32 v89, -v88, v88, v89
    v_max_f32 v89, 0, v89
    v_cvt_pk_bf16_f32 v89, v89, v89
    v_lshlrev_b32 v89, 16, v89
    v_add_f32 v89, 0x3727c5ac, v89
    v_cvt_pk_bf16_f32 v89, v89, v89
    v_lshlrev_b32 v89, 16, v89
    v_sqrt_f32 v89, v89
    s_nop 0
    v_cvt_pk_bf16_f32 v96, v88, v89
    v_mul_f32 v90, 0x3acccccd, v90
    v_mul_f32 v91, 0x3acccccd, v91
    v_fma_f32 v91, -v90, v90, v91
    v_max_f32 v91, 0, v91
    v_cvt_pk_bf16_f32 v91, v91, v91
    v_lshlrev_b32 v91, 16, v91
    v_add_f32 v91, 0x3727c5ac, v91
    v_cvt_pk_bf16_f32 v91, v91, v91
    v_lshlrev_b32 v91, 16, v91
    v_sqrt_f32 v91, v91
    s_nop 0
    v_cvt_pk_bf16_f32 v98, v90, v91
    v_mov_b32 v97, s34
    v_mov_b32 v99, s34
    s_add_u32 s4, s5, 32768
    v_lshlrev_b32 v4, 4, v1
    s_mov_b64 exec, 0xff
    buffer_store_dwordx4 v[96:99], v4, s[28:31], s4 offen sc1
    s_mov_b64 exec, -1
L_l2e_11:
    s_barrier
    s_branch L_g2
L_cold_aux0:
    s_load_dwordx2 s[74:75], s[52:53], s6
    s_mov_b32 s28, s66
    s_mov_b32 s29, s67
    s_mov_b32 s30, 67108864
    s_mov_b32 s31, 0x00020000
    s_mov_b32 s24, s64
    s_mov_b32 s25, s65
    s_mov_b32 s26, 256
    s_mov_b32 s27, 0x00020000
    v_lshlrev_b32 v196, 2, v199
    v_add_u32 v196, 135712, v196
    v_mov_b32 v220, 157696
    v_mov_b32 v221, 0
    ds_write_b32 v220, v221
    s_waitcnt vmcnt(2)
    buffer_load_dwordx2 v[54:55], v195, s[8:11], s16 offen offset:1280
    s_waitcnt vmcnt(2)
    buffer_load_dwordx2 v[56:57], v195, s[8:11], s17 offen offset:0
    s_waitcnt vmcnt(2)
    buffer_load_dwordx2 v[58:59], v195, s[8:11], s17 offen offset:1280
    s_waitcnt vmcnt(2)
    buffer_load_dwordx2 v[60:61], v195, s[8:11], s18 offen offset:0
    s_waitcnt vmcnt(2)
    buffer_load_dword v193, v194, s[24:27], 0 offen sc1
    buffer_load_dwordx4 v[64:67], v192, s[28:31], s20 offen sc1
    buffer_load_dwordx4 v[68:71], v192, s[28:31], s21 offen sc1
    buffer_load_dwordx4 v[72:75], v192, s[28:31], s22 offen sc1
    buffer_load_dwordx4 v[76:79], v192, s[28:31], s23 offen sc1
    buffer_load_dwordx2 v[62:63], v195, s[8:11], s18 offen offset:1280
    s_waitcnt vmcnt(7)
    v_lshlrev_b32 v80, 16, v48
    v_and_b32 v82, 0xffff0000, v48
    v_lshlrev_b32 v84, 16, v49
    v_and_b32 v86, 0xffff0000, v49
    v_lshlrev_b32 v81, 16, v50
    v_and_b32 v83, 0xffff0000, v50
    v_lshlrev_b32 v85, 16, v51
    v_and_b32 v87, 0xffff0000, v51
    v_lshlrev_b32 v88, 16, v52
    v_and_b32 v90, 0xffff0000, v52
    v_lshlrev_b32 v92, 16, v53
    v_and_b32 v94, 0xffff0000, v53
    v_lshlrev_b32 v89, 16, v54
    v_and_b32 v91, 0xffff0000, v54
    v_lshlrev_b32 v93, 16, v55
    v_and_b32 v95, 0xffff0000, v55
    v_lshlrev_b32 v96, 16, v56
    v_and_b32 v98, 0xffff0000, v56
    v_lshlrev_b32 v100, 16, v57
    v_and_b32 v102, 0xffff0000, v57
    v_lshlrev_b32 v97, 16, v58
    v_and_b32 v99, 0xffff0000, v58
    v_lshlrev_b32 v101, 16, v59
    v_and_b32 v103, 0xffff0000, v59
    s_mov_b32 s35, 0
    s_waitcnt vmcnt(1)
L_sw_15:
    v_readfirstlane_b32 s34, v193
    s_add_u32 s35, s35, 1
    s_sub_u32 s5, s34, s32
    s_add_u32 s5, s5, 1000
    s_cmp_ge_u32 s35, 400
    s_cselect_b32 s5, 0, s5
    s_cmp_lt_u32 s5, 2000
    s_cselect_b32 s34, s34, 0
    v_xor_b32 v200, s34, v65
    v_xor_b32 v201, s34, v67
    v_xor_b32 v202, s34, v69
    v_xor_b32 v203, s34, v71
    v_xor_b32 v204, s34, v73
    v_xor_b32 v205, s34, v75
    v_xor_b32 v206, s34, v77
    v_xor_b32 v207, s34, v79
    v_or3_b32 v200, v200, v201, v202
    v_or3_b32 v203, v203, v204, v205
    v_or3_b32 v200, v200, v206, v207
    v_or_b32 v200, v200, v203
    v_cmp_ne_u32 vcc, 0, v200
    s_cmp_eq_u32 s34, 0
    s_cbranch_scc1 L_sw_15_r
    s_nop 1
    s_cbranch_vccz L_sw_15_ok
L_sw_15_r:
    s_cmp_ge_u32 s35, 262144
    s_cbranch_scc1 L_sw_15_ok
    s_sleep 4
    buffer_load_dword v193, v194, s[24:27], 0 offen sc1
    buffer_load_dwordx4 v[64:67], v192, s[28:31], s20 offen sc1
    buffer_load_dwordx4 v[68:71], v192, s[28:31], s21 offen sc1
    buffer_load_dwordx4 v[72:75], v192, s[28:31], s22 offen sc1
    buffer_load_dwordx4 v[76:79], v192, s[28:31], s23 offen sc1
    s_waitcnt vmcnt(0)
    s_branch L_sw_15
L_sw_15_ok:
    v_and_b32 v200, 0xffff0000, v64
    v_lshlrev_b32 v208, 16, v64
    v_and_b32 v201, 0xffff0000, v66
    v_lshlrev_b32 v209, 16, v66
    v_and_b32 v202, 0xffff0000, v68
    v_lshlrev_b32 v210, 16, v68
    v_and_b32 v203, 0xffff0000, v70
    v_lshlrev_b32 v211, 16, v70
    v_and_b32 v204, 0xffff0000, v72
    v_lshlrev_b32 v212, 16, v72
    v_and_b32 v205, 0xffff0000, v74
    v_lshlrev_b32 v213, 16, v74
    v_and_b32 v206, 0xffff0000, v76
    v_lshlrev_b32 v214, 16, v76
    v_and_b32 v207, 0xffff0000, v78
    v_lshlrev_b32 v215, 16, v78
    v_rcp_f32 v200, v200
    v_rcp_f32 v201, v201
    v_rcp_f32 v202, v202
    v_rcp_f32 v203, v203
    v_rcp_f32 v204, v204
    v_rcp_f32 v205, v205
    v_rcp_f32 v206, v206
    v_rcp_f32 v207, v207
    v_pk_mul_f32 v[208:209], v[208:209], v[200:201] neg_lo:[1,0] neg_hi:[1,0]
    v_pk_mul_f32 v[210:211], v[210:211], v[202:203] neg_lo:[1,0] neg_hi:[1,0]
    v_pk_mul_f32 v[212:213], v[212:213], v[204:205] neg_lo:[1,0] neg_hi:[1,0]
    v_pk_mul_f32 v[214:215], v[214:215], v[206:207] neg_lo:[1,0] neg_hi:[1,0]
    v_pk_fma_f32 v[112:113], v[80:81], v[200:201], v[208:209]
    v_pk_fma_f32 v[114:115], v[82:83], v[200:201], v[208:209]
    v_pk_fma_f32 v[116:117], v[84:85], v[200:201], v[208:209]
    v_pk_fma_f32 v[118:119], v[86:87], v[200:201], v[208:209]
    v_cvt_pk_bf16_f32 v216, v112, v113
    v_cvt_pk_bf16_f32 v217, v114, v115
    v_cvt_pk_bf16_f32 v218, v116, v117
    v_cvt_pk_bf16_f32 v219, v118, v119
    ds_write_b32 v196, v216 offset:0
    ds_write_b32 v196, v217 offset:4672
    ds_write_b32 v196, v218 offset:9344
    ds_write_b32 v196, v219 offset:14016
    v_pk_fma_f32 v[120:121], v[88:89], v[202:203], v[210:211]
    v_pk_fma_f32 v[122:123], v[90:91], v[202:203], v[210:211]
    v_pk_fma_f32 v[124:125], v[92:93], v[202:203], v[210:211]
    v_pk_fma_f32 v[126:127], v[94:95], v[202:203], v[210:211]
    v_cvt_pk_bf16_f32 v216, v120, v121
    v_cvt_pk_bf16_f32 v217, v122, v123
    v_cvt_pk_bf16_f32 v218, v124, v125
    v_cvt_pk_bf16_f32 v219, v126, v127
    ds_write_b32 v196, v216 offset:1024
    ds_write_b32 v196, v217 offset:5696
    ds_write_b32 v196, v218 offset:10368
    ds_write_b32 v196, v219 offset:15040
    v_pk_fma_f32 v[128:129], v[96:97], v[204:205], v[212:213]
    v_pk_fma_f32 v[130:131], v[98:99], v[204:205], v[212:213]
    v_pk_fma_f32 v[132:133], v[100:101], v[204:205], v[212:213]
    v_pk_fma_f32 v[134:135], v[102:103], v[204:205], v[212:213]
    v_cvt_pk_bf16_f32 v216, v128, v129
    v_cvt_pk_bf16_f32 v217, v130, v131
    v_cvt_pk_bf16_f32 v218, v132, v133
    v_cvt_pk_bf16_f32 v219, v134, v135
    ds_write_b32 v196, v216 offset:2048
    ds_write_b32 v196, v217 offset:6720
    ds_write_b32 v196, v218 offset:11392
    ds_write_b32 v196, v219 offset:16064
    s_waitcnt vmcnt(0)
    v_lshlrev_b32 v104, 16, v60
    v_and_b32 v106, 0xffff0000, v60
    v_lshlrev_b32 v108, 16, v61
    v_and_b32 v110, 0xffff0000, v61
    v_lshlrev_b32 v105, 16, v62
    v_and_b32 v107, 0xffff0000, v62
    v_lshlrev_b32 v109, 16, v63
    v_and_b32 v111, 0xffff0000, v63
    v_pk_fma_f32 v[136:137], v[104:105], v[206:207], v[214:215]
    v_pk_fma_f32 v[138:139], v[106:107], v[206:207], v[214:215]
    v_pk_fma_f32 v[140:141], v[108:109], v[206:207], v[214:215]
    v_pk_fma_f32 v[142:143], v[110:111], v[206:207], v[214:215]
    v_cvt_pk_bf16_f32 v216, v136, v137
    v_cvt_pk_bf16_f32 v217, v138, v139
    v_cvt_pk_bf16_f32 v218, v140, v141
    v_cvt_pk_bf16_f32 v219, v142, v143
    ds_write_b32 v196, v216 offset:3072
    ds_write_b32 v196, v217 offset:7744
    ds_write_b32 v196, v218 offset:12416
    ds_write_b32 v196, v219 offset:17088
    s_branch L_rot_14
L_cold_aux1:
    s_load_dwordx2 s[74:75], s[52:53], s6
    s_mov_b32 s28, s66
    s_mov_b32 s29, s67
    s_mov_b32 s30, 67108864
    s_mov_b32 s31, 0x00020000
    s_mov_b32 s24, s64
    s_mov_b32 s25, s65
    s_mov_b32 s26, 256
    s_mov_b32 s27, 0x00020000
    v_lshlrev_b32 v196, 2, v199
    v_add_u32 v196, 135712, v196
    v_mov_b32 v220, 157696
    v_mov_b32 v221, 0
    ds_write_b32 v220, v221
    s_waitcnt vmcnt(2)
    buffer_load_dwordx2 v[58:59], v195, s[8:11], s17 offen offset:1280
    s_waitcnt vmcnt(2)
    buffer_load_dwordx2 v[60:61], v195, s[8:11], s18 offen offset:0
    s_waitcnt vmcnt(2)
    buffer_load_dwordx2 v[62:63], v195, s[8:11], s18 offen offset:1280
    s_waitcnt vmcnt(2)
    buffer_load_dwordx2 v[48:49], v195, s[8:11], 0 offen offset:0
    s_waitcnt vmcnt(2)
    buffer_load_dword v193, v194, s[24:27], 0 offen sc1
    buffer_load_dwordx4 v[64:67], v192, s[28:31], s20 offen sc1
    buffer_load_dwordx4 v[68:71], v192, s[28:31], s21 offen sc1
    buffer_load_dwordx4 v[72:75], v192, s[28:31], s22 offen sc1
    buffer_load_dwordx4 v[76:79], v192, s[28:31], s23 offen sc1
    buffer_load_dwordx2 v[50:51], v195, s[8:11], 0 offen offset:1280
    s_waitcnt vmcnt(7)
    v_lshlrev_b32 v88, 16, v52
    v_and_b32 v90, 0xffff0000, v52
    v_lshlrev_b32 v92, 16, v53
    v_and_b32 v94, 0xffff0000, v53
    v_lshlrev_b32 v89, 16, v54
    v_and_b32 v91, 0xffff0000, v54
    v_lshlrev_b32 v93, 16, v55
    v_and_b32 v95, 0xffff0000, v55
    v_lshlrev_b32 v96, 16, v56
    v_and_b32 v98, 0xffff0000, v56
    v_lshlrev_b32 v100, 16, v57
    v_and_b32 v102, 0xffff0000, v57
    v_lshlrev_b32 v97, 16, v58
    v_and_b32 v99, 0xffff0000, v58
    v_lshlrev_b32 v101, 16, v59
    v_and_b32 v103, 0xffff0000, v59
    v_lshlrev_b32 v104, 16, v60
    v_and_b32 v106, 0xffff0000, v60
    v_lshlrev_b32 v108, 16, v61
    v_and_b32 v110, 0xffff0000, v61
    v_lshlrev_b32 v105, 16, v62
    v_and_b32 v107, 0xffff0000, v62
    v_lshlrev_b32 v109, 16, v63
    v_and_b32 v111, 0xffff0000, v63
    s_mov_b32 s35, 0
    s_waitcnt vmcnt(1)
L_sw_16:
    v_readfirstlane_b32 s34, v193
    s_add_u32 s35, s35, 1
    s_sub_u32 s5, s34, s32
    s_add_u32 s5, s5, 1000
    s_cmp_ge_u32 s35, 400
    s_cselect_b32 s5, 0, s5
    s_cmp_lt_u32 s5, 2000
    s_cselect_b32 s34, s34, 0
    v_xor_b32 v200, s34, v65
    v_xor_b32 v201, s34, v67
    v_xor_b32 v202, s34, v69
    v_xor_b32 v203, s34, v71
    v_xor_b32 v204, s34, v73
    v_xor_b32 v205, s34, v75
    v_xor_b32 v206, s34, v77
    v_xor_b32 v207, s34, v79
    v_or3_b32 v200, v200, v201, v202
    v_or3_b32 v203, v203, v204, v205
    v_or3_b32 v200, v200, v206, v207
    v_or_b32 v200, v200, v203
    v_cmp_ne_u32 vcc, 0, v200
    s_cmp_eq_u32 s34, 0
    s_cbranch_scc1 L_sw_16_r
    s_nop 1
    s_cbranch_vccz L_sw_16_ok
L_sw_16_r:
    s_cmp_ge_u32 s35, 262144
    s_cbranch_scc1 L_sw_16_ok
    s_sleep 4
    buffer_load_dword v193, v194, s[24:27], 0 offen sc1
    buffer_load_dwordx4 v[64:67], v192, s[28:31], s20 offen sc1
    buffer_load_dwordx4 v[68:71], v192, s[28:31], s21 offen sc1
    buffer_load_dwordx4 v[72:75], v192, s[28:31], s22 offen sc1
    buffer_load_dwordx4 v[76:79], v192, s[28:31], s23 offen sc1
    s_waitcnt vmcnt(0)
    s_branch L_sw_16
L_sw_16_ok:
    v_and_b32 v200, 0xffff0000, v64
    v_lshlrev_b32 v208, 16, v64
    v_and_b32 v201, 0xffff0000, v66
    v_lshlrev_b32 v209, 16, v66
    v_and_b32 v202, 0xffff0000, v68
    v_lshlrev_b32 v210, 16, v68
    v_and_b32 v203, 0xffff0000, v70
    v_lshlrev_b32 v211, 16, v70
    v_and_b32 v204, 0xffff0000, v72
    v_lshlrev_b32 v212, 16, v72
    v_and_b32 v205, 0xffff0000, v74
    v_lshlrev_b32 v213, 16, v74
    v_and_b32 v206, 0xffff0000, v76
    v_lshlrev_b32 v214, 16, v76
    v_and_b32 v207, 0xffff0000, v78
    v_lshlrev_b32 v215, 16, v78
    v_rcp_f32 v200, v200
    v_rcp_f32 v201, v201
    v_rcp_f32 v202, v202
    v_rcp_f32 v203, v203
    v_rcp_f32 v204, v204
    v_rcp_f32 v205, v205
    v_rcp_f32 v206, v206
    v_rcp_f32 v207, v207
    v_pk_mul_f32 v[208:209], v[208:209], v[200:201] neg_lo:[1,0] neg_hi:[1,0]
    v_pk_mul_f32 v[210:211], v[210:211], v[202:203] neg_lo:[1,0] neg_hi:[1,0]
    v_pk_mul_f32 v[212:213], v[212:213], v[204:205] neg_lo:[1,0] neg_hi:[1,0]
    v_pk_mul_f32 v[214:215], v[214:215], v[206:207] neg_lo:[1,0] neg_hi:[1,0]
    v_pk_fma_f32 v[120:121], v[88:89], v[202:203], v[210:211]
    v_pk_fma_f32 v[122:123], v[90:91], v[202:203], v[210:211]
    v_pk_fma_f32 v[124:125], v[92:93], v[202:203], v[210:211]
    v_pk_fma_f32 v[126:127], v[94:95], v[202:203], v[210:211]
    v_cvt_pk_bf16_f32 v216, v120, v121
    v_cvt_pk_bf16_f32 v217, v122, v123
    v_cvt_pk_bf16_f32 v218, v124, v125
    v_cvt_pk_bf16_f32 v219, v126, v127
    ds_write_b32 v196, v216 offset:1024
    ds_write_b32 v196, v217 offset:5696
    ds_write_b32 v196, v218 offset:10368
    ds_write_b32 v196, v219 offset:15040
    v_pk_fma_f32 v[128:129], v[96:97], v[204:205], v[212:213]
    v_pk_fma_f32 v[130:131], v[98:99], v[204:205], v[212:213]
    v_pk_fma_f32 v[132:133], v[100:101], v[204:205], v[212:213]
    v_pk_fma_f32 v[134:135], v[102:103], v[204:205], v[212:213]
    v_cvt_pk_bf16_f32 v216, v128, v129
    v_cvt_pk_bf16_f32 v217, v130, v131
    v_cvt_pk_bf16_f32 v218, v132, v133
    v_cvt_pk_bf16_f32 v219, v134, v135
    ds_write_b32 v196, v216 offset:2048
    ds_write_b32 v196, v217 offset:6720
    ds_write_b32 v196, v218 offset:11392
    ds_write_b32 v196, v219 offset:16064
    v_pk_fma_f32 v[136:137], v[104:105], v[206:207], v[214:215]
    v_pk_fma_f32 v[138:139], v[106:107], v[206:207], v[214:215]
    v_pk_fma_f32 v[140:141], v[108:109], v[206:207], v[214:215]
    v_pk_fma_f32 v[142:143], v[110:111], v[206:207], v[214:215]
    v_cvt_pk_bf16_f32 v216, v136, v137
    v_cvt_pk_bf16_f32 v217, v138, v139
    v_cvt_pk_bf16_f32 v218, v140, v141
    v_cvt_pk_bf16_f32 v219, v142, v143
    ds_write_b32 v196, v216 offset:3072
    ds_write_b32 v196, v217 offset:7744
    ds_write_b32 v196, v218 offset:12416
    ds_write_b32 v196, v219 offset:17088
    s_waitcnt vmcnt(0)
    v_lshlrev_b32 v80, 16, v48
    v_and_b32 v82, 0xffff0000, v48
    v_lshlrev_b32 v84, 16, v49
    v_and_b32 v86, 0xffff0000, v49
    v_lshlrev_b32 v81, 16, v50
    v_and_b32 v83, 0xffff0000, v50
    v_lshlrev_b32 v85, 16, v51
    v_and_b32 v87, 0xffff0000, v51
    v_pk_fma_f32 v[112:113], v[80:81], v[200:201], v[208:209]
    v_pk_fma_f32 v[114:115], v[82:83], v[200:201], v[208:209]
    v_pk_fma_f32 v[116:117], v[84:85], v[200:201], v[208:209]
    v_pk_fma_f32 v[118:119], v[86:87], v[200:201], v[208:209]
    v_cvt_pk_bf16_f32 v216, v112, v113
    v_cvt_pk_bf16_f32 v217, v114, v115
    v_cvt_pk_bf16_f32 v218, v116, v117
    v_cvt_pk_bf16_f32 v219, v118, v119
    ds_write_b32 v196, v216 offset:0
    ds_write_b32 v196, v217 offset:4672
    ds_write_b32 v196, v218 offset:9344
    ds_write_b32 v196, v219 offset:14016
    s_branch L_rot_14
L_cold_aux2:
    s_load_dwordx2 s[74:75], s[52:53], s6
    s_mov_b32 s28, s66
    s_mov_b32 s29, s67
    s_mov_b32 s30, 67108864
    s_mov_b32 s31, 0x00020000
    s_mov_b32 s24, s64
    s_mov_b32 s25, s65
    s_mov_b32 s26, 256
    s_mov_b32 s27, 0x00020000
    v_lshlrev_b32 v196, 2, v199
    v_add_u32 v196, 135712, v196
    v_mov_b32 v220, 157696
    v_mov_b32 v221, 0
    ds_write_b32 v220, v221
    s_waitcnt vmcnt(2)
    buffer_load_dwordx2 v[62:63], v195, s[8:11], s18 offen offset:1280
    s_waitcnt vmcnt(2)
    buffer_load_dwordx2 v[48:49], v195, s[8:11], 0 offen offset:0
    s_waitcnt vmcnt(2)
    buffer_load_dwordx2 v[50:51], v195, s[8:11], 0 offen offset:1280
    s_waitcnt vmcnt(2)
    buffer_load_dwordx2 v[52:53], v195, s[8:11], s16 offen offset:0
    s_waitcnt vmcnt(2)
    buffer_load_dword v193, v194, s[24:27], 0 offen sc1
    buffer_load_dwordx4 v[64:67], v192, s[28:31], s20 offen sc1
    buffer_load_dwordx4 v[68:71], v192, s[28:31], s21 offen sc1
    buffer_load_dwordx4 v[72:75], v192, s[28:31], s22 offen sc1
    buffer_load_dwordx4 v[76:79], v192, s[28:31], s23 offen sc1
    buffer_load_dwordx2 v[54:55], v195, s[8:11], s16 offen offset:1280
    s_waitcnt vmcnt(7)
    v_lshlrev_b32 v96, 16, v56
    v_and_b32 v98, 0xffff0000, v56
    v_lshlrev_b32 v100, 16, v57
    v_and_b32 v102, 0xffff0000, v57
    v_lshlrev_b32 v97, 16, v58
    v_and_b32 v99, 0xffff0000, v58
    v_lshlrev_b32 v101, 16, v59
    v_and_b32 v103, 0xffff0000, v59
    v_lshlrev_b32 v104, 16, v60
    v_and_b32 v106, 0xffff0000, v60
    v_lshlrev_b32 v108, 16, v61
    v_and_b32 v110, 0xffff0000, v61
    v_lshlrev_b32 v105, 16, v62
    v_and_b32 v107, 0xffff0000, v62
    v_lshlrev_b32 v109, 16, v63
    v_and_b32 v111, 0xffff0000, v63
    v_lshlrev_b32 v80, 16, v48
    v_and_b32 v82, 0xffff0000, v48
    v_lshlrev_b32 v84, 16, v49
    v_and_b32 v86, 0xffff0000, v49
    v_lshlrev_b32 v81, 16, v50
    v_and_b32 v83, 0xffff0000, v50
    v_lshlrev_b32 v85, 16, v51
    v_and_b32 v87, 0xffff0000, v51
    s_mov_b32 s35, 0
    s_waitcnt vmcnt(1)
L_sw_17:
    v_readfirstlane_b32 s34, v193
    s_add_u32 s35, s35, 1
    s_sub_u32 s5, s34, s32
    s_add_u32 s5, s5, 1000
    s_cmp_ge_u32 s35, 400
    s_cselect_b32 s5, 0, s5
    s_cmp_lt_u32 s5, 2000
    s_cselect_b32 s34, s34, 0
    v_xor_b32 v200, s34, v65
    v_xor_b32 v201, s34, v67
    v_xor_b32 v202, s34, v69
    v_xor_b32 v203, s34, v71
    v_xor_b32 v204, s34, v73
    v_xor_b32 v205, s34, v75
    v_xor_b32 v206, s34, v77
    v_xor_b32 v207, s34, v79
    v_or3_b32 v200, v200, v201, v202
    v_or3_b32 v203, v203, v204, v205
    v_or3_b32 v200, v200, v206, v207
    v_or_b32 v200, v200, v203
    v_cmp_ne_u32 vcc, 0, v200
    s_cmp_eq_u32 s34, 0
    s_cbranch_scc1 L_sw_17_r
    s_nop 1
    s_cbranch_vccz L_sw_17_ok
L_sw_17_r:
    s_cmp_ge_u32 s35, 262144
    s_cbranch_scc1 L_sw_17_ok
    s_sleep 4
    buffer_load_dword v193, v194, s[24:27], 0 offen sc1
    buffer_load_dwordx4 v[64:67], v192, s[28:31], s20 offen sc1
    buffer_load_dwordx4 v[68:71], v192, s[28:31], s21 offen sc1
    buffer_load_dwordx4 v[72:75], v192, s[28:31], s22 offen sc1
    buffer_load_dwordx4 v[76:79], v192, s[28:31], s23 offen sc1
    s_waitcnt vmcnt(0)
    s_branch L_sw_17
L_sw_17_ok:
    v_and_b32 v200, 0xffff0000, v64
    v_lshlrev_b32 v208, 16, v64
    v_and_b32 v201, 0xffff0000, v66
    v_lshlrev_b32 v209, 16, v66
    v_and_b32 v202, 0xffff0000, v68
    v_lshlrev_b32 v210, 16, v68
    v_and_b32 v203, 0xffff0000, v70
    v_lshlrev_b32 v211, 16, v70
    v_and_b32 v204, 0xffff0000, v72
    v_lshlrev_b32 v212, 16, v72
    v_and_b32 v205, 0xffff0000, v74
    v_lshlrev_b32 v213, 16, v74
    v_and_b32 v206, 0xffff0000, v76
    v_lshlrev_b32 v214, 16, v76
    v_and_b32 v207, 0xffff0000, v78
    v_lshlrev_b32 v215, 16, v78
    v_rcp_f32 v200, v200
    v_rcp_f32 v201, v201
    v_rcp_f32 v202, v202
    v_rcp_f32 v203, v203
    v_rcp_f32 v204, v204
    v_rcp_f32 v205, v205
    v_rcp_f32 v206, v206
    v_rcp_f32 v207, v207
    v_pk_mul_f32 v[208:209], v[208:209], v[200:201] neg_lo:[1,0] neg_hi:[1,0]
    v_pk_mul_f32 v[210:211], v[210:211], v[202:203] neg_lo:[1,0] neg_hi:[1,0]
    v_pk_mul_f32 v[212:213], v[212:213], v[204:205] neg_lo:[1,0] neg_hi:[1,0]
    v_pk_mul_f32 v[214:215], v[214:215], v[206:207] neg_lo:[1,0] neg_hi:[1,0]
    v_pk_fma_f32 v[128:129], v[96:97], v[204:205], v[212:213]
    v_pk_fma_f32 v[130:131], v[98:99], v[204:205], v[212:213]
    v_pk_fma_f32 v[132:133], v[100:101], v[204:205], v[212:213]
    v_pk_fma_f32 v[134:135], v[102:103], v[204:205], v[212:213]
    v_cvt_pk_bf16_f32 v216, v128, v129
    v_cvt_pk_bf16_f32 v217, v130, v131
    v_cvt_pk_bf16_f32 v218, v132, v133
    v_cvt_pk_bf16_f32 v219, v134, v135
    ds_write_b32 v196, v216 offset:2048
    ds_write_b32 v196, v217 offset:6720
    ds_write_b32 v196, v218 offset:11392
    ds_write_b32 v196, v219 offset:16064
    v_pk_fma_f32 v[136:137], v[104:105], v[206:207], v[214:215]
    v_pk_fma_f32 v[138:139], v[106:107], v[206:207], v[214:215]
    v_pk_fma_f32 v[140:141], v[108:109], v[206:207], v[214:215]
    v_pk_fma_f32 v[142:143], v[110:111], v[206:207], v[214:215]
    v_cvt_pk_bf16_f32 v216, v136, v137
    v_cvt_pk_bf16_f32 v217, v138, v139
    v_cvt_pk_bf16_f32 v218, v140, v141
    v_cvt_pk_bf16_f32 v219, v142, v143
    ds_write_b32 v196, v216 offset:3072
    ds_write_b32 v196, v217 offset:7744
    ds_write_b32 v196, v218 offset:12416
    ds_write_b32 v196, v219 offset:17088
    v_pk_fma_f32 v[112:113], v[80:81], v[200:201], v[208:209]
    v_pk_fma_f32 v[114:115], v[82:83], v[200:201], v[208:209]
    v_pk_fma_f32 v[116:117], v[84:85], v[200:201], v[208:209]
    v_pk_fma_f32 v[118:119], v[86:87], v[200:201], v[208:209]
    v_cvt_pk_bf16_f32 v216, v112, v113
    v_cvt_pk_bf16_f32 v217, v114, v115
    v_cvt_pk_bf16_f32 v218, v116, v117
    v_cvt_pk_bf16_f32 v219, v118, v119
    ds_write_b32 v196, v216 offset:0
    ds_write_b32 v196, v217 offset:4672
    ds_write_b32 v196, v218 offset:9344
    ds_write_b32 v196, v219 offset:14016
    s_waitcnt vmcnt(0)
    v_lshlrev_b32 v88, 16, v52
    v_and_b32 v90, 0xffff0000, v52
    v_lshlrev_b32 v92, 16, v53
    v_and_b32 v94, 0xffff0000, v53
    v_lshlrev_b32 v89, 16, v54
    v_and_b32 v91, 0xffff0000, v54
    v_lshlrev_b32 v93, 16, v55
    v_and_b32 v95, 0xffff0000, v55
    v_pk_fma_f32 v[120:121], v[88:89], v[202:203], v[210:211]
    v_pk_fma_f32 v[122:123], v[90:91], v[202:203], v[210:211]
    v_pk_fma_f32 v[124:125], v[92:93], v[202:203], v[210:211]
    v_pk_fma_f32 v[126:127], v[94:95], v[202:203], v[210:211]
    v_cvt_pk_bf16_f32 v216, v120, v121
    v_cvt_pk_bf16_f32 v217, v122, v123
    v_cvt_pk_bf16_f32 v218, v124, v125
    v_cvt_pk_bf16_f32 v219, v126, v127
    ds_write_b32 v196, v216 offset:1024
    ds_write_b32 v196, v217 offset:5696
    ds_write_b32 v196, v218 offset:10368
    ds_write_b32 v196, v219 offset:15040
    s_branch L_rot_14
L_cold_aux3:
    s_load_dwordx2 s[74:75], s[52:53], s6
    s_mov_b32 s28, s66
    s_mov_b32 s29, s67
    s_mov_b32 s30, 67108864
    s_mov_b32 s31, 0x00020000
    s_mov_b32 s24, s64
    s_mov_b32 s25, s65
    s_mov_b32 s26, 256
    s_mov_b32 s27, 0x00020000
    v_lshlrev_b32 v196, 2, v199
    v_add_u32 v196, 135712, v196
    v_mov_b32 v220, 157696
    v_mov_b32 v221, 0
    ds_write_b32 v220, v221
    s_waitcnt vmcnt(2)
    buffer_load_dwordx2 v[50:51], v195, s[8:11], 0 offen offset:1280
    s_waitcnt vmcnt(2)
    buffer_load_dwordx2 v[52:53], v195, s[8:11], s16 offen offset:0
    s_waitcnt vmcnt(2)
    buffer_load_dwordx2 v[54:55], v195, s[8:11], s16 offen offset:1280
    s_waitcnt vmcnt(2)
    buffer_load_dwordx2 v[56:57], v195, s[8:11], s17 offen offset:0
    s_waitcnt vmcnt(2)
    buffer_load_dword v193, v194, s[24:27], 0 offen sc1
    buffer_load_dwordx4 v[64:67], v192, s[28:31], s20 offen sc1
    buffer_load_dwordx4 v[68:71], v192, s[28:31], s21 offen sc1
    buffer_load_dwordx4 v[72:75], v192, s[28:31], s22 offen sc1
    buffer_load_dwordx4 v[76:79], v192, s[28:31], s23 offen sc1
    buffer_load_dwordx2 v[58:59], v195, s[8:11], s17 offen offset:1280
    s_waitcnt vmcnt(7)
    v_lshlrev_b32 v104, 16, v60
    v_and_b32 v106, 0xffff0000, v60
    v_lshlrev_b32 v108, 16, v61
    v_and_b32 v110, 0xffff0000, v61
    v_lshlrev_b32 v105, 16, v62
    v_and_b32 v107, 0xffff0000, v62
    v_lshlrev_b32 v109, 16, v63
    v_and_b32 v111, 0xffff0000, v63
    v_lshlrev_b32 v80, 16, v48
    v_and_b32 v82, 0xffff0000, v48
    v_lshlrev_b32 v84, 16, v49
    v_and_b32 v86, 0xffff0000, v49
    v_lshlrev_b32 v81, 16, v50
    v_and_b32 v83, 0xffff0000, v50
    v_lshlrev_b32 v85, 16, v51
    v_and_b32 v87, 0xffff0000, v51
    v_lshlrev_b32 v88, 16, v52
    v_and_b32 v90, 0xffff0000, v52
    v_lshlrev_b32 v92, 16, v53
    v_and_b32 v94, 0xffff0000, v53
    v_lshlrev_b32 v89, 16, v54
    v_and_b32 v91, 0xffff0000, v54
    v_lshlrev_b32 v93, 16, v55
    v_and_b32 v95, 0xffff0000, v55
    s_mov_b32 s35, 0
    s_waitcnt vmcnt(1)
L_sw_18:
    v_readfirstlane_b32 s34, v193
    s_add_u32 s35, s35, 1
    s_sub_u32 s5, s34, s32
    s_add_u32 s5, s5, 1000
    s_cmp_ge_u32 s35, 400
    s_cselect_b32 s5, 0, s5
    s_cmp_lt_u32 s5, 2000
    s_cselect_b32 s34, s34, 0
    v_xor_b32 v200, s34, v65
    v_xor_b32 v201, s34, v67
    v_xor_b32 v202, s34, v69
    v_xor_b32 v203, s34, v71
    v_xor_b32 v204, s34, v73
    v_xor_b32 v205, s34, v75
    v_xor_b32 v206, s34, v77
    v_xor_b32 v207, s34, v79
    v_or3_b32 v200, v200, v201, v202
    v_or3_b32 v203, v203, v204, v205
    v_or3_b32 v200, v200, v206, v207
    v_or_b32 v200, v200, v203
    v_cmp_ne_u32 vcc, 0, v200
    s_cmp_eq_u32 s34, 0
    s_cbranch_scc1 L_sw_18_r
    s_nop 1
    s_cbranch_vccz L_sw_18_ok
L_sw_18_r:
    s_cmp_ge_u32 s35, 262144
    s_cbranch_scc1 L_sw_18_ok
    s_sleep 4
    buffer_load_dword v193, v194, s[24:27], 0 offen sc1
    buffer_load_dwordx4 v[64:67], v192, s[28:31], s20 offen sc1
    buffer_load_dwordx4 v[68:71], v192, s[28:31], s21 offen sc1
    buffer_load_dwordx4 v[72:75], v192, s[28:31], s22 offen sc1
    buffer_load_dwordx4 v[76:79], v192, s[28:31], s23 offen sc1
    s_waitcnt vmcnt(0)
    s_branch L_sw_18
L_sw_18_ok:
    v_and_b32 v200, 0xffff0000, v64
    v_lshlrev_b32 v208, 16, v64
    v_and_b32 v201, 0xffff0000, v66
    v_lshlrev_b32 v209, 16, v66
    v_and_b32 v202, 0xffff0000, v68
    v_lshlrev_b32 v210, 16, v68
    v_and_b32 v203, 0xffff0000, v70
    v_lshlrev_b32 v211, 16, v70
    v_and_b32 v204, 0xffff0000, v72
    v_lshlrev_b32 v212, 16, v72
    v_and_b32 v205, 0xffff0000, v74
    v_lshlrev_b32 v213, 16, v74
    v_and_b32 v206, 0xffff0000, v76
    v_lshlrev_b32 v214, 16, v76
    v_and_b32 v207, 0xffff0000, v78
    v_lshlrev_b32 v215, 16, v78
    v_rcp_f32 v200, v200
    v_rcp_f32 v201, v201
    v_rcp_f32 v202, v202
    v_rcp_f32 v203, v203
    v_rcp_f32 v204, v204
    v_rcp_f32 v205, v205
    v_rcp_f32 v206, v206
    v_rcp_f32 v207, v207
    v_pk_mul_f32 v[208:209], v[208:209], v[200:201] neg_lo:[1,0] neg_hi:[1,0]
    v_pk_mul_f32 v[210:211], v[210:211], v[202:203] neg_lo:[1,0] neg_hi:[1,0]
    v_pk_mul_f32 v[212:213], v[212:213], v[204:205] neg_lo:[1,0] neg_hi:[1,0]
    v_pk_mul_f32 v[214:215], v[214:215], v[206:207] neg_lo:[1,0] neg_hi:[1,0]
    v_pk_fma_f32 v[136:137], v[104:105], v[206:207], v[214:215]
    v_pk_fma_f32 v[138:139], v[106:107], v[206:207], v[214:215]
    v_pk_fma_f32 v[140:141], v[108:109], v[206:207], v[214:215]
    v_pk_fma_f32 v[142:143], v[110:111], v[206:207], v[214:215]
    v_cvt_pk_bf16_f32 v216, v136, v137
    v_cvt_pk_bf16_f32 v217, v138, v139
    v_cvt_pk_bf16_f32 v218, v140, v141
    v_cvt_pk_bf16_f32 v219, v142, v143
    ds_write_b32 v196, v216 offset:3072
    ds_write_b32 v196, v217 offset:7744
    ds_write_b32 v196, v218 offset:12416
    ds_write_b32 v196, v219 offset:17088
    v_pk_fma_f32 v[112:113], v[80:81], v[200:201], v[208:209]
    v_pk_fma_f32 v[114:115], v[82:83], v[200:201], v[208:209]
    v_pk_fma_f32 v[116:117], v[84:85], v[200:201], v[208:209]
    v_pk_fma_f32 v[118:119], v[86:87], v[200:201], v[208:209]
    v_cvt_pk_bf16_f32 v216, v112, v113
    v_cvt_pk_bf16_f32 v217, v114, v115
    v_cvt_pk_bf16_f32 v218, v116, v117
    v_cvt_pk_bf16_f32 v219, v118, v119
    ds_write_b32 v196, v216 offset:0
    ds_write_b32 v196, v217 offset:4672
    ds_write_b32 v196, v218 offset:9344
    ds_write_b32 v196, v219 offset:14016
    v_pk_fma_f32 v[120:121], v[88:89], v[202:203], v[210:211]
    v_pk_fma_f32 v[122:123], v[90:91], v[202:203], v[210:211]
    v_pk_fma_f32 v[124:125], v[92:93], v[202:203], v[210:211]
    v_pk_fma_f32 v[126:127], v[94:95], v[202:203], v[210:211]
    v_cvt_pk_bf16_f32 v216, v120, v121
    v_cvt_pk_bf16_f32 v217, v122, v123
    v_cvt_pk_bf16_f32 v218, v124, v125
    v_cvt_pk_bf16_f32 v219, v126, v127
    ds_write_b32 v196, v216 offset:1024
    ds_write_b32 v196, v217 offset:5696
    ds_write_b32 v196, v218 offset:10368
    ds_write_b32 v196, v219 offset:15040
    s_waitcnt vmcnt(0)
    v_lshlrev_b32 v96, 16, v56
    v_and_b32 v98, 0xffff0000, v56
    v_lshlrev_b32 v100, 16, v57
    v_and_b32 v102, 0xffff0000, v57
    v_lshlrev_b32 v97, 16, v58
    v_and_b32 v99, 0xffff0000, v58
    v_lshlrev_b32 v101, 16, v59
    v_and_b32 v103, 0xffff0000, v59
    v_pk_fma_f32 v[128:129], v[96:97], v[204:205], v[212:213]
    v_pk_fma_f32 v[130:131], v[98:99], v[204:205], v[212:213]
    v_pk_fma_f32 v[132:133], v[100:101], v[204:205], v[212:213]
    v_pk_fma_f32 v[134:135], v[102:103], v[204:205], v[212:213]
    v_cvt_pk_bf16_f32 v216, v128, v129
    v_cvt_pk_bf16_f32 v217, v130, v131
    v_cvt_pk_bf16_f32 v218, v132, v133
    v_cvt_pk_bf16_f32 v219, v134, v135
    ds_write_b32 v196, v216 offset:2048
    ds_write_b32 v196, v217 offset:6720
    ds_write_b32 v196, v218 offset:11392
    ds_write_b32 v196, v219 offset:16064
L_rot_14:
    s_waitcnt lgkmcnt(0)
    s_barrier
    s_lshl_b32 s76, s74, 16
    s_and_b32 s77, s74, 0xffff0000
    s_lshl_b32 s78, s75, 16
    s_and_b32 s79, s75, 0xffff0000
    s_mov_b32 s96, s76
    s_mov_b32 s97, s77
    s_mov_b32 s98, s78
    s_mov_b32 s99, s79
    v_lshlrev_b32 v197, 3, v199
    v_add_u32 v198, 67584, v197
    s_bfe_u32 s4, s2, 0x20001
    s_lshl_b32 s4, s4, 2
    s_bfe_u32 s5, s2, 0x20003
    s_add_u32 s68, s4, s5
    s_and_b32 s4, s2, 1
    s_mul_i32 s4, s4, 7
    s_lshr_b32 s5, s2, 5
    s_add_u32 s69, s4, s5
    s_cmp_lt_u32 s5, 7
    s_cselect_b32 s70, 1, 0
    s_cselect_b32 s4, 0, 64
    s_sub_u32 s71, s2, s4
    s_sub_u32 s71, s71, 160
    s_and_b32 s72, s3, 1
    v_lshlrev_b32 v10, 4, v1
    v_add_u32 v11, 4096, v10
    v_lshlrev_b32 v36, 7, v1
    s_lshr_b32 s15, s2, 5
    s_mul_i32 s4, s15, 54
    s_mul_i32 s5, s72, 27
    s_add_u32 s4, s4, s5
    s_mul_i32 s4, s4, 5120
    s_add_u32 s12, s4, 12582912
    s_mul_i32 s13, s72, 10240
    v_lshrrev_b32 v12, 4, v1
    v_bfe_u32 v13, v1, 1, 3
    v_or_b32 v14, 0, v12
    v_xor_b32 v13, v13, v14
    v_and_b32 v14, 1, v1
    v_lshl_add_u32 v13, v13, 1, v14
    v_mul_u32_u24 v12, 3456, v12
    v_lshl_add_u32 v12, v13, 4, v12
    s_lshl_b32 s4, s69, 8
    s_add_u32 s4, s4, 0
    v_add_u32 v2, s4, v12
    v_lshrrev_b32 v12, 4, v1
    v_bfe_u32 v13, v1, 1, 3
    v_or_b32 v14, 4, v12
    v_xor_b32 v13, v13, v14
    v_and_b32 v14, 1, v1
    v_lshl_add_u32 v13, v13, 1, v14
    v_mul_u32_u24 v12, 3456, v12
    v_lshl_add_u32 v12, v13, 4, v12
    s_lshl_b32 s4, s69, 8
    s_add_u32 s4, s4, 12800
    v_add_u32 v3, s4, v12
    v_lshrrev_b32 v12, 4, v1
    v_bfe_u32 v13, v1, 1, 3
    v_or_b32 v14, 0, v12
    v_xor_b32 v13, v13, v14
    v_and_b32 v14, 1, v1
    v_lshl_add_u32 v13, v13, 1, v14
    v_mul_u32_u24 v12, 3456, v12
    v_lshl_add_u32 v12, v13, 4, v12
    s_lshl_b32 s4, s69, 8
    s_add_u32 s4, s4, 25600
    v_add_u32 v4, s4, v12
    v_lshrrev_b32 v12, 4, v1
    v_bfe_u32 v13, v1, 1, 3
    v_or_b32 v14, 4, v12
    v_xor_b32 v13, v13, v14
    v_and_b32 v14, 1, v1
    v_lshl_add_u32 v13, v13, 1, v14
    v_mul_u32_u24 v12, 3456, v12
    v_lshl_add_u32 v12, v13, 4, v12
    s_lshl_b32 s4, s69, 8
    s_add_u32 s4, s4, 38400
    v_add_u32 v5, s4, v12
    s_lshl_b32 s4, s68, 10
    s_lshl_b32 s5, s72, 16
    s_add_u32 s4, s4, s5
    s_add_u32 s4, s4, 1048576
    v_add_u32 v6, s4, v10
    v_add_u32 v7, 15232, v6
    v_add_u32 v8, 30464, v6
    v_add_u32 v9, 45696, v6
    s_cmp_ge_u32 s3, 6
    s_cbranch_scc1 L_wp_19
    s_lshl_b32 s73, s72, 13
    s_add_u32 s73, s73, 9216
    s_cmp_eq_u32 s72, 0
    s_cselect_b32 s8, s56, s58
    s_cselect_b32 s9, s57, s59
    s_mov_b32 s10, 2211840
    s_mov_b32 s11, 0x00020000
    s_add_u32 m0, s73, 0
    s_mov_b32 s76, 0
    buffer_load_dwordx4 v2, s[8:11], s76 offen offset:0 lds
    buffer_load_dwordx4 v3, s[8:11], s76 offen offset:1024 lds
    buffer_load_dwordx4 v4, s[8:11], s76 offen offset:2048 lds
    buffer_load_dwordx4 v5, s[8:11], s76 offen offset:3072 lds
    s_add_u32 m0, s73, 4096
    s_mov_b32 s76, 55296
    buffer_load_dwordx4 v2, s[8:11], s76 offen offset:0 lds
    buffer_load_dwordx4 v3, s[8:11], s76 offen offset:1024 lds
    buffer_load_dwordx4 v4, s[8:11], s76 offen offset:2048 lds
    buffer_load_dwordx4 v5, s[8:11], s76 offen offset:3072 lds
    s_add_u32 m0, s73, 33792
    s_mov_b32 s76, 110592
    buffer_load_dwordx4 v2, s[8:11], s76 offen offset:0 lds
    buffer_load_dwordx4 v3, s[8:11], s76 offen offset:1024 lds
    buffer_load_dwordx4 v4, s[8:11], s76 offen offset:2048 lds
    buffer_load_dwordx4 v5, s[8:11], s76 offen offset:3072 lds
    s_add_u32 m0, s73, 37888
    s_mov_b32 s76, 165888
    buffer_load_dwordx4 v2, s[8:11], s76 offen offset:0 lds
    buffer_load_dwordx4 v3, s[8:11], s76 offen offset:1024 lds
    buffer_load_dwordx4 v4, s[8:11], s76 offen offset:2048 lds
    buffer_load_dwordx4 v5, s[8:11], s76 offen offset:3072 lds
    s_add_u32 m0, s73, 67584
    s_mov_b32 s76, 221184
    buffer_load_dwordx4 v2, s[8:11], s76 offen offset:0 lds
    buffer_load_dwordx4 v3, s[8:11], s76 offen offset:1024 lds
    buffer_load_dwordx4 v4, s[8:11], s76 offen offset:2048 lds
    buffer_load_dwordx4 v5, s[8:11], s76 offen offset:3072 lds
    s_add_u32 m0, s73, 71680
    s_mov_b32 s76, 276480
    buffer_load_dwordx4 v2, s[8:11], s76 offen offset:0 lds
    buffer_load_dwordx4 v3, s[8:11], s76 offen offset:1024 lds
    buffer_load_dwordx4 v4, s[8:11], s76 offen offset:2048 lds
    buffer_load_dwordx4 v5, s[8:11], s76 offen offset:3072 lds
    s_add_u32 m0, s73, 101376
    s_mov_b32 s76, 331776
    buffer_load_dwordx4 v2, s[8:11], s76 offen offset:0 lds
    buffer_load_dwordx4 v3, s[8:11], s76 offen offset:1024 lds
    buffer_load_dwordx4 v4, s[8:11], s76 offen offset:2048 lds
    buffer_load_dwordx4 v5, s[8:11], s76 offen offset:3072 lds
    s_add_u32 m0, s73, 105472
    s_mov_b32 s76, 387072
    buffer_load_dwordx4 v2, s[8:11], s76 offen offset:0 lds
    buffer_load_dwordx4 v3, s[8:11], s76 offen offset:1024 lds
    buffer_load_dwordx4 v4, s[8:11], s76 offen offset:2048 lds
    buffer_load_dwordx4 v5, s[8:11], s76 offen offset:3072 lds
L_wp_19:
    v_fmac_f32 v80, s96, v112
    v_fmac_f32 v81, s96, v113
    v_fmac_f32 v82, s97, v114
    v_fmac_f32 v83, s97, v115
    v_fmac_f32 v84, s98, v116
    v_fmac_f32 v85, s98, v117
    v_fmac_f32 v86, s99, v118
    v_fmac_f32 v87, s99, v119
    v_fmac_f32 v88, s96, v120
    v_fmac_f32 v89, s96, v121
    v_fmac_f32 v90, s97, v122
    v_fmac_f32 v91, s97, v123
    v_fmac_f32 v92, s98, v124
    v_fmac_f32 v93, s98, v125
    v_fmac_f32 v94, s99, v126
    v_fmac_f32 v95, s99, v127
    v_fmac_f32 v96, s96, v128
    v_fmac_f32 v97, s96, v129
    v_fmac_f32 v98, s97, v130
    v_fmac_f32 v99, s97, v131
    v_fmac_f32 v100, s98, v132
    v_fmac_f32 v101, s98, v133
    v_fmac_f32 v102, s99, v134
    v_fmac_f32 v103, s99, v135
    v_fmac_f32 v104, s96, v136
    v_fmac_f32 v105, s96, v137
    v_fmac_f32 v106, s97, v138
    v_fmac_f32 v107, s97, v139
    v_fmac_f32 v108, s98, v140
    v_fmac_f32 v109, s98, v141
    v_fmac_f32 v110, s99, v142
    v_fmac_f32 v111, s99, v143
    s_lshl_b32 s4, s19, 14
    s_add_u32 s20, s4, 1048576
    s_add_u32 s21, s20, 4096
    s_add_u32 s22, s20, 8192
    s_add_u32 s23, s20, 12288
    s_lshl_b32 s4, s19, 7
    s_add_u32 s19, s4, 278528
    v_mov_b32 v220, 157696
    v_mov_b32 v221, 1
    s_waitcnt vmcnt(0)
    s_barrier
    ds_read_b64 v[144:145], v197 offset:0
    ds_read_b64 v[146:147], v197 offset:33792
    ds_read_b64 v[148:149], v198 offset:0
    ds_read_b64 v[150:151], v198 offset:33792
    ds_read_b64 v[152:153], v197 offset:2048
    ds_read_b64 v[154:155], v197 offset:35840
    ds_read_b64 v[156:157], v198 offset:2048
    ds_read_b64 v[158:159], v198 offset:35840
    ds_read_b64 v[160:161], v197 offset:4096
    ds_read_b64 v[162:163], v197 offset:37888
    ds_read_b64 v[164:165], v198 offset:4096
    ds_read_b64 v[166:167], v198 offset:37888
    s_waitcnt lgkmcnt(8)
    v_add_f32 v144, v144, v80
    v_add_f32 v145, v145, v81
    v_add_f32 v146, v146, v82
    v_add_f32 v147, v147, v83
    v_add_f32 v148, v148, v84
    v_add_f32 v149, v149, v85
    v_add_f32 v150, v150, v86
    v_add_f32 v151, v151, v87
    v_cvt_pk_bf16_f32 v176, v144, v146
    v_cvt_pk_bf16_f32 v177, v148, v150
    v_cvt_pk_bf16_f32 v178, v145, v147
    v_cvt_pk_bf16_f32 v179, v149, v151
    buffer_store_dwordx4 v[176:179], v192, s[28:31], s20 offen sc1
    s_waitcnt lgkmcnt(4)
    v_add_f32 v152, v152, v88
    v_add_f32 v153, v153, v89
    v_add_f32 v154, v154, v90
    v_add_f32 v155, v155, v91
    v_add_f32 v156, v156, v92
    v_add_f32 v157, v157, v93
    v_add_f32 v158, v158, v94
    v_add_f32 v159, v159, v95
    v_cvt_pk_bf16_f32 v180, v152, v154
    v_cvt_pk_bf16_f32 v181, v156, v158
    v_cvt_pk_bf16_f32 v182, v153, v155
    v_cvt_pk_bf16_f32 v183, v157, v159
    buffer_store_dwordx4 v[180:183], v192, s[28:31], s21 offen sc1
    s_waitcnt lgkmcnt(0)
    v_add_f32 v160, v160, v96
    v_add_f32 v161, v161, v97
    v_add_f32 v162, v162, v98
    v_add_f32 v163, v163, v99
    v_add_f32 v164, v164, v100
    v_add_f32 v165, v165, v101
    v_add_f32 v166, v166, v102
    v_add_f32 v167, v167, v103
    v_cvt_pk_bf16_f32 v184, v160, v162
    v_cvt_pk_bf16_f32 v185, v164, v166
    v_cvt_pk_bf16_f32 v186, v161, v163
    v_cvt_pk_bf16_f32 v187, v165, v167
    buffer_store_dwordx4 v[184:187], v192, s[28:31], s22 offen sc1
    s_barrier
    ds_read_b64 v[168:169], v197 offset:6144
    ds_read_b64 v[170:171], v197 offset:39936
    ds_read_b64 v[172:173], v198 offset:6144
    ds_read_b64 v[174:175], v198 offset:39936
    s_waitcnt lgkmcnt(0)
    v_pk_add_f32 v[168:169], v[168:169], v[104:105]
    v_pk_add_f32 v[170:171], v[170:171], v[106:107]
    v_pk_add_f32 v[172:173], v[172:173], v[108:109]
    v_pk_add_f32 v[174:175], v[174:175], v[110:111]
    v_cvt_pk_bf16_f32 v188, v168, v170
    v_cvt_pk_bf16_f32 v189, v172, v174
    v_cvt_pk_bf16_f32 v190, v169, v171
    v_cvt_pk_bf16_f32 v191, v173, v175
    buffer_store_dwordx4 v[188:191], v192, s[28:31], s23 offen sc1
    s_waitcnt vmcnt(0)
    s_mov_b64 exec, 1
    ds_add_rtn_u32 v221, v220, v221
    s_mov_b64 exec, -1
    s_waitcnt lgkmcnt(0)
    v_readfirstlane_b32 s4, v221
    s_cmp_lg_u32 s4, 3
    s_cbranch_scc1 L_hf_20
    v_mov_b32 v220, s34
    v_mov_b32 v221, 0
    s_waitcnt vmcnt(0)
    s_mov_b64 exec, 1
    buffer_store_dword v220, v221, s[28:31], s19 offen sc1
    s_mov_b64 exec, -1
L_hf_20:
    s_mov_b32 s35, 0
    v_mov_b32 v220, 157696
L_hf_20_w:
    ds_read_b32 v221, v220
    s_add_u32 s35, s35, 1
    s_waitcnt lgkmcnt(0)
    v_readfirstlane_b32 s4, v221
    s_cmp_ge_u32 s35, 262144
    s_cbranch_scc1 L_hf_20_x
    s_cmp_lt_u32 s4, 4
    s_cbranch_scc1 L_hf_20_w
L_hf_20_x:
    s_cmp_ge_u32 s3, 6
    s_cbranch_scc1 L_w67
    s_mul_i32 s74, s72, 4608
    s_sleep 18
    s_branch L_ld_c
L_ld_helper:
    s_waitcnt lgkmcnt(0)
    s_mov_b32 s28, s66
    s_mov_b32 s29, s67
    s_mov_b32 s30, 67108864
    s_mov_b32 s31, 0x00020000
    s_mov_b32 s24, s64
    s_mov_b32 s25, s65
    s_mov_b32 s26, 256
    s_mov_b32 s27, 0x00020000
    s_bfe_u32 s4, s2, 0x20001
    s_lshl_b32 s4, s4, 2
    s_bfe_u32 s5, s2, 0x20003
    s_add_u32 s68, s4, s5
    s_and_b32 s4, s2, 1
    s_mul_i32 s4, s4, 7
    s_lshr_b32 s5, s2, 5
    s_add_u32 s69, s4, s5
    s_cmp_lt_u32 s5, 7
    s_cselect_b32 s70, 1, 0
    s_cselect_b32 s4, 0, 64
    s_sub_u32 s71, s2, s4
    s_sub_u32 s71, s71, 160
    s_and_b32 s72, s3, 1
    v_lshlrev_b32 v10, 4, v1
    v_add_u32 v11, 4096, v10
    v_lshlrev_b32 v36, 7, v1
    s_lshr_b32 s15, s2, 5
    s_mul_i32 s4, s15, 54
    s_mul_i32 s5, s72, 27
    s_add_u32 s4, s4, s5
    s_mul_i32 s4, s4, 5120
    s_add_u32 s12, s4, 12582912
    s_mul_i32 s13, s72, 10240
    v_lshrrev_b32 v12, 4, v1
    v_bfe_u32 v13, v1, 1, 3
    v_or_b32 v14, 0, v12
    v_xor_b32 v13, v13, v14
    v_and_b32 v14, 1, v1
    v_lshl_add_u32 v13, v13, 1, v14
    v_mul_u32_u24 v12, 3456, v12
    v_lshl_add_u32 v12, v13, 4, v12
    s_lshl_b32 s4, s69, 8
    s_add_u32 s4, s4, 0
    v_add_u32 v2, s4, v12
    v_lshrrev_b32 v12, 4, v1
    v_bfe_u32 v13, v1, 1, 3
    v_or_b32 v14, 4, v12
    v_xor_b32 v13, v13, v14
    v_and_b32 v14, 1, v1
    v_lshl_add_u32 v13, v13, 1, v14
    v_mul_u32_u24 v12, 3456, v12
    v_lshl_add_u32 v12, v13, 4, v12
    s_lshl_b32 s4, s69, 8
    s_add_u32 s4, s4, 12800
    v_add_u32 v3, s4, v12
    v_lshrrev_b32 v12, 4, v1
    v_bfe_u32 v13, v1, 1, 3
    v_or_b32 v14, 0, v12
    v_xor_b32 v13, v13, v14
    v_and_b32 v14, 1, v1
    v_lshl_add_u32 v13, v13, 1, v14
    v_mul_u32_u24 v12, 3456, v12
    v_lshl_add_u32 v12, v13, 4, v12
    s_lshl_b32 s4, s69, 8
    s_add_u32 s4, s4, 25600
    v_add_u32 v4, s4, v12
    v_lshrrev_b32 v12, 4, v1
    v_bfe_u32 v13, v1, 1, 3
    v_or_b32 v14, 4, v12
    v_xor_b32 v13, v13, v14
    v_and_b32 v14, 1, v1
    v_lshl_add_u32 v13, v13, 1, v14
    v_mul_u32_u24 v12, 3456, v12
    v_lshl_add_u32 v12, v13, 4, v12
    s_lshl_b32 s4, s69, 8
    s_add_u32 s4, s4, 38400
    v_add_u32 v5, s4, v12
    s_lshl_b32 s4, s68, 10
    s_lshl_b32 s5, s72, 16
    s_add_u32 s4, s4, s5
    s_add_u32 s4, s4, 1048576
    v_add_u32 v6, s4, v10
    v_add_u32 v7, 15232, v6
    v_add_u32 v8, 30464, v6
    v_add_u32 v9, 45696, v6
    s_cmp_ge_u32 s3, 6
    s_cbranch_scc1 L_cpf
    s_barrier
    v_mov_b32 v13, 0
    s_mov_b32 s35, 0
    s_mov_b64 exec, 1
L_gn_21:
    buffer_load_dword v12, v13, s[24:27], 0 offen sc1
    s_waitcnt vmcnt(0)
    v_readfirstlane_b32 s34, v12
    s_add_u32 s35, s35, 1
    s_sub_u32 s5, s34, s32
    s_add_u32 s5, s5, 1000
    s_cmp_ge_u32 s35, 400
    s_cselect_b32 s5, 0, s5
    s_cmp_lt_u32 s5, 2000
    s_cselect_b32 s34, s34, 0
    s_cmp_lg_u32 s34, 0
    s_cbranch_scc1 L_gn_21_ok
    s_sleep 2
    s_cmp_lt_u32 s35, 262144
    s_cbranch_scc1 L_gn_21
L_gn_21_ok:
    s_mov_b64 exec, -1
    s_cmp_eq_u32 s70, 0
    s_cbranch_scc1 L_ld_nog1
    s_lshl_b32 s73, s72, 13
    s_add_u32 s73, s73, 9216
    s_cmp_eq_u32 s72, 0
    s_cselect_b32 s8, s56, s58
    s_cselect_b32 s9, s57, s59
    s_mov_b32 s10, 2211840
    s_mov_b32 s11, 0x00020000
    s_add_u32 m0, s73, 0
    s_mov_b32 s76, 0
    buffer_load_dwordx4 v2, s[8:11], s76 offen offset:0 lds
    buffer_load_dwordx4 v3, s[8:11], s76 offen offset:1024 lds
    buffer_load_dwordx4 v4, s[8:11], s76 offen offset:2048 lds
    buffer_load_dwordx4 v5, s[8:11], s76 offen offset:3072 lds
    s_add_u32 m0, s73, 4096
    s_mov_b32 s76, 55296
    buffer_load_dwordx4 v2, s[8:11], s76 offen offset:0 lds
    buffer_load_dwordx4 v3, s[8:11], s76 offen offset:1024 lds
    buffer_load_dwordx4 v4, s[8:11], s76 offen offset:2048 lds
    buffer_load_dwordx4 v5, s[8:11], s76 offen offset:3072 lds
    s_add_u32 m0, s73, 33792
    s_mov_b32 s76, 110592
    buffer_load_dwordx4 v2, s[8:11], s76 offen offset:0 lds
    buffer_load_dwordx4 v3, s[8:11], s76 offen offset:1024 lds
    buffer_load_dwordx4 v4, s[8:11], s76 offen offset:2048 lds
    buffer_load_dwordx4 v5, s[8:11], s76 offen offset:3072 lds
    s_add_u32 m0, s73, 37888
    s_mov_b32 s76, 165888
    buffer_load_dwordx4 v2, s[8:11], s76 offen offset:0 lds
    buffer_load_dwordx4 v3, s[8:11], s76 offen offset:1024 lds
    buffer_load_dwordx4 v4, s[8:11], s76 offen offset:2048 lds
    buffer_load_dwordx4 v5, s[8:11], s76 offen offset:3072 lds
    s_add_u32 m0, s73, 67584
    s_mov_b32 s76, 221184
    buffer_load_dwordx4 v2, s[8:11], s76 offen offset:0 lds
    buffer_load_dwordx4 v3, s[8:11], s76 offen offset:1024 lds
    buffer_load_dwordx4 v4, s[8:11], s76 offen offset:2048 lds
    buffer_load_dwordx4 v5, s[8:11], s76 offen offset:3072 lds
    s_add_u32 m0, s73, 71680
    s_mov_b32 s76, 276480
    buffer_load_dwordx4 v2, s[8:11], s76 offen offset:0 lds
    buffer_load_dwordx4 v3, s[8:11], s76 offen offset:1024 lds
    buffer_load_dwordx4 v4, s[8:11], s76 offen offset:2048 lds
    buffer_load_dwordx4 v5, s[8:11], s76 offen offset:3072 lds
    s_add_u32 m0, s73, 101376
    s_mov_b32 s76, 331776
    buffer_load_dwordx4 v2, s[8:11], s76 offen offset:0 lds
    buffer_load_dwordx4 v3, s[8:11], s76 offen offset:1024 lds
    buffer_load_dwordx4 v4, s[8:11], s76 offen offset:2048 lds
    buffer_load_dwordx4 v5, s[8:11], s76 offen offset:3072 lds
    s_add_u32 m0, s73, 105472
    s_mov_b32 s76, 387072
    buffer_load_dwordx4 v2, s[8:11], s76 offen offset:0 lds
    buffer_load_dwordx4 v3, s[8:11], s76 offen offset:1024 lds
    buffer_load_dwordx4 v4, s[8:11], s76 offen offset:2048 lds
    buffer_load_dwordx4 v5, s[8:11], s76 offen offset:3072 lds
    s_mul_i32 s74, s72, 4608
    s_lshl_b32 s4, s71, 1
    s_add_u32 s4, s4, s72
    s_add_u32 s4, s4, 32
    s_lshl_b32 s4, s4, 7
    s_add_u32 s4, s4, 278528
    s_mov_b32 s35, 0
    s_mov_b64 exec, 1
L_pl_22:
    buffer_load_dword v32, v36, s[28:31], s4 offen sc1
    s_add_u32 s35, s35, 1
    s_waitcnt vmcnt(0)
    v_cmp_ne_u32 vcc, s34, v32
    s_cmp_ge_u32 s35, 262144
    s_cbranch_scc1 L_pl_22_ok
    s_nop 1
    s_cbranch_vccz L_pl_22_ok
    s_sleep 4
    s_branch L_pl_22
L_pl_22_ok:
    s_mov_b64 exec, -1
    s_sleep 8
L_ld_c:
    s_cmp_eq_u32 s72, 0
    s_cselect_b32 s8, s56, s58
    s_cselect_b32 s9, s57, s59
    s_mov_b32 s10, 2211840
    s_mov_b32 s11, 0x00020000
    v_lshrrev_b32 v12, 2, v1
    v_lshlrev_b32 v12, 3, v12
    v_and_b32 v13, 3, v1
    v_add_u32 v12, v12, v13
    s_lshl_b32 s4, s72, 2
    v_add_u32 v12, s4, v12
    v_lshlrev_b32 v12, 7, v12
    s_mov_b32 s35, 0
    s_mov_b32 s7, 0
    s_mov_b32 s6, 65535
    v_mov_b32 v17, s34
L_pn_23:
    s_mov_b32 s5, 278528
    buffer_load_dword v16, v12, s[28:31], s5 offen sc1
    s_add_u32 s5, s5, 16384
    s_mov_b64 exec, s[6:7]
    buffer_load_dword v17, v12, s[28:31], s5 offen sc1
    s_mov_b64 exec, -1
    s_add_u32 s35, s35, 1
    s_waitcnt vmcnt(0)
    v_xor_b32 v18, s34, v16
    v_xor_b32 v19, s34, v17
    v_or_b32 v18, v18, v19
    v_cmp_ne_u32 vcc, 0, v18
    s_cmp_ge_u32 s35, 262144
    s_cbranch_scc1 L_pn_23_ok
    s_nop 1
    s_cbranch_vccz L_pn_23_ok
    s_sleep 1
    s_branch L_pn_23
L_pn_23_ok:
    s_add_u32 m0, s74, 0
    s_mov_b32 s77, 0
    buffer_load_dwordx4 v6, s[28:31], s77 offen offset:0 sc1 lds
    buffer_load_dwordx4 v7, s[28:31], s77 offen offset:1152 sc1 lds
    buffer_load_dwordx4 v8, s[28:31], s77 offen offset:2304 sc1 lds
    buffer_load_dwordx4 v9, s[28:31], s77 offen offset:3456 sc1 lds
    s_add_u32 m0, s74, 33792
    s_mov_b32 s77, 131072
    buffer_load_dwordx4 v6, s[28:31], s77 offen offset:0 sc1 lds
    buffer_load_dwordx4 v7, s[28:31], s77 offen offset:1152 sc1 lds
    buffer_load_dwordx4 v8, s[28:31], s77 offen offset:2304 sc1 lds
    buffer_load_dwordx4 v9, s[28:31], s77 offen offset:3456 sc1 lds
    s_waitcnt vmcnt(4)
    s_barrier
    s_add_u32 m0, s74, 67584
    s_mov_b32 s77, 262144
    buffer_load_dwordx4 v6, s[28:31], s77 offen offset:0 sc1 lds
    buffer_load_dwordx4 v7, s[28:31], s77 offen offset:1152 sc1 lds
    buffer_load_dwordx4 v8, s[28:31], s77 offen offset:2304 sc1 lds
    buffer_load_dwordx4 v9, s[28:31], s77 offen offset:3456 sc1 lds
    s_add_u32 m0, s74, 101376
    s_mov_b32 s77, 393216
    buffer_load_dwordx4 v6, s[28:31], s77 offen offset:0 sc1 lds
    buffer_load_dwordx4 v7, s[28:31], s77 offen offset:1152 sc1 lds
    buffer_load_dwordx4 v8, s[28:31], s77 offen offset:2304 sc1 lds
    buffer_load_dwordx4 v9, s[28:31], s77 offen offset:3456 sc1 lds
    s_waitcnt vmcnt(8)
    s_barrier
    s_add_u32 m0, s74, 0
    s_mov_b32 s77, 524288
    buffer_load_dwordx4 v6, s[28:31], s77 offen offset:0 sc1 lds
    buffer_load_dwordx4 v7, s[28:31], s77 offen offset:1152 sc1 lds
    buffer_load_dwordx4 v8, s[28:31], s77 offen offset:2304 sc1 lds
    buffer_load_dwordx4 v9, s[28:31], s77 offen offset:3456 sc1 lds
    s_add_u32 m0, s73, 0
    s_mov_b32 s76, 442368
    buffer_load_dwordx4 v2, s[8:11], s76 offen offset:0 lds
    buffer_load_dwordx4 v3, s[8:11], s76 offen offset:1024 lds
    buffer_load_dwordx4 v4, s[8:11], s76 offen offset:2048 lds
    buffer_load_dwordx4 v5, s[8:11], s76 offen offset:3072 lds
    s_add_u32 m0, s73, 4096
    s_mov_b32 s76, 497664
    buffer_load_dwordx4 v2, s[8:11], s76 offen offset:0 lds
    buffer_load_dwordx4 v3, s[8:11], s76 offen offset:1024 lds
    buffer_load_dwordx4 v4, s[8:11], s76 offen offset:2048 lds
    buffer_load_dwordx4 v5, s[8:11], s76 offen offset:3072 lds
    s_waitcnt vmcnt(16)
    s_barrier
    s_add_u32 m0, s74, 33792
    s_mov_b32 s77, 655360
    buffer_load_dwordx4 v6, s[28:31], s77 offen offset:0 sc1 lds
    buffer_load_dwordx4 v7, s[28:31], s77 offen offset:1152 sc1 lds
    buffer_load_dwordx4 v8, s[28:31], s77 offen offset:2304 sc1 lds
    buffer_load_dwordx4 v9, s[28:31], s77 offen offset:3456 sc1 lds
    s_add_u32 m0, s73, 33792
    s_mov_b32 s76, 552960
    buffer_load_dwordx4 v2, s[8:11], s76 offen offset:0 lds
    buffer_load_dwordx4 v3, s[8:11], s76 offen offset:1024 lds
    buffer_load_dwordx4 v4, s[8:11], s76 offen offset:2048 lds
    buffer_load_dwordx4 v5, s[8:11], s76 offen offset:3072 lds
    s_add_u32 m0, s73, 37888
    s_mov_b32 s76, 608256
    buffer_load_dwordx4 v2, s[8:11], s76 offen offset:0 lds
    buffer_load_dwordx4 v3, s[8:11], s76 offen offset:1024 lds
    buffer_load_dwordx4 v4, s[8:11], s76 offen offset:2048 lds
    buffer_load_dwordx4 v5, s[8:11], s76 offen offset:3072 lds
    s_waitcnt vmcnt(24)
    s_barrier
    s_add_u32 m0, s74, 67584
    s_mov_b32 s77, 786432
    buffer_load_dwordx4 v6, s[28:31], s77 offen offset:0 sc1 lds
    buffer_load_dwordx4 v7, s[28:31], s77 offen offset:1152 sc1 lds
    buffer_load_dwordx4 v8, s[28:31], s77 offen offset:2304 sc1 lds
    buffer_load_dwordx4 v9, s[28:31], s77 offen offset:3456 sc1 lds
    s_add_u32 m0, s73, 67584
    s_mov_b32 s76, 663552
    buffer_load_dwordx4 v2, s[8:11], s76 offen offset:0 lds
    buffer_load_dwordx4 v3, s[8:11], s76 offen offset:1024 lds
    buffer_load_dwordx4 v4, s[8:11], s76 offen offset:2048 lds
    buffer_load_dwordx4 v5, s[8:11], s76 offen offset:3072 lds
    s_add_u32 m0, s73, 71680
    s_mov_b32 s76, 718848
    buffer_load_dwordx4 v2, s[8:11], s76 offen offset:0 lds
    buffer_load_dwordx4 v3, s[8:11], s76 offen offset:1024 lds
    buffer_load_dwordx4 v4, s[8:11], s76 offen offset:2048 lds
    buffer_load_dwordx4 v5, s[8:11], s76 offen offset:3072 lds
    s_waitcnt vmcnt(24)
    s_barrier
    s_add_u32 m0, s74, 101376
    s_mov_b32 s77, 917504
    buffer_load_dwordx4 v6, s[28:31], s77 offen offset:0 sc1 lds
    buffer_load_dwordx4 v7, s[28:31], s77 offen offset:1152 sc1 lds
    buffer_load_dwordx4 v8, s[28:31], s77 offen offset:2304 sc1 lds
    buffer_load_dwordx4 v9, s[28:31], s77 offen offset:3456 sc1 lds
    s_add_u32 m0, s73, 101376
    s_mov_b32 s76, 774144
    buffer_load_dwordx4 v2, s[8:11], s76 offen offset:0 lds
    buffer_load_dwordx4 v3, s[8:11], s76 offen offset:1024 lds
    buffer_load_dwordx4 v4, s[8:11], s76 offen offset:2048 lds
    buffer_load_dwordx4 v5, s[8:11], s76 offen offset:3072 lds
    s_add_u32 m0, s73, 105472
    s_mov_b32 s76, 829440
    buffer_load_dwordx4 v2, s[8:11], s76 offen offset:0 lds
    buffer_load_dwordx4 v3, s[8:11], s76 offen offset:1024 lds
    buffer_load_dwordx4 v4, s[8:11], s76 offen offset:2048 lds
    buffer_load_dwordx4 v5, s[8:11], s76 offen offset:3072 lds
    s_waitcnt vmcnt(24)
    s_barrier
    s_add_u32 m0, s74, 0
    s_mov_b32 s77, 1048576
    buffer_load_dwordx4 v6, s[28:31], s77 offen offset:0 sc1 lds
    buffer_load_dwordx4 v7, s[28:31], s77 offen offset:1152 sc1 lds
    buffer_load_dwordx4 v8, s[28:31], s77 offen offset:2304 sc1 lds
    buffer_load_dwordx4 v9, s[28:31], s77 offen offset:3456 sc1 lds
    s_add_u32 m0, s73, 0
    s_mov_b32 s76, 884736
    buffer_load_dwordx4 v2, s[8:11], s76 offen offset:0 lds
    buffer_load_dwordx4 v3, s[8:11], s76 offen offset:1024 lds
    buffer_load_dwordx4 v4, s[8:11], s76 offen offset:2048 lds
    buffer_load_dwordx4 v5, s[8:11], s76 offen offset:3072 lds
    s_add_u32 m0, s73, 4096
    s_mov_b32 s76, 940032
    buffer_load_dwordx4 v2, s[8:11], s76 offen offset:0 lds
    buffer_load_dwordx4 v3, s[8:11], s76 offen offset:1024 lds
    buffer_load_dwordx4 v4, s[8:11], s76 offen offset:2048 lds
    buffer_load_dwordx4 v5, s[8:11], s76 offen offset:3072 lds
    s_waitcnt vmcnt(24)
    s_barrier
    s_add_u32 m0, s74, 33792
    s_mov_b32 s77, 1179648
    buffer_load_dwordx4 v6, s[28:31], s77 offen offset:0 sc1 lds
    buffer_load_dwordx4 v7, s[28:31], s77 offen offset:1152 sc1 lds
    buffer_load_dwordx4 v8, s[28:31], s77 offen offset:2304 sc1 lds
    buffer_load_dwordx4 v9, s[28:31], s77 offen offset:3456 sc1 lds
    s_add_u32 m0, s73, 33792
    s_mov_b32 s76, 995328
    buffer_load_dwordx4 v2, s[8:11], s76 offen offset:0 lds
    buffer_load_dwordx4 v3, s[8:11], s76 offen offset:1024 lds
    buffer_load_dwordx4 v4, s[8:11], s76 offen offset:2048 lds
    buffer_load_dwordx4 v5, s[8:11], s76 offen offset:3072 lds
    s_add_u32 m0, s73, 37888
    s_mov_b32 s76, 1050624
    buffer_load_dwordx4 v2, s[8:11], s76 offen offset:0 lds
    buffer_load_dwordx4 v3, s[8:11], s76 offen offset:1024 lds
    buffer_load_dwordx4 v4, s[8:11], s76 offen offset:2048 lds
    buffer_load_dwordx4 v5, s[8:11], s76 offen offset:3072 lds
    s_waitcnt vmcnt(24)
    s_barrier
    s_mul_i32 s16, s72, 27
    s_lshl_b32 s4, s69, 1
    s_add_u32 s16, s16, s4
    s_lshl_b32 s18, s16, 7
    s_add_u32 s18, s18, 262144
    s_cmp_lt_u32 s69, 13
    s_cselect_b32 s4, 128, 0
    v_min_u32 v12, s4, v36
    buffer_load_dwordx4 v[32:35], v12, s[28:31], s18 offen sc1
    s_add_u32 m0, s74, 67584
    s_mov_b32 s77, 1310720
    buffer_load_dwordx4 v6, s[28:31], s77 offen offset:0 sc1 lds
    buffer_load_dwordx4 v7, s[28:31], s77 offen offset:1152 sc1 lds
    buffer_load_dwordx4 v8, s[28:31], s77 offen offset:2304 sc1 lds
    buffer_load_dwordx4 v9, s[28:31], s77 offen offset:3456 sc1 lds
    s_add_u32 m0, s73, 67584
    s_mov_b32 s76, 1105920
    buffer_load_dwordx4 v2, s[8:11], s76 offen offset:0 lds
    buffer_load_dwordx4 v3, s[8:11], s76 offen offset:1024 lds
    buffer_load_dwordx4 v4, s[8:11], s76 offen offset:2048 lds
    buffer_load_dwordx4 v5, s[8:11], s76 offen offset:3072 lds
    s_add_u32 m0, s73, 71680
    s_mov_b32 s76, 1161216
    buffer_load_dwordx4 v2, s[8:11], s76 offen offset:0 lds
    buffer_load_dwordx4 v3, s[8:11], s76 offen offset:1024 lds
    buffer_load_dwordx4 v4, s[8:11], s76 offen offset:2048 lds
    buffer_load_dwordx4 v5, s[8:11], s76 offen offset:3072 lds
    s_waitcnt vmcnt(25)
    s_barrier
    s_add_u32 m0, s74, 101376
    s_mov_b32 s77, 1441792
    buffer_load_dwordx4 v6, s[28:31], s77 offen offset:0 sc1 lds
    buffer_load_dwordx4 v7, s[28:31], s77 offen offset:1152 sc1 lds
    buffer_load_dwordx4 v8, s[28:31], s77 offen offset:2304 sc1 lds
    buffer_load_dwordx4 v9, s[28:31], s77 offen offset:3456 sc1 lds
    s_add_u32 m0, s73, 101376
    s_mov_b32 s76, 1216512
    buffer_load_dwordx4 v2, s[8:11], s76 offen offset:0 lds
    buffer_load_dwordx4 v3, s[8:11], s76 offen offset:1024 lds
    buffer_load_dwordx4 v4, s[8:11], s76 offen offset:2048 lds
    buffer_load_dwordx4 v5, s[8:11], s76 offen offset:3072 lds
    s_add_u32 m0, s73, 105472
    s_mov_b32 s76, 1271808
    buffer_load_dwordx4 v2, s[8:11], s76 offen offset:0 lds
    buffer_load_dwordx4 v3, s[8:11], s76 offen offset:1024 lds
    buffer_load_dwordx4 v4, s[8:11], s76 offen offset:2048 lds
    buffer_load_dwordx4 v5, s[8:11], s76 offen offset:3072 lds
    s_waitcnt vmcnt(25)
    s_barrier
    s_add_u32 m0, s74, 0
    s_mov_b32 s77, 1572864
    buffer_load_dwordx4 v6, s[28:31], s77 offen offset:0 sc1 lds
    buffer_load_dwordx4 v7, s[28:31], s77 offen offset:1152 sc1 lds
    buffer_load_dwordx4 v8, s[28:31], s77 offen offset:2304 sc1 lds
    buffer_load_dwordx4 v9, s[28:31], s77 offen offset:3456 sc1 lds
    s_add_u32 m0, s73, 0
    s_mov_b32 s76, 1327104
    buffer_load_dwordx4 v2, s[8:11], s76 offen offset:0 lds
    buffer_load_dwordx4 v3, s[8:11], s76 offen offset:1024 lds
    buffer_load_dwordx4 v4, s[8:11], s76 offen offset:2048 lds
    buffer_load_dwordx4 v5, s[8:11], s76 offen offset:3072 lds
    s_add_u32 m0, s73, 4096
    s_mov_b32 s76, 1382400
    buffer_load_dwordx4 v2, s[8:11], s76 offen offset:0 lds
    buffer_load_dwordx4 v3, s[8:11], s76 offen offset:1024 lds
    buffer_load_dwordx4 v4, s[8:11], s76 offen offset:2048 lds
    buffer_load_dwordx4 v5, s[8:11], s76 offen offset:3072 lds
    s_waitcnt vmcnt(24)
    s_barrier
    s_mov_b32 s35, 0
L_cs_24:
    v_xor_b32 v32, s34, v32
    v_xor_b32 v33, s34, v33
    v_xor_b32 v34, s34, v34
    v_xor_b32 v35, s34, v35
    v_or3_b32 v32, v32, v33, v34
    v_or_b32 v32, v32, v35
    v_cmp_ne_u32 vcc, 0, v32
    s_add_u32 s35, s35, 1
    s_cmp_ge_u32 s35, 262144
    s_cbranch_scc1 L_cs_24_ok
    s_cbranch_vccz L_cs_24_ok
    buffer_load_dwordx4 v[32:35], v12, s[28:31], s18 offen sc1
    s_waitcnt vmcnt(0)
    s_branch L_cs_24
L_cs_24_ok:
    s_lshl_b32 s4, s16, 8
    s_add_u32 s4, s4, 65536
    s_mov_b32 exec_hi, 0
    buffer_load_dwordx4 v[16:19], v10, s[28:31], s4 offen sc1
    s_add_u32 s4, s4, 13824
    buffer_load_dwordx4 v[20:23], v10, s[28:31], s4 offen sc1
    s_add_u32 s4, s4, 13824
    buffer_load_dwordx4 v[24:27], v10, s[28:31], s4 offen sc1
    s_add_u32 s4, s4, 13824
    buffer_load_dwordx4 v[28:31], v10, s[28:31], s4 offen sc1
    s_mov_b64 exec, -1
    s_add_u32 m0, s74, 33792
    s_mov_b32 s77, 1703936
    buffer_load_dwordx4 v6, s[28:31], s77 offen offset:0 sc1 lds
    buffer_load_dwordx4 v7, s[28:31], s77 offen offset:1152 sc1 lds
    buffer_load_dwordx4 v8, s[28:31], s77 offen offset:2304 sc1 lds
    buffer_load_dwordx4 v9, s[28:31], s77 offen offset:3456 sc1 lds
    s_add_u32 m0, s73, 33792
    s_mov_b32 s76, 1437696
    buffer_load_dwordx4 v2, s[8:11], s76 offen offset:0 lds
    buffer_load_dwordx4 v3, s[8:11], s76 offen offset:1024 lds
    buffer_load_dwordx4 v4, s[8:11], s76 offen offset:2048 lds
    buffer_load_dwordx4 v5, s[8:11], s76 offen offset:3072 lds
    s_add_u32 m0, s73, 37888
    s_mov_b32 s76, 1492992
    buffer_load_dwordx4 v2, s[8:11], s76 offen offset:0 lds
    buffer_load_dwordx4 v3, s[8:11], s76 offen offset:1024 lds
    buffer_load_dwordx4 v4, s[8:11], s76 offen offset:2048 lds
    buffer_load_dwordx4 v5, s[8:11], s76 offen offset:3072 lds
    s_waitcnt vmcnt(28)
    s_barrier
    s_lshr_b32 s4, s15, 1
    s_mul_i32 s4, s4, 6912
    s_add_u32 s4, s4, 458752
    v_min_u32 v33, 6784, v36
    buffer_load_dword v32, v33, s[28:31], s4 offen sc1
    s_add_u32 m0, s74, 67584
    s_mov_b32 s77, 1835008
    buffer_load_dwordx4 v6, s[28:31], s77 offen offset:0 sc1 lds
    buffer_load_dwordx4 v7, s[28:31], s77 offen offset:1152 sc1 lds
    buffer_load_dwordx4 v8, s[28:31], s77 offen offset:2304 sc1 lds
    buffer_load_dwordx4 v9, s[28:31], s77 offen offset:3456 sc1 lds
    s_add_u32 m0, s73, 67584
    s_mov_b32 s76, 1548288
    buffer_load_dwordx4 v2, s[8:11], s76 offen offset:0 lds
    buffer_load_dwordx4 v3, s[8:11], s76 offen offset:1024 lds
    buffer_load_dwordx4 v4, s[8:11], s76 offen offset:2048 lds
    buffer_load_dwordx4 v5, s[8:11], s76 offen offset:3072 lds
    s_add_u32 m0, s73, 71680
    s_mov_b32 s76, 1603584
    buffer_load_dwordx4 v2, s[8:11], s76 offen offset:0 lds
    buffer_load_dwordx4 v3, s[8:11], s76 offen offset:1024 lds
    buffer_load_dwordx4 v4, s[8:11], s76 offen offset:2048 lds
    buffer_load_dwordx4 v5, s[8:11], s76 offen offset:3072 lds
    s_waitcnt vmcnt(29)
    s_barrier
    s_add_u32 m0, s74, 101376
    s_mov_b32 s77, 1966080
    buffer_load_dwordx4 v6, s[28:31], s77 offen offset:0 sc1 lds
    buffer_load_dwordx4 v7, s[28:31], s77 offen offset:1152 sc1 lds
    buffer_load_dwordx4 v8, s[28:31], s77 offen offset:2304 sc1 lds
    buffer_load_dwordx4 v9, s[28:31], s77 offen offset:3456 sc1 lds
    s_add_u32 m0, s73, 101376
    s_mov_b32 s76, 1658880
    buffer_load_dwordx4 v2, s[8:11], s76 offen offset:0 lds
    buffer_load_dwordx4 v3, s[8:11], s76 offen offset:1024 lds
    buffer_load_dwordx4 v4, s[8:11], s76 offen offset:2048 lds
    buffer_load_dwordx4 v5, s[8:11], s76 offen offset:3072 lds
    s_add_u32 m0, s73, 105472
    s_mov_b32 s76, 1714176
    buffer_load_dwordx4 v2, s[8:11], s76 offen offset:0 lds
    buffer_load_dwordx4 v3, s[8:11], s76 offen offset:1024 lds
    buffer_load_dwordx4 v4, s[8:11], s76 offen offset:2048 lds
    buffer_load_dwordx4 v5, s[8:11], s76 offen offset:3072 lds
    s_waitcnt vmcnt(25)
    s_barrier
    s_lshl_b32 s4, s72, 9
    s_add_u32 s4, s4, 126976
    v_add_u32 v12, s4, v10
    v_add_f32 v16, v16, v20
    v_add_f32 v24, v24, v28
    v_add_f32 v17, v17, v21
    v_add_f32 v25, v25, v29
    v_add_f32 v18, v18, v22
    v_add_f32 v26, v26, v30
    v_add_f32 v19, v19, v23
    v_add_f32 v27, v27, v31
    v_add_f32 v16, v16, v24
    v_add_f32 v17, v17, v25
    v_add_f32 v18, v18, v26
    v_add_f32 v19, v19, v27
    s_mov_b32 exec_hi, 0
    ds_write_b128 v12, v[16:19]
    s_mov_b64 exec, -1
    s_waitcnt lgkmcnt(0)
    s_lshl_b32 s17, s68, 10
    s_add_u32 s17, s17, 32768
    buffer_load_dwordx4 v[16:19], v10, s[28:31], s17 offen sc1
    s_add_u32 m0, s74, 0
    s_mov_b32 s77, 2097152
    buffer_load_dwordx4 v6, s[28:31], s77 offen offset:0 sc1 lds
    buffer_load_dwordx4 v7, s[28:31], s77 offen offset:1152 sc1 lds
    buffer_load_dwordx4 v8, s[28:31], s77 offen offset:2304 sc1 lds
    buffer_load_dwordx4 v9, s[28:31], s77 offen offset:3456 sc1 lds
    s_add_u32 m0, s73, 0
    s_mov_b32 s76, 1769472
    buffer_load_dwordx4 v2, s[8:11], s76 offen offset:0 lds
    buffer_load_dwordx4 v3, s[8:11], s76 offen offset:1024 lds
    buffer_load_dwordx4 v4, s[8:11], s76 offen offset:2048 lds
    buffer_load_dwordx4 v5, s[8:11], s76 offen offset:3072 lds
    s_add_u32 m0, s73, 4096
    s_mov_b32 s76, 1824768
    buffer_load_dwordx4 v2, s[8:11], s76 offen offset:0 lds
    buffer_load_dwordx4 v3, s[8:11], s76 offen offset:1024 lds
    buffer_load_dwordx4 v4, s[8:11], s76 offen offset:2048 lds
    buffer_load_dwordx4 v5, s[8:11], s76 offen offset:3072 lds
    s_waitcnt vmcnt(25)
    s_barrier
    s_add_u32 m0, s74, 33792
    s_mov_b32 s77, 2228224
    buffer_load_dwordx4 v6, s[28:31], s77 offen offset:0 sc1 lds
    buffer_load_dwordx4 v7, s[28:31], s77 offen offset:1152 sc1 lds
    buffer_load_dwordx4 v8, s[28:31], s77 offen offset:2304 sc1 lds
    buffer_load_dwordx4 v9, s[28:31], s77 offen offset:3456 sc1 lds
    s_add_u32 m0, s73, 33792
    s_mov_b32 s76, 1880064
    buffer_load_dwordx4 v2, s[8:11], s76 offen offset:0 lds
    buffer_load_dwordx4 v3, s[8:11], s76 offen offset:1024 lds
    buffer_load_dwordx4 v4, s[8:11], s76 offen offset:2048 lds
    buffer_load_dwordx4 v5, s[8:11], s76 offen offset:3072 lds
    s_add_u32 m0, s73, 37888
    s_mov_b32 s76, 1935360
    buffer_load_dwordx4 v2, s[8:11], s76 offen offset:0 lds
    buffer_load_dwordx4 v3, s[8:11], s76 offen offset:1024 lds
    buffer_load_dwordx4 v4, s[8:11], s76 offen offset:2048 lds
    buffer_load_dwordx4 v5, s[8:11], s76 offen offset:3072 lds
    v_cmp_ne_u32 vcc, s34, v32
    s_nop 3
    s_cbranch_vccz L_rt_25
    s_lshr_b32 s4, s15, 1
    s_mul_i32 s4, s4, 6912
    s_add_u32 s4, s4, 458752
    s_mov_b32 s35, 0
    s_mov_b32 s7, 4194303
    s_mov_b32 s6, 4294967295
    v_mov_b32 v32, s34
L_pn_26:
    s_mov_b32 s5, s4
    s_mov_b64 exec, s[6:7]
    buffer_load_dword v32, v36, s[28:31], s5 offen sc1
    s_mov_b64 exec, -1
    s_add_u32 s35, s35, 1
    s_waitcnt vmcnt(0)
    v_xor_b32 v33, s34, v32
    v_cmp_ne_u32 vcc, 0, v33
    s_cmp_ge_u32 s35, 262144
    s_cbranch_scc1 L_pn_26_ok
    s_nop 1
    s_cbranch_vccz L_pn_26_ok
    s_sleep 32
    s_branch L_pn_26
L_pn_26_ok:
L_rt_25:
    s_waitcnt vmcnt(25)
    s_barrier
    s_add_u32 m0, s74, 67584
    s_mov_b32 s77, 2359296
    buffer_load_dwordx4 v6, s[28:31], s77 offen offset:0 sc1 lds
    buffer_load_dwordx4 v7, s[28:31], s77 offen offset:1152 sc1 lds
    buffer_load_dwordx4 v8, s[28:31], s77 offen offset:2304 sc1 lds
    buffer_load_dwordx4 v9, s[28:31], s77 offen offset:3456 sc1 lds
    s_add_u32 m0, s73, 67584
    s_mov_b32 s76, 1990656
    buffer_load_dwordx4 v2, s[8:11], s76 offen offset:0 lds
    buffer_load_dwordx4 v3, s[8:11], s76 offen offset:1024 lds
    buffer_load_dwordx4 v4, s[8:11], s76 offen offset:2048 lds
    buffer_load_dwordx4 v5, s[8:11], s76 offen offset:3072 lds
    s_add_u32 m0, s73, 71680
    s_mov_b32 s76, 2045952
    buffer_load_dwordx4 v2, s[8:11], s76 offen offset:0 lds
    buffer_load_dwordx4 v3, s[8:11], s76 offen offset:1024 lds
    buffer_load_dwordx4 v4, s[8:11], s76 offen offset:2048 lds
    buffer_load_dwordx4 v5, s[8:11], s76 offen offset:3072 lds
    s_waitcnt vmcnt(24)
    s_barrier
    s_add_u32 m0, s74, 101376
    s_mov_b32 s77, 2490368
    buffer_load_dwordx4 v6, s[28:31], s77 offen offset:0 sc1 lds
    buffer_load_dwordx4 v7, s[28:31], s77 offen offset:1152 sc1 lds
    buffer_load_dwordx4 v8, s[28:31], s77 offen offset:2304 sc1 lds
    buffer_load_dwordx4 v9, s[28:31], s77 offen offset:3456 sc1 lds
    s_add_u32 m0, s73, 101376
    s_mov_b32 s76, 2101248
    buffer_load_dwordx4 v2, s[8:11], s76 offen offset:0 lds
    buffer_load_dwordx4 v3, s[8:11], s76 offen offset:1024 lds
    buffer_load_dwordx4 v4, s[8:11], s76 offen offset:2048 lds
    buffer_load_dwordx4 v5, s[8:11], s76 offen offset:3072 lds
    s_add_u32 m0, s73, 105472
    s_mov_b32 s76, 2156544
    buffer_load_dwordx4 v2, s[8:11], s76 offen offset:0 lds
    buffer_load_dwordx4 v3, s[8:11], s76 offen offset:1024 lds
    buffer_load_dwordx4 v4, s[8:11], s76 offen offset:2048 lds
    buffer_load_dwordx4 v5, s[8:11], s76 offen offset:3072 lds
    s_mov_b32 s35, 0
L_s2_27:
    v_xor_b32 v12, s34, v17
    v_xor_b32 v13, s34, v19
    v_or_b32 v12, v12, v13
    v_cmp_ne_u32 vcc, 0, v12
    s_add_u32 s35, s35, 1
    s_cmp_ge_u32 s35, 262144
    s_cbranch_scc1 L_s2_27_ok
    s_cbranch_vccz L_s2_27_ok
    buffer_load_dwordx4 v[16:19], v10, s[28:31], s17 offen sc1
    s_waitcnt vmcnt(0)
    s_branch L_s2_27
L_s2_27_ok:
    v_lshlrev_b32 v16, 16, v16
    v_lshlrev_b32 v17, 16, v18
    s_mov_b32 s4, 128000
    v_lshl_add_u32 v12, v1, 3, s4
    ds_write_b64 v12, v[16:17]
    s_waitcnt lgkmcnt(0)
    s_waitcnt vmcnt(24)
    s_barrier
    s_add_u32 s33, s12, 0
    s_add_u32 m0, s13, 143360
    s_nop 0
    buffer_load_dwordx4 v10, s[28:31], s33 offen offset:0 sc1 lds
    buffer_load_dwordx4 v10, s[28:31], s33 offen offset:1024 sc1 lds
    buffer_load_dwordx4 v10, s[28:31], s33 offen offset:2048 sc1 lds
    buffer_load_dwordx4 v10, s[28:31], s33 offen offset:3072 sc1 lds
    s_add_u32 m0, s13, 147456
    s_nop 0
    buffer_load_dwordx4 v11, s[28:31], s33 offen offset:0 sc1 lds
    buffer_load_dwordx4 v11, s[28:31], s33 offen offset:1024 sc1 lds
    buffer_load_dwordx4 v11, s[28:31], s33 offen offset:2048 sc1 lds
    buffer_load_dwordx4 v11, s[28:31], s33 offen offset:3072 sc1 lds
    s_add_u32 m0, s13, 151552
    s_nop 0
    s_add_u32 s33, s33, 4096
    buffer_load_dwordx4 v11, s[28:31], s33 offen offset:0 sc1 lds
    buffer_load_dwordx4 v11, s[28:31], s33 offen offset:1024 sc1 lds
    s_add_u32 s33, s12, 10240
    s_add_u32 m0, s13, 0
    s_nop 0
    buffer_load_dwordx4 v10, s[28:31], s33 offen offset:0 sc1 lds
    buffer_load_dwordx4 v10, s[28:31], s33 offen offset:1024 sc1 lds
    buffer_load_dwordx4 v10, s[28:31], s33 offen offset:2048 sc1 lds
    buffer_load_dwordx4 v10, s[28:31], s33 offen offset:3072 sc1 lds
    s_add_u32 m0, s13, 4096
    s_nop 0
    buffer_load_dwordx4 v11, s[28:31], s33 offen offset:0 sc1 lds
    buffer_load_dwordx4 v11, s[28:31], s33 offen offset:1024 sc1 lds
    buffer_load_dwordx4 v11, s[28:31], s33 offen offset:2048 sc1 lds
    buffer_load_dwordx4 v11, s[28:31], s33 offen offset:3072 sc1 lds
    s_add_u32 m0, s13, 8192
    s_nop 0
    s_add_u32 s33, s33, 4096
    buffer_load_dwordx4 v11, s[28:31], s33 offen offset:0 sc1 lds
    buffer_load_dwordx4 v11, s[28:31], s33 offen offset:1024 sc1 lds
    s_waitcnt vmcnt(32)
    s_barrier
    s_add_u32 s33, s12, 20480
    s_add_u32 m0, s13, 20480
    s_nop 0
    buffer_load_dwordx4 v10, s[28:31], s33 offen offset:0 sc1 lds
    buffer_load_dwordx4 v10, s[28:31], s33 offen offset:1024 sc1 lds
    buffer_load_dwordx4 v10, s[28:31], s33 offen offset:2048 sc1 lds
    buffer_load_dwordx4 v10, s[28:31], s33 offen offset:3072 sc1 lds
    s_add_u32 m0, s13, 24576
    s_nop 0
    buffer_load_dwordx4 v11, s[28:31], s33 offen offset:0 sc1 lds
    buffer_load_dwordx4 v11, s[28:31], s33 offen offset:1024 sc1 lds
    buffer_load_dwordx4 v11, s[28:31], s33 offen offset:2048 sc1 lds
    buffer_load_dwordx4 v11, s[28:31], s33 offen offset:3072 sc1 lds
    s_add_u32 m0, s13, 28672
    s_nop 0
    s_add_u32 s33, s33, 4096
    buffer_load_dwordx4 v11, s[28:31], s33 offen offset:0 sc1 lds
    buffer_load_dwordx4 v11, s[28:31], s33 offen offset:1024 sc1 lds
    s_waitcnt vmcnt(30)
    s_barrier
    s_add_u32 s33, s12, 30720
    s_add_u32 m0, s13, 40960
    s_nop 0
    buffer_load_dwordx4 v10, s[28:31], s33 offen offset:0 sc1 lds
    buffer_load_dwordx4 v10, s[28:31], s33 offen offset:1024 sc1 lds
    buffer_load_dwordx4 v10, s[28:31], s33 offen offset:2048 sc1 lds
    buffer_load_dwordx4 v10, s[28:31], s33 offen offset:3072 sc1 lds
    s_add_u32 m0, s13, 45056
    s_nop 0
    buffer_load_dwordx4 v11, s[28:31], s33 offen offset:0 sc1 lds
    buffer_load_dwordx4 v11, s[28:31], s33 offen offset:1024 sc1 lds
    buffer_load_dwordx4 v11, s[28:31], s33 offen offset:2048 sc1 lds
    buffer_load_dwordx4 v11, s[28:31], s33 offen offset:3072 sc1 lds
    s_add_u32 m0, s13, 49152
    s_nop 0
    s_add_u32 s33, s33, 4096
    buffer_load_dwordx4 v11, s[28:31], s33 offen offset:0 sc1 lds
    buffer_load_dwordx4 v11, s[28:31], s33 offen offset:1024 sc1 lds
    s_add_u32 s33, s12, 40960
    s_add_u32 m0, s13, 61440
    s_nop 0
    buffer_load_dwordx4 v10, s[28:31], s33 offen offset:0 sc1 lds
    buffer_load_dwordx4 v10, s[28:31], s33 offen offset:1024 sc1 lds
    buffer_load_dwordx4 v10, s[28:31], s33 offen offset:2048 sc1 lds
    buffer_load_dwordx4 v10, s[28:31], s33 offen offset:3072 sc1 lds
    s_add_u32 m0, s13, 65536
    s_nop 0
    buffer_load_dwordx4 v11, s[28:31], s33 offen offset:0 sc1 lds
    buffer_load_dwordx4 v11, s[28:31], s33 offen offset:1024 sc1 lds
    buffer_load_dwordx4 v11, s[28:31], s33 offen offset:2048 sc1 lds
    buffer_load_dwordx4 v11, s[28:31], s33 offen offset:3072 sc1 lds
    s_add_u32 m0, s13, 69632
    s_nop 0
    s_add_u32 s33, s33, 4096
    buffer_load_dwordx4 v11, s[28:31], s33 offen offset:0 sc1 lds
    buffer_load_dwordx4 v11, s[28:31], s33 offen offset:1024 sc1 lds
    s_barrier
    s_add_u32 s33, s12, 51200
    s_add_u32 m0, s13, 81920
    s_nop 0
    buffer_load_dwordx4 v10, s[28:31], s33 offen offset:0 sc1 lds
    buffer_load_dwordx4 v10, s[28:31], s33 offen offset:1024 sc1 lds
    buffer_load_dwordx4 v10, s[28:31], s33 offen offset:2048 sc1 lds
    buffer_load_dwordx4 v10, s[28:31], s33 offen offset:3072 sc1 lds
    s_add_u32 m0, s13, 86016
    s_nop 0
    buffer_load_dwordx4 v11, s[28:31], s33 offen offset:0 sc1 lds
    buffer_load_dwordx4 v11, s[28:31], s33 offen offset:1024 sc1 lds
    buffer_load_dwordx4 v11, s[28:31], s33 offen offset:2048 sc1 lds
    buffer_load_dwordx4 v11, s[28:31], s33 offen offset:3072 sc1 lds
    s_add_u32 m0, s13, 90112
    s_nop 0
    s_add_u32 s33, s33, 4096
    buffer_load_dwordx4 v11, s[28:31], s33 offen offset:0 sc1 lds
    buffer_load_dwordx4 v11, s[28:31], s33 offen offset:1024 sc1 lds
    s_add_u32 s33, s12, 61440
    s_add_u32 m0, s13, 102400
    s_nop 0
    buffer_load_dwordx4 v10, s[28:31], s33 offen offset:0 sc1 lds
    buffer_load_dwordx4 v10, s[28:31], s33 offen offset:1024 sc1 lds
    buffer_load_dwordx4 v10, s[28:31], s33 offen offset:2048 sc1 lds
    buffer_load_dwordx4 v10, s[28:31], s33 offen offset:3072 sc1 lds
    s_add_u32 m0, s13, 106496
    s_nop 0
    buffer_load_dwordx4 v11, s[28:31], s33 offen offset:0 sc1 lds
    buffer_load_dwordx4 v11, s[28:31], s33 offen offset:1024 sc1 lds
    buffer_load_dwordx4 v11, s[28:31], s33 offen offset:2048 sc1 lds
    buffer_load_dwordx4 v11, s[28:31], s33 offen offset:3072 sc1 lds
    s_add_u32 m0, s13, 110592
    s_nop 0
    s_add_u32 s33, s33, 4096
    buffer_load_dwordx4 v11, s[28:31], s33 offen offset:0 sc1 lds
    buffer_load_dwordx4 v11, s[28:31], s33 offen offset:1024 sc1 lds
    s_add_u32 s33, s12, 71680
    s_add_u32 m0, s13, 122880
    s_nop 0
    buffer_load_dwordx4 v10, s[28:31], s33 offen offset:0 sc1 lds
    buffer_load_dwordx4 v10, s[28:31], s33 offen offset:1024 sc1 lds
    buffer_load_dwordx4 v10, s[28:31], s33 offen offset:2048 sc1 lds
    buffer_load_dwordx4 v10, s[28:31], s33 offen offset:3072 sc1 lds
    s_add_u32 m0, s13, 126976
    s_nop 0
    buffer_load_dwordx4 v11, s[28:31], s33 offen offset:0 sc1 lds
    buffer_load_dwordx4 v11, s[28:31], s33 offen offset:1024 sc1 lds
    buffer_load_dwordx4 v11, s[28:31], s33 offen offset:2048 sc1 lds
    buffer_load_dwordx4 v11, s[28:31], s33 offen offset:3072 sc1 lds
    s_add_u32 m0, s13, 131072
    s_nop 0
    s_add_u32 s33, s33, 4096
    buffer_load_dwordx4 v11, s[28:31], s33 offen offset:0 sc1 lds
    buffer_load_dwordx4 v11, s[28:31], s33 offen offset:1024 sc1 lds
    s_branch L_ld_g2
L_ld_nog1:

    s_lshl_b32 s4, s71, 1
    s_add_u32 s4, s4, s72
    s_lshl_b32 s4, s4, 7
    s_add_u32 s4, s4, 278528
    s_lshr_b32 s4, s15, 1
    s_mul_i32 s4, s4, 6912
    s_add_u32 s4, s4, 458752
    s_mov_b32 s35, 0
    s_mov_b32 s7, 4194303
    s_mov_b32 s6, 4294967295
    v_mov_b32 v32, s34
L_pn_28:
    s_mov_b32 s5, s4
    s_mov_b64 exec, s[6:7]
    buffer_load_dword v32, v36, s[28:31], s5 offen sc1
    s_mov_b64 exec, -1
    s_add_u32 s35, s35, 1
    s_waitcnt vmcnt(0)
    v_xor_b32 v33, s34, v32
    v_cmp_ne_u32 vcc, 0, v33
    s_cmp_ge_u32 s35, 262144
    s_cbranch_scc1 L_pn_28_ok
    s_nop 1
    s_cbranch_vccz L_pn_28_ok
    s_sleep 32
    s_branch L_pn_28
L_pn_28_ok:
    s_add_u32 s33, s12, 0
    s_add_u32 m0, s13, 143360
    s_nop 0
    buffer_load_dwordx4 v10, s[28:31], s33 offen offset:0 sc1 lds
    buffer_load_dwordx4 v10, s[28:31], s33 offen offset:1024 sc1 lds
    buffer_load_dwordx4 v10, s[28:31], s33 offen offset:2048 sc1 lds
    buffer_load_dwordx4 v10, s[28:31], s33 offen offset:3072 sc1 lds
    s_add_u32 m0, s13, 147456
    s_nop 0
    buffer_load_dwordx4 v11, s[28:31], s33 offen offset:0 sc1 lds
    buffer_load_dwordx4 v11, s[28:31], s33 offen offset:1024 sc1 lds
    buffer_load_dwordx4 v11, s[28:31], s33 offen offset:2048 sc1 lds
    buffer_load_dwordx4 v11, s[28:31], s33 offen offset:3072 sc1 lds
    s_add_u32 m0, s13, 151552
    s_nop 0
    s_add_u32 s33, s33, 4096
    buffer_load_dwordx4 v11, s[28:31], s33 offen offset:0 sc1 lds
    buffer_load_dwordx4 v11, s[28:31], s33 offen offset:1024 sc1 lds
    s_add_u32 s33, s12, 10240
    s_add_u32 m0, s13, 0
    s_nop 0
    buffer_load_dwordx4 v10, s[28:31], s33 offen offset:0 sc1 lds
    buffer_load_dwordx4 v10, s[28:31], s33 offen offset:1024 sc1 lds
    buffer_load_dwordx4 v10, s[28:31], s33 offen offset:2048 sc1 lds
    buffer_load_dwordx4 v10, s[28:31], s33 offen offset:3072 sc1 lds
    s_add_u32 m0, s13, 4096
    s_nop 0
    buffer_load_dwordx4 v11, s[28:31], s33 offen offset:0 sc1 lds
    buffer_load_dwordx4 v11, s[28:31], s33 offen offset:1024 sc1 lds
    buffer_load_dwordx4 v11, s[28:31], s33 offen offset:2048 sc1 lds
    buffer_load_dwordx4 v11, s[28:31], s33 offen offset:3072 sc1 lds
    s_add_u32 m0, s13, 8192
    s_nop 0
    s_add_u32 s33, s33, 4096
    buffer_load_dwordx4 v11, s[28:31], s33 offen offset:0 sc1 lds
    buffer_load_dwordx4 v11, s[28:31], s33 offen offset:1024 sc1 lds
    s_add_u32 s33, s12, 20480
    s_add_u32 m0, s13, 20480
    s_nop 0
    buffer_load_dwordx4 v10, s[28:31], s33 offen offset:0 sc1 lds
    buffer_load_dwordx4 v10, s[28:31], s33 offen offset:1024 sc1 lds
    buffer_load_dwordx4 v10, s[28:31], s33 offen offset:2048 sc1 lds
    buffer_load_dwordx4 v10, s[28:31], s33 offen offset:3072 sc1 lds
    s_add_u32 m0, s13, 24576
    s_nop 0
    buffer_load_dwordx4 v11, s[28:31], s33 offen offset:0 sc1 lds
    buffer_load_dwordx4 v11, s[28:31], s33 offen offset:1024 sc1 lds
    buffer_load_dwordx4 v11, s[28:31], s33 offen offset:2048 sc1 lds
    buffer_load_dwordx4 v11, s[28:31], s33 offen offset:3072 sc1 lds
    s_add_u32 m0, s13, 28672
    s_nop 0
    s_add_u32 s33, s33, 4096
    buffer_load_dwordx4 v11, s[28:31], s33 offen offset:0 sc1 lds
    buffer_load_dwordx4 v11, s[28:31], s33 offen offset:1024 sc1 lds
    s_add_u32 s33, s12, 30720
    s_add_u32 m0, s13, 40960
    s_nop 0
    buffer_load_dwordx4 v10, s[28:31], s33 offen offset:0 sc1 lds
    buffer_load_dwordx4 v10, s[28:31], s33 offen offset:1024 sc1 lds
    buffer_load_dwordx4 v10, s[28:31], s33 offen offset:2048 sc1 lds
    buffer_load_dwordx4 v10, s[28:31], s33 offen offset:3072 sc1 lds
    s_add_u32 m0, s13, 45056
    s_nop 0
    buffer_load_dwordx4 v11, s[28:31], s33 offen offset:0 sc1 lds
    buffer_load_dwordx4 v11, s[28:31], s33 offen offset:1024 sc1 lds
    buffer_load_dwordx4 v11, s[28:31], s33 offen offset:2048 sc1 lds
    buffer_load_dwordx4 v11, s[28:31], s33 offen offset:3072 sc1 lds
    s_add_u32 m0, s13, 49152
    s_nop 0
    s_add_u32 s33, s33, 4096
    buffer_load_dwordx4 v11, s[28:31], s33 offen offset:0 sc1 lds
    buffer_load_dwordx4 v11, s[28:31], s33 offen offset:1024 sc1 lds
    s_add_u32 s33, s12, 40960
    s_add_u32 m0, s13, 61440
    s_nop 0
    buffer_load_dwordx4 v10, s[28:31], s33 offen offset:0 sc1 lds
    buffer_load_dwordx4 v10, s[28:31], s33 offen offset:1024 sc1 lds
    buffer_load_dwordx4 v10, s[28:31], s33 offen offset:2048 sc1 lds
    buffer_load_dwordx4 v10, s[28:31], s33 offen offset:3072 sc1 lds
    s_add_u32 m0, s13, 65536
    s_nop 0
    buffer_load_dwordx4 v11, s[28:31], s33 offen offset:0 sc1 lds
    buffer_load_dwordx4 v11, s[28:31], s33 offen offset:1024 sc1 lds
    buffer_load_dwordx4 v11, s[28:31], s33 offen offset:2048 sc1 lds
    buffer_load_dwordx4 v11, s[28:31], s33 offen offset:3072 sc1 lds
    s_add_u32 m0, s13, 69632
    s_nop 0
    s_add_u32 s33, s33, 4096
    buffer_load_dwordx4 v11, s[28:31], s33 offen offset:0 sc1 lds
    buffer_load_dwordx4 v11, s[28:31], s33 offen offset:1024 sc1 lds
    s_add_u32 s33, s12, 51200
    s_add_u32 m0, s13, 81920
    s_nop 0
    buffer_load_dwordx4 v10, s[28:31], s33 offen offset:0 sc1 lds
    buffer_load_dwordx4 v10, s[28:31], s33 offen offset:1024 sc1 lds
    buffer_load_dwordx4 v10, s[28:31], s33 offen offset:2048 sc1 lds
    buffer_load_dwordx4 v10, s[28:31], s33 offen offset:3072 sc1 lds
    s_add_u32 m0, s13, 86016
    s_nop 0
    buffer_load_dwordx4 v11, s[28:31], s33 offen offset:0 sc1 lds
    buffer_load_dwordx4 v11, s[28:31], s33 offen offset:1024 sc1 lds
    buffer_load_dwordx4 v11, s[28:31], s33 offen offset:2048 sc1 lds
    buffer_load_dwordx4 v11, s[28:31], s33 offen offset:3072 sc1 lds
    s_add_u32 m0, s13, 90112
    s_nop 0
    s_add_u32 s33, s33, 4096
    buffer_load_dwordx4 v11, s[28:31], s33 offen offset:0 sc1 lds
    buffer_load_dwordx4 v11, s[28:31], s33 offen offset:1024 sc1 lds
    s_add_u32 s33, s12, 61440
    s_add_u32 m0, s13, 102400
    s_nop 0
    buffer_load_dwordx4 v10, s[28:31], s33 offen offset:0 sc1 lds
    buffer_load_dwordx4 v10, s[28:31], s33 offen offset:1024 sc1 lds
    buffer_load_dwordx4 v10, s[28:31], s33 offen offset:2048 sc1 lds
    buffer_load_dwordx4 v10, s[28:31], s33 offen offset:3072 sc1 lds
    s_add_u32 m0, s13, 106496
    s_nop 0
    buffer_load_dwordx4 v11, s[28:31], s33 offen offset:0 sc1 lds
    buffer_load_dwordx4 v11, s[28:31], s33 offen offset:1024 sc1 lds
    buffer_load_dwordx4 v11, s[28:31], s33 offen offset:2048 sc1 lds
    buffer_load_dwordx4 v11, s[28:31], s33 offen offset:3072 sc1 lds
    s_add_u32 m0, s13, 110592
    s_nop 0
    s_add_u32 s33, s33, 4096
    buffer_load_dwordx4 v11, s[28:31], s33 offen offset:0 sc1 lds
    buffer_load_dwordx4 v11, s[28:31], s33 offen offset:1024 sc1 lds
    s_add_u32 s33, s12, 71680
    s_add_u32 m0, s13, 122880
    s_nop 0
    buffer_load_dwordx4 v10, s[28:31], s33 offen offset:0 sc1 lds
    buffer_load_dwordx4 v10, s[28:31], s33 offen offset:1024 sc1 lds
    buffer_load_dwordx4 v10, s[28:31], s33 offen offset:2048 sc1 lds
    buffer_load_dwordx4 v10, s[28:31], s33 offen offset:3072 sc1 lds
    s_add_u32 m0, s13, 126976
    s_nop 0
    buffer_load_dwordx4 v11, s[28:31], s33 offen offset:0 sc1 lds
    buffer_load_dwordx4 v11, s[28:31], s33 offen offset:1024 sc1 lds
    buffer_load_dwordx4 v11, s[28:31], s33 offen offset:2048 sc1 lds
    buffer_load_dwordx4 v11, s[28:31], s33 offen offset:3072 sc1 lds
    s_add_u32 m0, s13, 131072
    s_nop 0
    s_add_u32 s33, s33, 4096
    buffer_load_dwordx4 v11, s[28:31], s33 offen offset:0 sc1 lds
    buffer_load_dwordx4 v11, s[28:31], s33 offen offset:1024 sc1 lds
L_ld_g2:
    s_waitcnt vmcnt(63)
    s_barrier
    s_waitcnt vmcnt(60)
    s_barrier
    s_add_u32 s33, s12, 81920
    s_add_u32 m0, s13, 143360
    s_nop 0
    buffer_load_dwordx4 v10, s[28:31], s33 offen offset:0 sc1 lds
    buffer_load_dwordx4 v10, s[28:31], s33 offen offset:1024 sc1 lds
    buffer_load_dwordx4 v10, s[28:31], s33 offen offset:2048 sc1 lds
    buffer_load_dwordx4 v10, s[28:31], s33 offen offset:3072 sc1 lds
    s_add_u32 m0, s13, 147456
    s_nop 0
    buffer_load_dwordx4 v11, s[28:31], s33 offen sc1 lds
    s_waitcnt vmcnt(55)
    s_barrier
    s_add_u32 s33, s12, 87040
    s_add_u32 m0, s13, 148480
    s_nop 0
    buffer_load_dwordx4 v10, s[28:31], s33 offen offset:0 sc1 lds
    buffer_load_dwordx4 v10, s[28:31], s33 offen offset:1024 sc1 lds
    buffer_load_dwordx4 v10, s[28:31], s33 offen offset:2048 sc1 lds
    buffer_load_dwordx4 v10, s[28:31], s33 offen offset:3072 sc1 lds
    s_add_u32 m0, s13, 152576
    s_nop 0
    buffer_load_dwordx4 v11, s[28:31], s33 offen sc1 lds
    s_waitcnt vmcnt(50)
    s_barrier
    s_add_u32 s33, s12, 92160
    s_add_u32 m0, s13, 0
    s_nop 0
    buffer_load_dwordx4 v10, s[28:31], s33 offen offset:0 sc1 lds
    buffer_load_dwordx4 v10, s[28:31], s33 offen offset:1024 sc1 lds
    buffer_load_dwordx4 v10, s[28:31], s33 offen offset:2048 sc1 lds
    buffer_load_dwordx4 v10, s[28:31], s33 offen offset:3072 sc1 lds
    s_add_u32 m0, s13, 4096
    s_nop 0
    buffer_load_dwordx4 v11, s[28:31], s33 offen sc1 lds
    s_waitcnt vmcnt(45)
    s_barrier
    s_add_u32 s33, s12, 97280
    s_add_u32 m0, s13, 5120
    s_nop 0
    buffer_load_dwordx4 v10, s[28:31], s33 offen offset:0 sc1 lds
    buffer_load_dwordx4 v10, s[28:31], s33 offen offset:1024 sc1 lds
    buffer_load_dwordx4 v10, s[28:31], s33 offen offset:2048 sc1 lds
    buffer_load_dwordx4 v10, s[28:31], s33 offen offset:3072 sc1 lds
    s_add_u32 m0, s13, 9216
    s_nop 0
    buffer_load_dwordx4 v11, s[28:31], s33 offen sc1 lds
    s_waitcnt vmcnt(40)
    s_barrier
    s_add_u32 s33, s12, 102400
    s_add_u32 m0, s13, 20480
    s_nop 0
    buffer_load_dwordx4 v10, s[28:31], s33 offen offset:0 sc1 lds
    buffer_load_dwordx4 v10, s[28:31], s33 offen offset:1024 sc1 lds
    buffer_load_dwordx4 v10, s[28:31], s33 offen offset:2048 sc1 lds
    buffer_load_dwordx4 v10, s[28:31], s33 offen offset:3072 sc1 lds
    s_add_u32 m0, s13, 24576
    s_nop 0
    buffer_load_dwordx4 v11, s[28:31], s33 offen sc1 lds
    s_waitcnt vmcnt(35)
    s_barrier
    s_add_u32 s33, s12, 107520
    s_add_u32 m0, s13, 25600
    s_nop 0
    buffer_load_dwordx4 v10, s[28:31], s33 offen offset:0 sc1 lds
    buffer_load_dwordx4 v10, s[28:31], s33 offen offset:1024 sc1 lds
    buffer_load_dwordx4 v10, s[28:31], s33 offen offset:2048 sc1 lds
    buffer_load_dwordx4 v10, s[28:31], s33 offen offset:3072 sc1 lds
    s_add_u32 m0, s13, 29696
    s_nop 0
    buffer_load_dwordx4 v11, s[28:31], s33 offen sc1 lds
    s_waitcnt vmcnt(30)
    s_barrier
    s_add_u32 s33, s12, 112640
    s_add_u32 m0, s13, 40960
    s_nop 0
    buffer_load_dwordx4 v10, s[28:31], s33 offen offset:0 sc1 lds
    buffer_load_dwordx4 v10, s[28:31], s33 offen offset:1024 sc1 lds
    buffer_load_dwordx4 v10, s[28:31], s33 offen offset:2048 sc1 lds
    buffer_load_dwordx4 v10, s[28:31], s33 offen offset:3072 sc1 lds
    s_add_u32 m0, s13, 45056
    s_nop 0
    buffer_load_dwordx4 v11, s[28:31], s33 offen sc1 lds
    s_waitcnt vmcnt(25)
    s_barrier
    s_add_u32 s33, s12, 117760
    s_add_u32 m0, s13, 46080
    s_nop 0
    buffer_load_dwordx4 v10, s[28:31], s33 offen offset:0 sc1 lds
    buffer_load_dwordx4 v10, s[28:31], s33 offen offset:1024 sc1 lds
    buffer_load_dwordx4 v10, s[28:31], s33 offen offset:2048 sc1 lds
    buffer_load_dwordx4 v10, s[28:31], s33 offen offset:3072 sc1 lds
    s_add_u32 m0, s13, 50176
    s_nop 0
    buffer_load_dwordx4 v11, s[28:31], s33 offen sc1 lds
    s_waitcnt vmcnt(20)
    s_barrier
    s_add_u32 s33, s12, 122880
    s_add_u32 m0, s13, 61440
    s_nop 0
    buffer_load_dwordx4 v10, s[28:31], s33 offen offset:0 sc1 lds
    buffer_load_dwordx4 v10, s[28:31], s33 offen offset:1024 sc1 lds
    buffer_load_dwordx4 v10, s[28:31], s33 offen offset:2048 sc1 lds
    buffer_load_dwordx4 v10, s[28:31], s33 offen offset:3072 sc1 lds
    s_add_u32 m0, s13, 65536
    s_nop 0
    buffer_load_dwordx4 v11, s[28:31], s33 offen sc1 lds
    s_waitcnt vmcnt(15)
    s_barrier
    s_add_u32 s33, s12, 128000
    s_add_u32 m0, s13, 66560
    s_nop 0
    buffer_load_dwordx4 v10, s[28:31], s33 offen offset:0 sc1 lds
    buffer_load_dwordx4 v10, s[28:31], s33 offen offset:1024 sc1 lds
    buffer_load_dwordx4 v10, s[28:31], s33 offen offset:2048 sc1 lds
    buffer_load_dwordx4 v10, s[28:31], s33 offen offset:3072 sc1 lds
    s_add_u32 m0, s13, 70656
    s_nop 0
    buffer_load_dwordx4 v11, s[28:31], s33 offen sc1 lds
    s_waitcnt vmcnt(10)
    s_barrier
    s_add_u32 s33, s12, 133120
    s_add_u32 m0, s13, 81920
    s_nop 0
    buffer_load_dwordx4 v10, s[28:31], s33 offen offset:0 sc1 lds
    buffer_load_dwordx4 v10, s[28:31], s33 offen offset:1024 sc1 lds
    buffer_load_dwordx4 v10, s[28:31], s33 offen offset:2048 sc1 lds
    buffer_load_dwordx4 v10, s[28:31], s33 offen offset:3072 sc1 lds
    s_add_u32 m0, s13, 86016
    s_nop 0
    buffer_load_dwordx4 v11, s[28:31], s33 offen sc1 lds
    s_waitcnt vmcnt(5)
    s_barrier
    s_waitcnt vmcnt(0)
    s_barrier
L_ld_end:
    s_endpgm
L_cpf:
    s_sleep 48
    v_mov_b32 v49, 0
    s_mov_b32 s35, 0
    s_mov_b64 exec, 1
L_gn_29:
    buffer_load_dword v48, v49, s[24:27], 0 offen sc1
    s_waitcnt vmcnt(0)
    v_readfirstlane_b32 s34, v48
    s_add_u32 s35, s35, 1
    s_sub_u32 s5, s34, s32
    s_add_u32 s5, s5, 1000
    s_cmp_ge_u32 s35, 400
    s_cselect_b32 s5, 0, s5
    s_cmp_lt_u32 s5, 2000
    s_cselect_b32 s34, s34, 0
    s_cmp_lg_u32 s34, 0
    s_cbranch_scc1 L_gn_29_ok
    s_sleep 2
    s_cmp_lt_u32 s35, 262144
    s_cbranch_scc1 L_gn_29
L_gn_29_ok:
    s_mov_b64 exec, -1
    s_cmp_ge_u32 s3, 6
    s_cselect_b32 s4, 2, 0
    s_sub_u32 s4, s3, s4
    s_mul_i32 s20, s4, 10240
    s_mul_i32 s5, s71, 6
    s_add_u32 s21, s5, s4
    s_sub_u32 s5, 63, s71
    s_lshl_b32 s5, s5, 1
    s_add_u32 s5, s5, s4
    s_add_u32 s5, s5, 188
    s_add_u32 s4, s20, 94208
    s_cmp_lg_u32 s70, 0
    s_cselect_b32 s21, s5, s21
    s_cselect_b32 s20, s4, s20
    s_cmp_ge_u32 s21, 216
    s_cbranch_scc1 L_rte_30
    s_mov_b32 s8, s60
    s_mov_b32 s9, s61
    s_mov_b32 s10, 2211840
    s_mov_b32 s11, 0x00020000
    v_add_u32 v58, 0, v1
    v_mul_u32_u24 v59, 3277, v58
    v_lshrrev_b32 v59, 16, v59
    v_mul_u32_u24 v60, 20, v59
    v_sub_u32 v58, v58, v60
    v_mul_u32_u24 v59, 1280, v59
    v_lshl_add_u32 v48, v58, 4, v59
    v_add_u32 v58, 64, v1
    v_mul_u32_u24 v59, 3277, v58
    v_lshrrev_b32 v59, 16, v59
    v_mul_u32_u24 v60, 20, v59
    v_sub_u32 v58, v58, v60
    v_mul_u32_u24 v59, 1280, v59
    v_lshl_add_u32 v49, v58, 4, v59
    v_add_u32 v58, 128, v1
    v_mul_u32_u24 v59, 3277, v58
    v_lshrrev_b32 v59, 16, v59
    v_mul_u32_u24 v60, 20, v59
    v_sub_u32 v58, v58, v60
    v_mul_u32_u24 v59, 1280, v59
    v_lshl_add_u32 v50, v58, 4, v59
    v_add_u32 v58, 192, v1
    v_mul_u32_u24 v59, 3277, v58
    v_lshrrev_b32 v59, 16, v59
    v_mul_u32_u24 v60, 20, v59
    v_sub_u32 v58, v58, v60
    v_mul_u32_u24 v59, 1280, v59
    v_lshl_add_u32 v51, v58, 4, v59
    v_add_u32 v58, 256, v1
    v_mul_u32_u24 v59, 3277, v58
    v_lshrrev_b32 v59, 16, v59
    v_mul_u32_u24 v60, 20, v59
    v_sub_u32 v58, v58, v60
    v_mul_u32_u24 v59, 1280, v59
    v_lshl_add_u32 v52, v58, 4, v59
    v_add_u32 v58, 320, v1
    v_mul_u32_u24 v59, 3277, v58
    v_lshrrev_b32 v59, 16, v59
    v_mul_u32_u24 v60, 20, v59
    v_sub_u32 v58, v58, v60
    v_mul_u32_u24 v59, 1280, v59
    v_lshl_add_u32 v53, v58, 4, v59
    v_add_u32 v58, 384, v1
    v_mul_u32_u24 v59, 3277, v58
    v_lshrrev_b32 v59, 16, v59
    v_mul_u32_u24 v60, 20, v59
    v_sub_u32 v58, v58, v60
    v_mul_u32_u24 v59, 1280, v59
    v_lshl_add_u32 v54, v58, 4, v59
    v_add_u32 v58, 448, v1
    v_mul_u32_u24 v59, 3277, v58
    v_lshrrev_b32 v59, 16, v59
    v_mul_u32_u24 v60, 20, v59
    v_sub_u32 v58, v58, v60
    v_mul_u32_u24 v59, 1280, v59
    v_lshl_add_u32 v55, v58, 4, v59
    v_add_u32 v58, 512, v1
    v_mul_u32_u24 v59, 3277, v58
    v_lshrrev_b32 v59, 16, v59
    v_mul_u32_u24 v60, 20, v59
    v_sub_u32 v58, v58, v60
    v_mul_u32_u24 v59, 1280, v59
    v_lshl_add_u32 v56, v58, 4, v59
    v_add_u32 v58, 576, v1
    v_mul_u32_u24 v59, 3277, v58
    v_lshrrev_b32 v59, 16, v59
    v_mul_u32_u24 v60, 20, v59
    v_sub_u32 v58, v58, v60
    v_mul_u32_u24 v59, 1280, v59
    v_lshl_add_u32 v57, v58, 4, v59
    v_lshrrev_b32 v58, 4, v1
    v_bfe_u32 v59, v1, 2, 2
    v_lshl_add_u32 v58, v58, 3, v59
    v_mul_u32_u24 v58, 320, v58
    v_and_b32 v59, 3, v1
    v_lshl_add_u32 v58, v59, 3, v58
    v_add_u32 v62, s20, v58
    v_lshlrev_b32 v63, 4, v1
    s_lshr_b32 s22, s21, 2
    s_and_b32 s23, s21, 3
    s_mul_i32 s4, s22, 40960
    s_mul_i32 s5, s23, 320
    s_add_u32 s4, s4, s5
    s_add_u32 m0, s20, 0
    s_nop 0
    buffer_load_dwordx4 v48, s[8:11], s4 offen lds
    s_add_u32 m0, s20, 1024
    s_nop 0
    buffer_load_dwordx4 v49, s[8:11], s4 offen lds
    s_add_u32 m0, s20, 2048
    s_nop 0
    buffer_load_dwordx4 v50, s[8:11], s4 offen lds
    s_add_u32 m0, s20, 3072
    s_nop 0
    buffer_load_dwordx4 v51, s[8:11], s4 offen lds
    s_add_u32 m0, s20, 4096
    s_nop 0
    buffer_load_dwordx4 v52, s[8:11], s4 offen lds
    s_add_u32 m0, s20, 5120
    s_nop 0
    buffer_load_dwordx4 v53, s[8:11], s4 offen lds
    s_add_u32 m0, s20, 6144
    s_nop 0
    buffer_load_dwordx4 v54, s[8:11], s4 offen lds
    s_add_u32 m0, s20, 7168
    s_nop 0
    buffer_load_dwordx4 v55, s[8:11], s4 offen lds
    s_add_u32 m0, s20, 8192
    s_nop 0
    buffer_load_dwordx4 v56, s[8:11], s4 offen lds
    s_add_u32 m0, s20, 9216
    s_nop 0
    buffer_load_dwordx4 v57, s[8:11], s4 offen lds
    s_mul_i32 s4, s23, 108
    s_add_u32 s4, s4, s22
    s_mul_i32 s4, s4, 5120
    s_add_u32 s4, s4, 12582912
    s_waitcnt vmcnt(0)
    ds_read_b64_tr_b16 v[64:65], v62 offset:0
    ds_read_b64_tr_b16 v[66:67], v62 offset:1280
    ds_read_b64_tr_b16 v[68:69], v62 offset:32
    ds_read_b64_tr_b16 v[70:71], v62 offset:1312
    ds_read_b64_tr_b16 v[72:73], v62 offset:64
    ds_read_b64_tr_b16 v[74:75], v62 offset:1344
    ds_read_b64_tr_b16 v[76:77], v62 offset:96
    ds_read_b64_tr_b16 v[78:79], v62 offset:1376
    ds_read_b64_tr_b16 v[80:81], v62 offset:128
    ds_read_b64_tr_b16 v[82:83], v62 offset:1408
    s_waitcnt lgkmcnt(8)
    buffer_store_dwordx4 v[64:67], v63, s[28:31], s4 offen sc1
    s_add_u32 s4, s4, 1024
    ds_read_b64_tr_b16 v[84:85], v62 offset:160
    ds_read_b64_tr_b16 v[86:87], v62 offset:1440
    s_waitcnt lgkmcnt(8)
    buffer_store_dwordx4 v[68:71], v63, s[28:31], s4 offen sc1
    s_add_u32 s4, s4, 1024
    ds_read_b64_tr_b16 v[88:89], v62 offset:192
    ds_read_b64_tr_b16 v[90:91], v62 offset:1472
    s_waitcnt lgkmcnt(8)
    buffer_store_dwordx4 v[72:75], v63, s[28:31], s4 offen sc1
    s_add_u32 s4, s4, 1024
    ds_read_b64_tr_b16 v[92:93], v62 offset:224
    ds_read_b64_tr_b16 v[94:95], v62 offset:1504
    s_waitcnt lgkmcnt(8)
    buffer_store_dwordx4 v[76:79], v63, s[28:31], s4 offen sc1
    s_add_u32 s4, s4, 1024
    ds_read_b64_tr_b16 v[96:97], v62 offset:256
    ds_read_b64_tr_b16 v[98:99], v62 offset:1536
    s_waitcnt lgkmcnt(8)
    buffer_store_dwordx4 v[80:83], v63, s[28:31], s4 offen sc1
    s_add_u32 s4, s4, 272384
    ds_read_b64_tr_b16 v[100:101], v62 offset:288
    ds_read_b64_tr_b16 v[102:103], v62 offset:1568
    s_waitcnt lgkmcnt(8)
    buffer_store_dwordx4 v[84:87], v63, s[28:31], s4 offen sc1
    s_add_u32 s4, s4, 1024
    s_waitcnt lgkmcnt(6)
    buffer_store_dwordx4 v[88:91], v63, s[28:31], s4 offen sc1
    s_add_u32 s4, s4, 1024
    s_waitcnt lgkmcnt(4)
    buffer_store_dwordx4 v[92:95], v63, s[28:31], s4 offen sc1
    s_add_u32 s4, s4, 1024
    s_waitcnt lgkmcnt(2)
    buffer_store_dwordx4 v[96:99], v63, s[28:31], s4 offen sc1
    s_add_u32 s4, s4, 1024
    s_waitcnt lgkmcnt(0)
    buffer_store_dwordx4 v[100:103], v63, s[28:31], s4 offen sc1
    s_add_u32 s4, s4, 1024
    s_mul_i32 s4, s23, 54
    s_add_u32 s4, s4, s22
    s_lshl_b32 s4, s4, 7
    s_add_u32 s4, s4, 458752
    v_mov_b32 v58, s34
    v_mov_b32 v59, 0
    s_waitcnt vmcnt(0)
    s_mov_b64 exec, 1
    buffer_store_dword v58, v59, s[28:31], s4 offen sc1
    s_mov_b64 exec, -1
L_rte_30:
L_w67:
    s_branch L_ld_end
L_end:
    s_endpgm
L_codeend:
.section .rodata,"a"
.p2align 6
.amdhsa_kernel sequential_preLN__ssm_conv_s4__glu_gated_reglu__prompt_kernel
  .amdhsa_next_free_vgpr 256
  .amdhsa_next_free_sgpr 102
  .amdhsa_accum_offset 256
  .amdhsa_group_segment_fixed_size 0
  .amdhsa_kernarg_size 128
  .amdhsa_user_sgpr_count 2
  .amdhsa_user_sgpr_kernarg_segment_ptr 1
  .amdhsa_system_sgpr_workgroup_id_x 1
  .amdhsa_float_denorm_mode_32 3
.end_amdhsa_kernel
```
